```python
import torch

def _softmax(x, axis=-1):
    return torch.softmax(x, dim=axis)
def _gelu(x):
    return torch.nn.functional.gelu(x, approximate="tanh")
def _silu(x):
    return torch.nn.functional.silu(x)
def _sigmoid(x):
    return torch.sigmoid(x)
def _layernorm(x, axis=-1, eps=1e-5):
    m = x.mean(dim=axis, keepdim=True)
    v = x.var(dim=axis, keepdim=True, unbiased=False)
    return (x - m) / torch.sqrt(v + eps)
def _scatter_add(tgt, idx, src, axis=0):
    return tgt.clone().index_add_(axis, idx, src)
def _segment_sum(src, seg, n):
    out = torch.zeros((n,) + src.shape[1:], dtype=src.dtype)
    return out.index_add_(0, seg, src)
def _pad(x, pw):
    flat = tuple(v for pair in reversed(pw) for v in pair)
    return torch.nn.functional.pad(x, flat)

kernel_name = 'recurrent_scan__mha_block_cached__moe_arch_mod__prompt'

def setup_inputs():

    _w = (lambda a: (lambda t: t.to(torch.bfloat16) if t.is_floating_point() else t)(torch.as_tensor(a)))
    def _A_setup():
        B, Sq, D = 1, 2048, 640
        H, Sk, Dh = 32, 2048, 128
        return {
            "x": _w((lambda *s: torch.randn(*s, dtype=torch.bfloat16) * 0.05)(B, Sq, D)),
            "k_cache": _w((lambda *s: torch.randn(*s, dtype=torch.bfloat16) * 1.6)(B, H, Sk, Dh)),
            "v_cache": _w((lambda *s: torch.randn(*s, dtype=torch.bfloat16) * 0.2)(B, H, Sk, Dh)),
            "wq": _w((lambda *s: torch.randn(*s, dtype=torch.bfloat16) * 1.6)(D, H * Dh) * (D ** -0.5)),
            "wo": _w((lambda *s: torch.randn(*s, dtype=torch.bfloat16) * 0.2)(H * Dh, D) * ((H * Dh) ** -0.5)),
        }
    _A_in = _A_setup()

    def _B_setup():
        B, S, D, F, C = 1, 2048, 640, 1728, 1
        return {
            "x": _w((lambda *s: torch.randn(*s, dtype=torch.bfloat16) * 0.05)(B, S, D)),
            "w_r": _w((lambda *s: torch.randn(*s, dtype=torch.bfloat16) * 0.2)(D)),
            "w_gate": _w((lambda *s: torch.randn(*s, dtype=torch.bfloat16) * 0.1)(D, F)),
            "w_up": _w((lambda *s: torch.randn(*s, dtype=torch.bfloat16) * 0.1)(D, F)),
            "w_down": _w((lambda *s: torch.randn(*s, dtype=torch.bfloat16) * 0.1)(F, D)),
        }
    _B_in = _B_setup()

    return {
        "A_x": _A_in["x"],
        "A_k_cache": _A_in["k_cache"],
        "A_v_cache": _A_in["v_cache"],
        "A_wq": _A_in["wq"],
        "A_wo": _A_in["wo"],
        "B_x": _B_in["x"],
        "B_w_r": _B_in["w_r"],
        "B_w_gate": _B_in["w_gate"],
        "B_w_up": _B_in["w_up"],
        "B_w_down": _B_in["w_down"],
    }

def reference(A_x, A_k_cache, A_v_cache, A_wq, A_wo, B_x, B_w_r, B_w_gate, B_w_up, B_w_down):
    def _A_ref(x, k_cache, v_cache, wq, wo):
        B, Sq, D = x.shape
        H, Dh = 32, 128
        q = (lambda x, *d: x.permute(*d))((x @ wq).reshape(B, Sq, H, Dh), 0, 2, 1, 3)
        scores = torch.einsum("bhqd,bhkd->bhqk", q, k_cache) * (Dh ** -0.5)
        p = _softmax(scores, axis=-1)
        o = torch.einsum("bhqk,bhkd->bhqd", p, v_cache)
        return (lambda x, *d: x.permute(*d))(o, 0, 2, 1, 3).reshape(B, Sq, H * Dh) @ wo

    def _B_ref(x, w_r, w_gate, w_up, w_down):
        B, S, D = x.shape
        C = 1
        r = x @ w_r
        idx = torch.argsort(-r, axis=-1)[:, :C]
        idx_e = (lambda x, n, axis: torch.repeat_interleave(x, n, dim=axis))(idx.reshape(B, C, 1), D, axis=2)
        x_sel = (lambda x, i, axis: torch.take_along_dim(x, i, dim=axis))(x, idx_e, axis=1)
        g = _silu(x_sel @ w_gate)
        u = x_sel @ w_up
        y = (g * u) @ w_down
        r_sel = _sigmoid((lambda x, i, axis: torch.take_along_dim(x, i, dim=axis))(r, idx, axis=1))
        y = y * r_sel.reshape(B, C, 1)
        b_off = (torch.arange(B) * S).reshape(B, 1)
        flat_idx = (idx + b_off).reshape(B * C)
        zero = (x * 0.0).reshape(B * S, D)
        upd = _scatter_add(zero, flat_idx, y.reshape(B * C, D), axis=0)
        return x + upd.reshape(B, S, D)

    x = A_x
    xn = _layernorm(x, axis=-1)
    s = _A_ref(xn, A_k_cache, A_v_cache, A_wq, A_wo)
    g = _silu(_B_ref(xn, B_w_r, B_w_gate, B_w_up, B_w_down))
    return x + s * g
```

```asm
; @launch grid=(256,1,1) block=(256,1,1) lds=163840
.amdgcn_target "amdgcn-amd-amdhsa--gfx950"
.text
.globl recurrent_scan__mha_block_cached__moe_arch_mod__prompt_kernel
.p2align 8
.type recurrent_scan__mha_block_cached__moe_arch_mod__prompt_kernel,@function
recurrent_scan__mha_block_cached__moe_arch_mod__prompt_kernel:
s_cmp_ge_u32 s2, 256
s_cbranch_scc1 END
s_load_dwordx16 s[36:51], s[0:1], 0
s_load_dwordx8 s[52:59], s[0:1], 64
s_load_dwordx2 s[60:61], s[0:1], 96
v_lshrrev_b32 v240, 6, v0
v_lshrrev_b32 v32, 5, v0
v_readfirstlane_b32 s28, v240
v_and_b32 v33, 31, v0
s_and_b32 s29, s2, 7
s_lshl_b32 s29, s29, 2
s_lshr_b32 s30, s2, 3
s_and_b32 s31, s30, 3
s_add_u32 s29, s29, s31
s_lshr_b32 s63, s30, 2
v_and_b32 v0, 63, v0
s_lshl_b32 s30, s63, 4
s_lshl_b32 s31, s28, 2
s_add_u32 s30, s30, s31
s_lshl_b32 s33, s28, 12
s_lshl_b32 s75, s28, 13
v_lshrrev_b32 v240, 3, v0
v_and_b32 v241, 7, v0
v_lshrrev_b32 v242, 4, v0
s_lshl_b32 s31, s30, 4
v_add_u32 v240, s31, v240
v_mul_u32_u24 v240, 1280, v240
v_xor_b32 v243, v241, v242
v_lshl_add_u32 v20, v243, 4, v240
v_xor_b32 v243, 4, v243
v_lshl_add_u32 v21, v243, 4, v240
v_add_u32 v21, 9216, v21
v_and_b32 v241, 15, v0
s_lshl_b32 s31, s28, 4
v_add_u32 v244, s31, v242
v_lshlrev_b32 v243, 2, v242
v_xor_b32 v243, v243, v241
v_lshlrev_b32 v243, 4, v243
v_lshl_add_u32 v3, v244, 13, v243
s_waitcnt lgkmcnt(0)
s_add_u32 s16, s36, 0
s_addc_u32 s17, s37, 0
s_mov_b32 s18, 2621440
s_mov_b32 s19, 0x20000
s_lshl_b32 s31, s29, 8
s_add_u32 s12, s42, s31
s_addc_u32 s13, s43, 0
s_mov_b32 s14, 5234944
s_mov_b32 s15, 0x20000
s_add_u32 m0, s75, 131072
s_mov_b32 s62, 0
buffer_load_dwordx4 v20, s[16:19], s62 offen  lds
buffer_load_dwordx4 v21, s[16:19], s62 offen offset:1024  lds
s_add_u32 m0, s75, 133120
s_mov_b32 s62, 20480
buffer_load_dwordx4 v20, s[16:19], s62 offen  lds
buffer_load_dwordx4 v21, s[16:19], s62 offen offset:1024  lds
s_add_u32 m0, s75, 135168
s_mov_b32 s62, 40960
buffer_load_dwordx4 v20, s[16:19], s62 offen  lds
buffer_load_dwordx4 v21, s[16:19], s62 offen offset:1024  lds
s_add_u32 m0, s75, 137216
s_mov_b32 s62, 61440
buffer_load_dwordx4 v20, s[16:19], s62 offen  lds
buffer_load_dwordx4 v21, s[16:19], s62 offen offset:1024  lds
s_add_u32 m0, s33, 98304
s_mov_b32 s32, 0
buffer_load_dwordx4 v3, s[12:15], s32 offen offset:0  lds
s_mov_b32 s32, 31744
buffer_load_dwordx4 v3, s[12:15], s32 offen offset:1024  lds
s_mov_b32 s32, 63488
buffer_load_dwordx4 v3, s[12:15], s32 offen offset:2048  lds
s_mov_b32 s32, 95232
buffer_load_dwordx4 v3, s[12:15], s32 offen offset:3072  lds
s_add_u32 m0, s75, 32768
s_mov_b32 s62, 128
buffer_load_dwordx4 v20, s[16:19], s62 offen  lds
buffer_load_dwordx4 v21, s[16:19], s62 offen offset:1024  lds
s_add_u32 m0, s75, 34816
s_mov_b32 s62, 20608
buffer_load_dwordx4 v20, s[16:19], s62 offen  lds
buffer_load_dwordx4 v21, s[16:19], s62 offen offset:1024  lds
s_add_u32 m0, s75, 36864
s_mov_b32 s62, 41088
buffer_load_dwordx4 v20, s[16:19], s62 offen  lds
buffer_load_dwordx4 v21, s[16:19], s62 offen offset:1024  lds
s_add_u32 m0, s75, 38912
s_mov_b32 s62, 61568
buffer_load_dwordx4 v20, s[16:19], s62 offen  lds
buffer_load_dwordx4 v21, s[16:19], s62 offen offset:1024  lds
s_lshl_b32 s31, s63, 8
s_lshl_b32 s32, s29, 3
s_add_u32 s31, s31, s32
v_add_u32 v32, s31, v32
v_lshlrev_b32 v35, 3, v33
v_mul_u32_u24 v34, 1280, v32
v_add_u32 v34, v34, v35
buffer_load_dwordx2 v[40:41], v34, s[16:19], 0 offen offset:0
buffer_load_dwordx2 v[42:43], v34, s[16:19], 0 offen offset:256
buffer_load_dwordx2 v[44:45], v34, s[16:19], 0 offen offset:512
buffer_load_dwordx2 v[46:47], v34, s[16:19], 0 offen offset:768
buffer_load_dwordx2 v[48:49], v34, s[16:19], 0 offen offset:1024
s_getpc_b64 s[72:73]
CODE0:
s_lshr_b32 s31, s2, 3
s_and_b32 s31, s31, 7
s_lshl_b32 s32, s28, 7
s_add_u32 s31, s31, s32
v_and_b32 v248, 15, v0
v_lshl_add_u32 v248, v248, 3, s31
v_lshlrev_b32 v248, 7, v248
v_min_u32 v248, (CODE1 - CODE0), v248
v_mov_b32 v249, 0
v_lshl_add_u64 v[248:249], v[248:249], 0, s[72:73]
global_load_dword v239, v[248:249], off
v_and_b32 v245, 3, v0
v_bfe_u32 v246, v0, 2, 2
s_add_u32 s31, s28, 0
s_and_b32 s31, s31, 3
s_lshl_b32 s76, s31, 2
s_add_u32 s31, s28, 1
s_and_b32 s31, s31, 3
s_lshl_b32 s77, s31, 2
s_add_u32 s31, s28, 2
s_and_b32 s31, s31, 3
s_lshl_b32 s78, s31, 2
s_add_u32 s31, s28, 3
s_and_b32 s31, s31, 3
s_lshl_b32 s79, s31, 2
v_lshl_add_u32 v248, v242, 3, v246
v_lshlrev_b32 v248, 8, v248
v_lshl_add_u32 v248, v245, 4, v248
v_add_u32 v248, 65536, v248
v_lshlrev_b32 v247, 2, v246
v_xor_b32 v243, s76, v247
v_lshl_add_u32 v16, v243, 4, v248
v_xor_b32 v243, s77, v247
v_lshl_add_u32 v17, v243, 4, v248
v_xor_b32 v243, s78, v247
v_lshl_add_u32 v18, v243, 4, v248
v_xor_b32 v243, s79, v247
v_lshl_add_u32 v19, v243, 4, v248
v_lshrrev_b32 v243, 1, v241
v_xor_b32 v243, v243, v242
v_lshlrev_b32 v248, 7, v241
v_add_u32 v248, s75, v248
v_lshl_add_u32 v248, v243, 4, v248
v_add_u32 v22, 131072, v248
v_add_u32 v24, 32768, v248
v_xor_b32 v23, 64, v22
v_xor_b32 v25, 64, v24
v_mov_b32 v26, 0x3f803f80
v_mov_b32 v27, 0x3f803f80
v_mov_b32 v28, 0x3f803f80
v_mov_b32 v29, 0x3f803f80
v_mov_b32 v248, 16384
v_mov_b32 v249, 0
ds_write_b32 v248, v249
s_add_u32 s68, s48, 0
s_addc_u32 s69, s49, 0
s_mov_b32 s70, 1280
s_mov_b32 s71, 0x20000
s_add_u32 s24, s60, 0
s_addc_u32 s25, s61, 0
s_mov_b32 s26, 4194304
s_mov_b32 s27, 0x20000
s_add_u32 s64, s58, 0
s_addc_u32 s65, s59, 0
s_mov_b32 s66, 256
s_mov_b32 s67, 0x20000
s_mov_b32 s101, 0xffff0000
s_mov_b32 s100, 0x3acccccd
s_add_u32 m0, s33, 114688
s_mov_b32 s32, 524288
buffer_load_dwordx4 v3, s[12:15], s32 offen offset:0  lds
s_mov_b32 s32, 556032
buffer_load_dwordx4 v3, s[12:15], s32 offen offset:1024  lds
s_mov_b32 s32, 587776
buffer_load_dwordx4 v3, s[12:15], s32 offen offset:2048  lds
s_mov_b32 s32, 619520
buffer_load_dwordx4 v3, s[12:15], s32 offen offset:3072  lds
s_waitcnt vmcnt(18)
s_waitcnt lgkmcnt(0)
s_barrier
ds_read_b64_tr_b16 a[0:1], v16 offset:32768
ds_read_b64_tr_b16 a[2:3], v16 offset:33792
ds_read_b64_tr_b16 a[4:5], v16 offset:40960
ds_read_b64_tr_b16 a[6:7], v16 offset:41984
ds_read_b128 a[192:195], v22 offset:0
ds_read_b128 a[196:199], v23 offset:0
ds_read_b128 a[200:203], v22 offset:2048
ds_read_b128 a[204:207], v23 offset:2048
ds_read_b128 a[208:211], v22 offset:4096
ds_read_b128 a[212:215], v23 offset:4096
ds_read_b128 a[216:219], v22 offset:6144
ds_read_b128 a[220:223], v23 offset:6144
ds_read_b64_tr_b16 a[8:9], v16 offset:32776
ds_read_b64_tr_b16 a[10:11], v16 offset:33800
ds_read_b64_tr_b16 a[12:13], v16 offset:40968
ds_read_b64_tr_b16 a[14:15], v16 offset:41992
s_waitcnt lgkmcnt(4)
v_mfma_f32_16x16x32_bf16 v[96:99], a[0:3], a[192:195], 0
ds_read_b64_tr_b16 a[16:17], v17 offset:32768
v_mfma_f32_16x16x32_bf16 v[96:99], a[4:7], a[196:199], v[96:99]
s_mov_b32 s62, 256
v_mfma_f32_16x16x32_bf16 v[128:131], a[0:3], a[200:203], 0
s_add_u32 m0, s75, 131072
ds_read_b64_tr_b16 a[18:19], v17 offset:33792
v_mfma_f32_16x16x32_bf16 v[128:131], a[4:7], a[204:207], v[128:131]
buffer_load_dwordx4 v20, s[16:19], s62 offen offset:0  lds
v_mfma_f32_16x16x32_bf16 v[160:163], a[0:3], a[208:211], 0
s_waitcnt vmcnt(6)
ds_read_b64_tr_b16 a[20:21], v17 offset:40960
v_mfma_f32_16x16x32_bf16 v[160:163], a[4:7], a[212:215], v[160:163]
v_lshlrev_b32 v60, 16, v40
v_and_b32 v61, s101, v40
v_mfma_f32_16x16x32_bf16 v[192:195], a[0:3], a[216:219], 0
s_add_u32 m0, s75, 131072
ds_read_b64_tr_b16 a[22:23], v17 offset:41984
v_lshlrev_b32 v62, 16, v41
v_mfma_f32_16x16x32_bf16 v[192:195], a[4:7], a[220:223], v[192:195]
buffer_load_dwordx4 v21, s[16:19], s62 offen offset:1024  lds
v_mfma_f32_16x16x32_bf16 v[224:227], a[0:3], v[26:29], 0
v_and_b32 v63, s101, v41
v_lshlrev_b32 v64, 16, v42
v_mfma_f32_16x16x32_bf16 v[224:227], a[4:7], v[26:29], v[224:227]
s_waitcnt lgkmcnt(2)
s_mov_b32 s32, 1048576
v_and_b32 v65, s101, v42
v_lshlrev_b32 v66, 16, v43
v_mfma_f32_16x16x32_bf16 v[100:103], a[8:11], a[192:195], 0
s_add_u32 m0, s33, 65536
ds_read_b64_tr_b16 a[24:25], v17 offset:32776
v_and_b32 v67, s101, v43
v_mfma_f32_16x16x32_bf16 v[100:103], a[12:15], a[196:199], v[100:103]
buffer_load_dwordx4 v3, s[12:15], s32 offen offset:0  lds
v_mfma_f32_16x16x32_bf16 v[132:135], a[8:11], a[200:203], 0
ds_read_b64_tr_b16 a[26:27], v17 offset:33800
v_lshlrev_b32 v68, 16, v44
v_mfma_f32_16x16x32_bf16 v[132:135], a[12:15], a[204:207], v[132:135]
s_mov_b32 s62, 20736
v_and_b32 v69, s101, v44
v_lshlrev_b32 v70, 16, v45
v_mfma_f32_16x16x32_bf16 v[164:167], a[8:11], a[208:211], 0
s_add_u32 m0, s75, 133120
ds_read_b64_tr_b16 a[28:29], v17 offset:40968
v_and_b32 v71, s101, v45
v_mfma_f32_16x16x32_bf16 v[164:167], a[12:15], a[212:215], v[164:167]
buffer_load_dwordx4 v20, s[16:19], s62 offen offset:0  lds
v_mfma_f32_16x16x32_bf16 v[196:199], a[8:11], a[216:219], 0
ds_read_b64_tr_b16 a[30:31], v17 offset:41992
v_lshlrev_b32 v72, 16, v46
v_mfma_f32_16x16x32_bf16 v[196:199], a[12:15], a[220:223], v[196:199]
s_mov_b32 s32, 1080320
v_and_b32 v73, s101, v46
v_lshlrev_b32 v74, 16, v47
v_mfma_f32_16x16x32_bf16 v[228:231], a[8:11], v[26:29], 0
s_add_u32 m0, s33, 65536
v_and_b32 v75, s101, v47
v_lshlrev_b32 v76, 16, v48
v_mfma_f32_16x16x32_bf16 v[228:231], a[12:15], v[26:29], v[228:231]
buffer_load_dwordx4 v3, s[12:15], s32 offen offset:1024  lds
v_mfma_f32_16x16x32_bf16 v[104:107], a[16:19], a[192:195], 0
s_waitcnt lgkmcnt(1)
ds_read_b64_tr_b16 a[0:1], v18 offset:32768
v_and_b32 v77, s101, v48
v_mfma_f32_16x16x32_bf16 v[104:107], a[20:23], a[196:199], v[104:107]
v_lshlrev_b32 v78, 16, v49
v_and_b32 v79, s101, v49
v_mfma_f32_16x16x32_bf16 v[136:139], a[16:19], a[200:203], 0
s_add_u32 m0, s75, 133120
ds_read_b64_tr_b16 a[2:3], v18 offset:33792
v_add_f32 v80, v60, v61
v_mfma_f32_16x16x32_bf16 v[136:139], a[20:23], a[204:207], v[136:139]
buffer_load_dwordx4 v21, s[16:19], s62 offen offset:1024  lds
v_mfma_f32_16x16x32_bf16 v[168:171], a[16:19], a[208:211], 0
ds_read_b64_tr_b16 a[4:5], v18 offset:40960
v_add_f32 v81, v62, v63
v_mfma_f32_16x16x32_bf16 v[168:171], a[20:23], a[212:215], v[168:171]
s_mov_b32 s62, 41216
v_add_f32 v82, v64, v65
v_add_f32 v83, v66, v67
v_mfma_f32_16x16x32_bf16 v[200:203], a[16:19], a[216:219], 0
s_add_u32 m0, s75, 135168
ds_read_b64_tr_b16 a[6:7], v18 offset:41984
v_add_f32 v84, v68, v69
v_mfma_f32_16x16x32_bf16 v[200:203], a[20:23], a[220:223], v[200:203]
buffer_load_dwordx4 v20, s[16:19], s62 offen offset:0  lds
v_mfma_f32_16x16x32_bf16 v[108:111], a[24:27], a[192:195], 0
s_waitcnt lgkmcnt(2)
ds_read_b64_tr_b16 a[8:9], v18 offset:32776
v_add_f32 v85, v70, v71
v_mfma_f32_16x16x32_bf16 v[108:111], a[28:31], a[196:199], v[108:111]
v_add_f32 v86, v72, v73
v_add_f32 v87, v74, v75
v_mfma_f32_16x16x32_bf16 v[140:143], a[24:27], a[200:203], 0
s_add_u32 m0, s75, 135168
ds_read_b64_tr_b16 a[10:11], v18 offset:33800
v_add_f32 v88, v76, v77
v_mfma_f32_16x16x32_bf16 v[140:143], a[28:31], a[204:207], v[140:143]
buffer_load_dwordx4 v21, s[16:19], s62 offen offset:1024  lds
v_mfma_f32_16x16x32_bf16 v[172:175], a[24:27], a[208:211], 0
ds_read_b64_tr_b16 a[12:13], v18 offset:40968
v_add_f32 v89, v78, v79
v_mfma_f32_16x16x32_bf16 v[172:175], a[28:31], a[212:215], v[172:175]
s_mov_b32 s62, 61696
v_add_f32 v80, v80, v85
v_add_f32 v81, v81, v86
v_mfma_f32_16x16x32_bf16 v[204:207], a[24:27], a[216:219], 0
s_add_u32 m0, s75, 137216
ds_read_b64_tr_b16 a[14:15], v18 offset:41992
v_add_f32 v82, v82, v87
v_mfma_f32_16x16x32_bf16 v[204:207], a[28:31], a[220:223], v[204:207]
buffer_load_dwordx4 v20, s[16:19], s62 offen offset:0  lds
v_mfma_f32_16x16x32_bf16 v[112:115], a[0:3], a[192:195], 0
s_waitcnt lgkmcnt(2)
ds_read_b64_tr_b16 a[16:17], v19 offset:32768
v_add_f32 v83, v83, v88
v_mfma_f32_16x16x32_bf16 v[112:115], a[4:7], a[196:199], v[112:115]
v_add_f32 v84, v84, v89
v_add_f32 v80, v80, v81
v_mfma_f32_16x16x32_bf16 v[144:147], a[0:3], a[200:203], 0
s_add_u32 m0, s75, 137216
ds_read_b64_tr_b16 a[18:19], v19 offset:33792
v_add_f32 v82, v82, v83
v_mfma_f32_16x16x32_bf16 v[144:147], a[4:7], a[204:207], v[144:147]
buffer_load_dwordx4 v21, s[16:19], s62 offen offset:1024  lds
v_mfma_f32_16x16x32_bf16 v[176:179], a[0:3], a[208:211], 0
ds_read_b64_tr_b16 a[20:21], v19 offset:40960
v_add_f32 v80, v80, v84
v_mfma_f32_16x16x32_bf16 v[176:179], a[4:7], a[212:215], v[176:179]
s_mov_b32 s32, 1112064
v_add_f32 v80, v80, v82
v_mfma_f32_16x16x32_bf16 v[208:211], a[0:3], a[216:219], 0
s_add_u32 m0, s33, 65536
s_nop 0
ds_read_b64_tr_b16 a[22:23], v19 offset:41984
v_add_f32_dpp v80, v80, v80 row_ror:8 row_mask:0xf bank_mask:0xf
v_mfma_f32_16x16x32_bf16 v[208:211], a[4:7], a[220:223], v[208:211]
buffer_load_dwordx4 v3, s[12:15], s32 offen offset:2048  lds
v_mfma_f32_16x16x32_bf16 v[116:119], a[8:11], a[192:195], 0
s_waitcnt lgkmcnt(2)
ds_read_b64_tr_b16 a[24:25], v19 offset:32776
v_mfma_f32_16x16x32_bf16 v[116:119], a[12:15], a[196:199], v[116:119]
s_mov_b32 s32, 1143808
s_nop 0
ds_read_b128 a[224:227], v24 offset:0
v_add_f32_dpp v80, v80, v80 row_ror:4 row_mask:0xf bank_mask:0xf
v_mfma_f32_16x16x32_bf16 v[148:151], a[8:11], a[200:203], 0
s_add_u32 m0, s33, 65536
ds_read_b64_tr_b16 a[26:27], v19 offset:33800
v_mfma_f32_16x16x32_bf16 v[148:151], a[12:15], a[204:207], v[148:151]
s_nop 0
buffer_load_dwordx4 v3, s[12:15], s32 offen offset:3072  lds
v_mfma_f32_16x16x32_bf16 v[180:183], a[8:11], a[208:211], 0
ds_read_b64_tr_b16 a[28:29], v19 offset:40968
v_add_f32_dpp v80, v80, v80 row_ror:2 row_mask:0xf bank_mask:0xf
v_mfma_f32_16x16x32_bf16 v[180:183], a[12:15], a[212:215], v[180:183]
ds_read_b128 a[228:231], v25 offset:0
v_mfma_f32_16x16x32_bf16 v[212:215], a[8:11], a[216:219], 0
s_nop 0
ds_read_b64_tr_b16 a[30:31], v19 offset:41992
v_add_f32_dpp v80, v80, v80 row_ror:1 row_mask:0xf bank_mask:0xf
v_mfma_f32_16x16x32_bf16 v[212:215], a[12:15], a[220:223], v[212:215]
s_mov_b32 s32, 1572864
v_mov_b32 v81, v80
s_waitcnt vmcnt(12)
s_barrier
v_mfma_f32_16x16x32_bf16 v[120:123], a[16:19], a[192:195], 0
s_waitcnt lgkmcnt(3)
s_add_u32 m0, s33, 81920
s_nop 0
ds_read_b64_tr_b16 a[0:1], v16 offset:49152
v_permlane16_swap_b32 v80, v81
v_mfma_f32_16x16x32_bf16 v[120:123], a[20:23], a[196:199], v[120:123]
buffer_load_dwordx4 v3, s[12:15], s32 offen offset:0  lds
v_mfma_f32_16x16x32_bf16 v[152:155], a[16:19], a[200:203], 0
ds_read_b64_tr_b16 a[2:3], v16 offset:50176
v_mfma_f32_16x16x32_bf16 v[152:155], a[20:23], a[204:207], v[152:155]
s_nop 0
ds_read_b128 a[232:235], v24 offset:2048
v_add_f32 v80, v80, v81
v_mfma_f32_16x16x32_bf16 v[184:187], a[16:19], a[208:211], 0
ds_read_b64_tr_b16 a[4:5], v16 offset:57344
buffer_load_dwordx2 v[50:51], v35, s[68:71], 0 offen offset:0
v_mul_f32 v80, s100, v80
v_mfma_f32_16x16x32_bf16 v[184:187], a[20:23], a[212:215], v[184:187]
ds_read_b128 a[236:239], v25 offset:2048
v_sub_f32 v90, v60, v80
v_mfma_f32_16x16x32_bf16 v[216:219], a[16:19], a[216:219], 0
ds_read_b64_tr_b16 a[6:7], v16 offset:58368
buffer_load_dwordx2 v[52:53], v35, s[68:71], 0 offen offset:256
v_sub_f32 v91, v61, v80
v_mfma_f32_16x16x32_bf16 v[216:219], a[20:23], a[220:223], v[216:219]
s_mov_b32 s32, 1604608
ds_read_b128 a[240:243], v24 offset:4096
v_sub_f32 v92, v62, v80
v_mfma_f32_16x16x32_bf16 v[124:127], a[24:27], a[192:195], 0
s_waitcnt lgkmcnt(5)
s_add_u32 m0, s33, 81920
ds_read_b64_tr_b16 a[8:9], v16 offset:49160
buffer_load_dwordx2 v[54:55], v35, s[68:71], 0 offen offset:512
v_sub_f32 v93, v63, v80
v_mfma_f32_16x16x32_bf16 v[124:127], a[28:31], a[196:199], v[124:127]
buffer_load_dwordx4 v3, s[12:15], s32 offen offset:1024  lds
v_mfma_f32_16x16x32_bf16 v[156:159], a[24:27], a[200:203], 0
ds_read_b64_tr_b16 a[10:11], v16 offset:50184
v_mul_f32 v82, v90, v90
v_mfma_f32_16x16x32_bf16 v[156:159], a[28:31], a[204:207], v[156:159]
ds_read_b128 a[244:247], v25 offset:4096
v_mul_f32 v83, v91, v91
v_mfma_f32_16x16x32_bf16 v[188:191], a[24:27], a[208:211], 0
ds_read_b64_tr_b16 a[12:13], v16 offset:57352
buffer_load_dwordx2 v[56:57], v35, s[68:71], 0 offen offset:768
v_mul_f32 v84, v92, v92
v_mfma_f32_16x16x32_bf16 v[188:191], a[28:31], a[212:215], v[188:191]
ds_read_b128 a[248:251], v24 offset:6144
v_mul_f32 v85, v93, v93
v_mfma_f32_16x16x32_bf16 v[220:223], a[24:27], a[216:219], 0
ds_read_b64_tr_b16 a[14:15], v16 offset:58376
buffer_load_dwordx2 v[58:59], v35, s[68:71], 0 offen offset:1024
v_sub_f32 v90, v64, v80
v_mfma_f32_16x16x32_bf16 v[220:223], a[28:31], a[220:223], v[220:223]
ds_read_b128 a[252:255], v25 offset:6144
v_sub_f32 v91, v65, v80
v_mfma_f32_16x16x32_bf16 v[96:99], a[0:3], a[224:227], v[96:99]
s_waitcnt lgkmcnt(5)
s_lshl_b32 s31, s2, 2
ds_read_b64_tr_b16 a[16:17], v17 offset:49152
v_sub_f32 v92, v66, v80
v_mfma_f32_16x16x32_bf16 v[96:99], a[4:7], a[228:231], v[96:99]
s_mov_b32 s62, 384
v_sub_f32 v93, v67, v80
v_fmac_f32 v82, v90, v90
v_mfma_f32_16x16x32_bf16 v[128:131], a[0:3], a[232:235], v[128:131]
s_waitcnt lgkmcnt(1)
s_add_u32 m0, s75, 32768
ds_read_b64_tr_b16 a[18:19], v17 offset:50176
v_fmac_f32 v83, v91, v91
v_mfma_f32_16x16x32_bf16 v[128:131], a[4:7], a[236:239], v[128:131]
buffer_load_dwordx4 v20, s[16:19], s62 offen offset:0  lds
v_mfma_f32_16x16x32_bf16 v[160:163], a[0:3], a[240:243], v[160:163]
s_add_u32 s31, s31, s28
ds_read_b64_tr_b16 a[20:21], v17 offset:57344
v_fmac_f32 v84, v92, v92
v_mfma_f32_16x16x32_bf16 v[160:163], a[4:7], a[244:247], v[160:163]
s_lshl_b32 s31, s31, 8
v_fmac_f32 v85, v93, v93
v_sub_f32 v90, v68, v80
v_mfma_f32_16x16x32_bf16 v[192:195], a[0:3], a[248:251], v[192:195]
s_add_u32 m0, s75, 32768
ds_read_b64_tr_b16 a[22:23], v17 offset:58368
v_sub_f32 v91, v69, v80
v_mfma_f32_16x16x32_bf16 v[192:195], a[4:7], a[252:255], v[192:195]
s_cmp_lt_u32 s31, 77824
s_mov_b32 s47, 4194304
s_cselect_b32 s47, 3276800, s47
buffer_load_dwordx4 v21, s[16:19], s62 offen offset:1024  lds
v_mfma_f32_16x16x32_bf16 v[224:227], a[0:3], v[26:29], v[224:227]
s_add_u32 s47, s47, s31
v_sub_f32 v92, v70, v80
v_sub_f32 v93, v71, v80
v_mfma_f32_16x16x32_bf16 v[224:227], a[4:7], v[26:29], v[224:227]
s_mov_b32 s32, 1636352
v_fmac_f32 v82, v90, v90
v_fmac_f32 v83, v91, v91
v_mfma_f32_16x16x32_bf16 v[100:103], a[8:11], a[224:227], v[100:103]
s_add_u32 m0, s33, 81920
ds_read_b64_tr_b16 a[24:25], v17 offset:49160
v_fmac_f32 v84, v92, v92
v_mfma_f32_16x16x32_bf16 v[100:103], a[12:15], a[228:231], v[100:103]
buffer_load_dwordx4 v3, s[12:15], s32 offen offset:2048  lds
v_mfma_f32_16x16x32_bf16 v[132:135], a[8:11], a[232:235], v[132:135]
s_lshr_b32 s31, s29, 2
ds_read_b64_tr_b16 a[26:27], v17 offset:50184
v_fmac_f32 v85, v93, v93
v_mfma_f32_16x16x32_bf16 v[132:135], a[12:15], a[236:239], v[132:135]
s_mov_b32 s62, 20864
v_sub_f32 v90, v72, v80
v_sub_f32 v91, v73, v80
v_mfma_f32_16x16x32_bf16 v[164:167], a[8:11], a[240:243], v[164:167]
s_add_u32 m0, s75, 34816
ds_read_b64_tr_b16 a[28:29], v17 offset:57352
v_sub_f32 v92, v74, v80
v_mfma_f32_16x16x32_bf16 v[164:167], a[12:15], a[244:247], v[164:167]
s_and_b32 s74, s30, 0x78
buffer_load_dwordx4 v20, s[16:19], s62 offen offset:0  lds
v_mfma_f32_16x16x32_bf16 v[196:199], a[8:11], a[248:251], v[196:199]
s_add_u32 s74, s74, s31
ds_read_b64_tr_b16 a[30:31], v17 offset:58376
v_sub_f32 v93, v75, v80
v_mfma_f32_16x16x32_bf16 v[196:199], a[12:15], a[252:255], v[196:199]
s_mov_b32 s32, 1668096
v_fmac_f32 v82, v90, v90
v_fmac_f32 v83, v91, v91
v_mfma_f32_16x16x32_bf16 v[228:231], a[8:11], v[26:29], v[228:231]
s_add_u32 m0, s33, 81920
v_fmac_f32 v84, v92, v92
v_fmac_f32 v85, v93, v93
v_mfma_f32_16x16x32_bf16 v[228:231], a[12:15], v[26:29], v[228:231]
s_waitcnt lgkmcnt(2)
buffer_load_dwordx4 v3, s[12:15], s32 offen offset:3072  lds
v_mfma_f32_16x16x32_bf16 v[104:107], a[16:19], a[224:227], v[104:107]
s_lshl_b32 s74, s74, 5
ds_read_b64_tr_b16 a[0:1], v18 offset:49152
v_sub_f32 v90, v76, v80
v_mfma_f32_16x16x32_bf16 v[104:107], a[20:23], a[228:231], v[104:107]
s_and_b32 s31, s29, 3
v_sub_f32 v91, v77, v80
v_sub_f32 v92, v78, v80
v_mfma_f32_16x16x32_bf16 v[136:139], a[16:19], a[232:235], v[136:139]
s_add_u32 m0, s75, 34816
ds_read_b64_tr_b16 a[2:3], v18 offset:50176
v_sub_f32 v93, v79, v80
v_mfma_f32_16x16x32_bf16 v[136:139], a[20:23], a[236:239], v[136:139]
s_add_u32 s74, s74, s31
buffer_load_dwordx4 v21, s[16:19], s62 offen offset:1024  lds
v_mfma_f32_16x16x32_bf16 v[168:171], a[16:19], a[240:243], v[168:171]
s_and_b32 s31, s30, 4
ds_read_b64_tr_b16 a[4:5], v18 offset:57344
v_fmac_f32 v82, v90, v90
v_mfma_f32_16x16x32_bf16 v[168:171], a[20:23], a[244:247], v[168:171]
s_mov_b32 s62, 41344
v_fmac_f32 v83, v91, v91
v_fmac_f32 v84, v92, v92
v_mfma_f32_16x16x32_bf16 v[200:203], a[16:19], a[248:251], v[200:203]
s_add_u32 m0, s75, 36864
ds_read_b64_tr_b16 a[6:7], v18 offset:58368
v_fmac_f32 v85, v93, v93
v_mfma_f32_16x16x32_bf16 v[200:203], a[20:23], a[252:255], v[200:203]
buffer_load_dwordx4 v20, s[16:19], s62 offen offset:0  lds
v_mfma_f32_16x16x32_bf16 v[108:111], a[24:27], a[224:227], v[108:111]
s_waitcnt lgkmcnt(2)
s_add_u32 s74, s74, s31
ds_read_b64_tr_b16 a[8:9], v18 offset:49160
v_add_f32 v82, v82, v83
v_mfma_f32_16x16x32_bf16 v[108:111], a[28:31], a[228:231], v[108:111]
s_lshl_b32 s74, s74, 2
v_add_f32 v84, v84, v85
v_add_f32 v82, v82, v84
v_mfma_f32_16x16x32_bf16 v[140:143], a[24:27], a[232:235], v[140:143]
s_add_u32 m0, s75, 36864
ds_read_b64_tr_b16 a[10:11], v18 offset:50184
v_mfma_f32_16x16x32_bf16 v[140:143], a[28:31], a[236:239], v[140:143]
s_nop 0
buffer_load_dwordx4 v21, s[16:19], s62 offen offset:1024  lds
v_mfma_f32_16x16x32_bf16 v[172:175], a[24:27], a[240:243], v[172:175]
s_add_u32 s74, s74, 3317760
ds_read_b64_tr_b16 a[12:13], v18 offset:57352
v_add_f32_dpp v82, v82, v82 row_ror:8 row_mask:0xf bank_mask:0xf
v_mfma_f32_16x16x32_bf16 v[172:175], a[28:31], a[244:247], v[172:175]
s_mov_b32 s62, 61824
v_mfma_f32_16x16x32_bf16 v[204:207], a[24:27], a[248:251], v[204:207]
s_add_u32 m0, s75, 38912
s_nop 0
ds_read_b64_tr_b16 a[14:15], v18 offset:58376
v_add_f32_dpp v82, v82, v82 row_ror:4 row_mask:0xf bank_mask:0xf
v_mfma_f32_16x16x32_bf16 v[204:207], a[28:31], a[252:255], v[204:207]
buffer_load_dwordx4 v20, s[16:19], s62 offen offset:0  lds
v_mfma_f32_16x16x32_bf16 v[112:115], a[0:3], a[224:227], v[112:115]
s_waitcnt lgkmcnt(2)
s_lshl_b32 s31, s29, 19
ds_read_b64_tr_b16 a[16:17], v19 offset:49152
v_mfma_f32_16x16x32_bf16 v[112:115], a[4:7], a[228:231], v[112:115]
s_nop 0
v_add_f32_dpp v82, v82, v82 row_ror:2 row_mask:0xf bank_mask:0xf
v_mfma_f32_16x16x32_bf16 v[144:147], a[0:3], a[232:235], v[144:147]
s_add_u32 m0, s75, 38912
s_nop 0
ds_read_b64_tr_b16 a[18:19], v19 offset:50176
v_add_f32_dpp v82, v82, v82 row_ror:1 row_mask:0xf bank_mask:0xf
v_mfma_f32_16x16x32_bf16 v[144:147], a[4:7], a[236:239], v[144:147]
s_add_u32 s4, s38, s31
s_addc_u32 s5, s39, 0
buffer_load_dwordx4 v21, s[16:19], s62 offen offset:1024  lds
v_mfma_f32_16x16x32_bf16 v[176:179], a[0:3], a[240:243], v[176:179]
s_mov_b32 s6, 0x90000
ds_read_b64_tr_b16 a[20:21], v19 offset:57344
v_mov_b32 v83, v82
v_mfma_f32_16x16x32_bf16 v[176:179], a[4:7], a[244:247], v[176:179]
v_mfma_f32_16x16x32_bf16 v[208:211], a[0:3], a[248:251], v[208:211]
s_nop 0
ds_read_b64_tr_b16 a[22:23], v19 offset:58368
v_permlane16_swap_b32 v82, v83
v_mfma_f32_16x16x32_bf16 v[208:211], a[4:7], a[252:255], v[208:211]
s_waitcnt vmcnt(19)
ds_read_b128 a[192:195], v22 offset:0
v_mfma_f32_16x16x32_bf16 v[116:119], a[8:11], a[224:227], v[116:119]
s_waitcnt lgkmcnt(3)
s_nop 0
ds_read_b64_tr_b16 a[24:25], v19 offset:49160
v_add_f32 v82, v82, v83
v_mfma_f32_16x16x32_bf16 v[116:119], a[12:15], a[228:231], v[116:119]
s_mov_b32 s7, 0x20000
ds_read_b128 a[196:199], v23 offset:0
v_mul_f32 v82, s100, v82
v_mfma_f32_16x16x32_bf16 v[148:151], a[8:11], a[232:235], v[148:151]
s_add_u32 s8, s40, s31
s_addc_u32 s9, s41, 0
ds_read_b64_tr_b16 a[26:27], v19 offset:50184
v_cvt_pk_bf16_f32 v80, v80, v80
v_mfma_f32_16x16x32_bf16 v[148:151], a[12:15], a[236:239], v[148:151]
s_mov_b32 s10, 0x90000
ds_read_b128 a[200:203], v22 offset:2048
v_lshlrev_b32 v80, 16, v80
v_mfma_f32_16x16x32_bf16 v[180:183], a[8:11], a[240:243], v[180:183]
s_mov_b32 s11, 0x20000
ds_read_b64_tr_b16 a[28:29], v19 offset:57352
v_cvt_pk_bf16_f32 v82, v82, v82
v_mfma_f32_16x16x32_bf16 v[180:183], a[12:15], a[244:247], v[180:183]
ds_read_b128 a[204:207], v23 offset:2048
v_lshlrev_b32 v82, 16, v82
v_mfma_f32_16x16x32_bf16 v[212:215], a[8:11], a[248:251], v[212:215]
s_mov_b64 s[38:39], s[4:5]
ds_read_b64_tr_b16 a[30:31], v19 offset:58376
v_add_f32 v82, 0x3727c5ac, v82
v_mfma_f32_16x16x32_bf16 v[212:215], a[12:15], a[252:255], v[212:215]
s_mov_b32 s32, 2097152
v_cvt_pk_bf16_f32 v82, v82, v82
v_lshlrev_b32 v82, 16, v82
s_waitcnt vmcnt(17)
s_barrier
v_mfma_f32_16x16x32_bf16 v[120:123], a[16:19], a[224:227], v[120:123]
s_waitcnt lgkmcnt(4)
s_add_u32 m0, s33, 98304
ds_read_b64_tr_b16 a[0:1], v16 offset:0
v_mfma_f32_16x16x32_bf16 v[120:123], a[20:23], a[228:231], v[120:123]
s_mov_b64 s[40:41], s[8:9]
buffer_load_dwordx4 v3, s[12:15], s32 offen offset:0  lds
v_mfma_f32_16x16x32_bf16 v[152:155], a[16:19], a[232:235], v[152:155]
s_mov_b64 s[42:43], s[4:5]
ds_read_b64_tr_b16 a[2:3], v16 offset:1024
v_mfma_f32_16x16x32_bf16 v[152:155], a[20:23], a[236:239], v[152:155]
s_mov_b64 s[36:37], s[8:9]
ds_read_b128 a[208:211], v22 offset:4096
v_mfma_f32_16x16x32_bf16 v[184:187], a[16:19], a[240:243], v[184:187]
s_movk_i32 s48, 4096
ds_read_b64_tr_b16 a[4:5], v16 offset:8192
v_mfma_f32_16x16x32_bf16 v[184:187], a[20:23], a[244:247], v[184:187]
ds_read_b128 a[212:215], v23 offset:4096
v_mfma_f32_16x16x32_bf16 v[216:219], a[16:19], a[248:251], v[216:219]
s_lshl_b32 s31, s30, 10
ds_read_b64_tr_b16 a[6:7], v16 offset:9216
v_mfma_f32_16x16x32_bf16 v[216:219], a[20:23], a[252:255], v[216:219]
s_mov_b32 s32, 2128896
ds_read_b128 a[216:219], v22 offset:6144
v_mfma_f32_16x16x32_bf16 v[124:127], a[24:27], a[224:227], v[124:127]
s_waitcnt lgkmcnt(5)
s_add_u32 m0, s33, 98304
ds_read_b64_tr_b16 a[8:9], v16 offset:8
v_mfma_f32_16x16x32_bf16 v[124:127], a[28:31], a[228:231], v[124:127]
s_lshl_b32 s3, s29, 19
buffer_load_dwordx4 v3, s[12:15], s32 offen offset:1024  lds
v_mfma_f32_16x16x32_bf16 v[156:159], a[24:27], a[232:235], v[156:159]
s_add_u32 s31, s31, s3
ds_read_b64_tr_b16 a[10:11], v16 offset:1032
v_mfma_f32_16x16x32_bf16 v[156:159], a[28:31], a[236:239], v[156:159]
s_add_u32 s31, s31, 4194304
ds_read_b128 a[220:223], v23 offset:6144
v_mfma_f32_16x16x32_bf16 v[188:191], a[24:27], a[240:243], v[188:191]
s_add_u32 s20, s60, s31
s_addc_u32 s21, s61, 0
ds_read_b64_tr_b16 a[12:13], v16 offset:8200
v_mfma_f32_16x16x32_bf16 v[188:191], a[28:31], a[244:247], v[188:191]
v_sqrt_f32 v82, v82
v_mfma_f32_16x16x32_bf16 v[220:223], a[24:27], a[248:251], v[220:223]
s_mov_b32 s22, 397312
ds_read_b64_tr_b16 a[14:15], v16 offset:9224
v_mfma_f32_16x16x32_bf16 v[220:223], a[28:31], a[252:255], v[220:223]
s_nop 0
v_cvt_pk_bf16_f32 v82, v82, v82
v_lshlrev_b32 v82, 16, v82
v_mfma_f32_16x16x32_bf16 v[96:99], a[0:3], a[192:195], v[96:99]
s_waitcnt lgkmcnt(3)
s_mov_b32 s23, 0x20000
ds_read_b64_tr_b16 a[16:17], v17 offset:0
v_mfma_f32_16x16x32_bf16 v[96:99], a[4:7], a[196:199], v[96:99]
s_mov_b32 s62, 512
v_rcp_f32 v82, v82
v_mfma_f32_16x16x32_bf16 v[128:131], a[0:3], a[200:203], v[128:131]
s_waitcnt lgkmcnt(2)
s_add_u32 m0, s75, 131072
ds_read_b64_tr_b16 a[18:19], v17 offset:1024
v_lshlrev_b32 v36, 4, v32
v_mfma_f32_16x16x32_bf16 v[128:131], a[4:7], a[204:207], v[128:131]
buffer_load_dwordx4 v20, s[16:19], s62 offen offset:0  lds
v_mfma_f32_16x16x32_bf16 v[160:163], a[0:3], a[208:211], v[160:163]
ds_read_b64_tr_b16 a[20:21], v17 offset:8192
v_add_u32 v36, 3162112, v36
v_mfma_f32_16x16x32_bf16 v[160:163], a[4:7], a[212:215], v[160:163]
v_mul_f32 v88, 1040356334, v82
v_mul_f32 v89, v80, v88
v_mfma_f32_16x16x32_bf16 v[192:195], a[0:3], a[216:219], v[192:195]
s_add_u32 m0, s75, 131072
ds_read_b64_tr_b16 a[22:23], v17 offset:9216
v_sub_f32 v89, 0, v89
v_mfma_f32_16x16x32_bf16 v[192:195], a[4:7], a[220:223], v[192:195]
buffer_load_dwordx4 v21, s[16:19], s62 offen offset:1024  lds
v_mfma_f32_16x16x32_bf16 v[224:227], a[0:3], v[26:29], v[224:227]
v_lshlrev_b32 v30, 4, v0
v_mov_b32 v31, 0
v_mfma_f32_16x16x32_bf16 v[224:227], a[4:7], v[26:29], v[224:227]
s_mov_b32 s32, 2160640
v_mov_b32 v94, 0
v_lshl_or_b32 v243, s28, 2, v242
v_mfma_f32_16x16x32_bf16 v[100:103], a[8:11], a[192:195], v[100:103]
s_waitcnt lgkmcnt(1)
s_add_u32 m0, s33, 98304
ds_read_b64_tr_b16 a[24:25], v17 offset:8
v_xor_b32 v243, v243, v241
v_mfma_f32_16x16x32_bf16 v[100:103], a[12:15], a[196:199], v[100:103]
buffer_load_dwordx4 v3, s[12:15], s32 offen offset:2048  lds
v_mfma_f32_16x16x32_bf16 v[132:135], a[8:11], a[200:203], v[132:135]
ds_read_b64_tr_b16 a[26:27], v17 offset:1032
v_lshlrev_b32 v243, 4, v243
v_mfma_f32_16x16x32_bf16 v[132:135], a[12:15], a[204:207], v[132:135]
s_mov_b32 s62, 20992
v_lshl_add_u32 v1, v244, 8, v243
v_lshl_or_b32 v243, s28, 2, v242
v_mfma_f32_16x16x32_bf16 v[164:167], a[8:11], a[208:211], v[164:167]
s_add_u32 m0, s75, 133120
ds_read_b64_tr_b16 a[28:29], v17 offset:8200
v_and_b32 v243, 7, v243
v_mfma_f32_16x16x32_bf16 v[164:167], a[12:15], a[212:215], v[164:167]
buffer_load_dwordx4 v20, s[16:19], s62 offen offset:0  lds
v_mfma_f32_16x16x32_bf16 v[196:199], a[8:11], a[216:219], v[196:199]
ds_read_b64_tr_b16 a[30:31], v17 offset:9224
v_lshlrev_b32 v243, 1, v243
v_mfma_f32_16x16x32_bf16 v[196:199], a[12:15], a[220:223], v[196:199]
s_mov_b32 s32, 2192384
v_xor_b32 v243, v243, v241
v_lshlrev_b32 v243, 4, v243
v_mfma_f32_16x16x32_bf16 v[228:231], a[8:11], v[26:29], v[228:231]
s_add_u32 m0, s33, 98304
v_lshl_add_u32 v2, v244, 8, v243
v_lshlrev_b32 v244, 8, v245
v_mfma_f32_16x16x32_bf16 v[228:231], a[12:15], v[26:29], v[228:231]
buffer_load_dwordx4 v3, s[12:15], s32 offen offset:3072  lds
v_mfma_f32_16x16x32_bf16 v[104:107], a[16:19], a[192:195], v[104:107]
s_waitcnt lgkmcnt(1)
ds_read_b64_tr_b16 a[0:1], v18 offset:0
v_lshl_add_u32 v244, v246, 12, v244
v_mfma_f32_16x16x32_bf16 v[104:107], a[20:23], a[196:199], v[104:107]
v_or_b32 v243, s76, v242
v_xor_b32 v243, v243, v241
v_mfma_f32_16x16x32_bf16 v[136:139], a[16:19], a[200:203], v[136:139]
s_add_u32 m0, s75, 133120
ds_read_b64_tr_b16 a[2:3], v18 offset:1024
v_lshl_add_u32 v4, v243, 4, v244
v_mfma_f32_16x16x32_bf16 v[136:139], a[20:23], a[204:207], v[136:139]
buffer_load_dwordx4 v21, s[16:19], s62 offen offset:1024  lds
v_mfma_f32_16x16x32_bf16 v[168:171], a[16:19], a[208:211], v[168:171]
ds_read_b64_tr_b16 a[4:5], v18 offset:8192
v_or_b32 v243, s77, v242
v_mfma_f32_16x16x32_bf16 v[168:171], a[20:23], a[212:215], v[168:171]
s_mov_b32 s62, 41472
v_xor_b32 v243, v243, v241
v_lshl_add_u32 v5, v243, 4, v244
v_mfma_f32_16x16x32_bf16 v[200:203], a[16:19], a[216:219], v[200:203]
s_add_u32 m0, s75, 135168
ds_read_b64_tr_b16 a[6:7], v18 offset:9216
v_or_b32 v243, s78, v242
v_mfma_f32_16x16x32_bf16 v[200:203], a[20:23], a[220:223], v[200:203]
buffer_load_dwordx4 v20, s[16:19], s62 offen offset:0  lds
v_mfma_f32_16x16x32_bf16 v[108:111], a[24:27], a[192:195], v[108:111]
s_waitcnt lgkmcnt(2)
ds_read_b64_tr_b16 a[8:9], v18 offset:8
v_xor_b32 v243, v243, v241
v_mfma_f32_16x16x32_bf16 v[108:111], a[28:31], a[196:199], v[108:111]
v_lshl_add_u32 v6, v243, 4, v244
v_or_b32 v243, s79, v242
v_mfma_f32_16x16x32_bf16 v[140:143], a[24:27], a[200:203], v[140:143]
s_add_u32 m0, s75, 135168
ds_read_b64_tr_b16 a[10:11], v18 offset:1032
v_xor_b32 v243, v243, v241
v_mfma_f32_16x16x32_bf16 v[140:143], a[28:31], a[204:207], v[140:143]
buffer_load_dwordx4 v21, s[16:19], s62 offen offset:1024  lds
v_mfma_f32_16x16x32_bf16 v[172:175], a[24:27], a[208:211], v[172:175]
ds_read_b64_tr_b16 a[12:13], v18 offset:8200
v_lshl_add_u32 v7, v243, 4, v244
v_mfma_f32_16x16x32_bf16 v[172:175], a[28:31], a[212:215], v[172:175]
s_mov_b32 s62, 61952
v_lshl_add_u32 v244, v242, 4, v246
v_lshlrev_b32 v244, 8, v244
v_mfma_f32_16x16x32_bf16 v[204:207], a[24:27], a[216:219], v[204:207]
s_add_u32 m0, s75, 137216
ds_read_b64_tr_b16 a[14:15], v18 offset:9224
v_lshl_add_u32 v244, v245, 3, v244
v_mfma_f32_16x16x32_bf16 v[204:207], a[28:31], a[220:223], v[204:207]
buffer_load_dwordx4 v20, s[16:19], s62 offen offset:0  lds
v_mfma_f32_16x16x32_bf16 v[112:115], a[0:3], a[192:195], v[112:115]
s_waitcnt lgkmcnt(2)
ds_read_b64_tr_b16 a[16:17], v19 offset:0
v_add_u32 v244, 65536, v244
v_mfma_f32_16x16x32_bf16 v[112:115], a[4:7], a[196:199], v[112:115]
v_and_b32 v247, 1, v242
v_lshl_or_b32 v247, v247, 2, v246
v_mfma_f32_16x16x32_bf16 v[144:147], a[0:3], a[200:203], v[144:147]
s_add_u32 m0, s75, 137216
ds_read_b64_tr_b16 a[18:19], v19 offset:1024
v_xor_b32 v243, 0, v247
v_mfma_f32_16x16x32_bf16 v[144:147], a[4:7], a[204:207], v[144:147]
buffer_load_dwordx4 v21, s[16:19], s62 offen offset:1024  lds
v_mfma_f32_16x16x32_bf16 v[176:179], a[0:3], a[208:211], v[176:179]
ds_read_b64_tr_b16 a[20:21], v19 offset:8192
v_lshl_add_u32 v8, v243, 5, v244
v_mfma_f32_16x16x32_bf16 v[176:179], a[4:7], a[212:215], v[176:179]
v_xor_b32 v243, 1, v247
v_lshl_add_u32 v9, v243, 5, v244
v_mfma_f32_16x16x32_bf16 v[208:211], a[0:3], a[216:219], v[208:211]
ds_read_b64_tr_b16 a[22:23], v19 offset:9216
v_xor_b32 v243, 2, v247
v_mfma_f32_16x16x32_bf16 v[208:211], a[4:7], a[220:223], v[208:211]
s_waitcnt vmcnt(12)
ds_read_b128 a[224:227], v24 offset:0
v_lshl_add_u32 v10, v243, 5, v244
v_mfma_f32_16x16x32_bf16 v[116:119], a[8:11], a[192:195], v[116:119]
s_waitcnt lgkmcnt(3)
ds_read_b64_tr_b16 a[24:25], v19 offset:8
v_xor_b32 v243, 3, v247
v_mfma_f32_16x16x32_bf16 v[116:119], a[12:15], a[196:199], v[116:119]
ds_read_b128 a[228:231], v25 offset:0
v_lshl_add_u32 v11, v243, 5, v244
v_mfma_f32_16x16x32_bf16 v[148:151], a[8:11], a[200:203], v[148:151]
ds_read_b64_tr_b16 a[26:27], v19 offset:1032
v_xor_b32 v243, 4, v247
v_mfma_f32_16x16x32_bf16 v[148:151], a[12:15], a[204:207], v[148:151]
ds_read_b128 a[232:235], v24 offset:2048
v_lshl_add_u32 v12, v243, 5, v244
v_mfma_f32_16x16x32_bf16 v[180:183], a[8:11], a[208:211], v[180:183]
ds_read_b64_tr_b16 a[28:29], v19 offset:8200
v_xor_b32 v243, 5, v247
v_mfma_f32_16x16x32_bf16 v[180:183], a[12:15], a[212:215], v[180:183]
ds_read_b128 a[236:239], v25 offset:2048
v_lshl_add_u32 v13, v243, 5, v244
v_mfma_f32_16x16x32_bf16 v[212:215], a[8:11], a[216:219], v[212:215]
ds_read_b64_tr_b16 a[30:31], v19 offset:9224
v_xor_b32 v243, 6, v247
v_mfma_f32_16x16x32_bf16 v[212:215], a[12:15], a[220:223], v[212:215]
s_mov_b32 s32, 2621440
v_lshl_add_u32 v14, v243, 5, v244
v_xor_b32 v243, 7, v247
s_barrier
v_mfma_f32_16x16x32_bf16 v[120:123], a[16:19], a[192:195], v[120:123]
s_waitcnt lgkmcnt(4)
s_add_u32 m0, s33, 114688
ds_read_b64_tr_b16 a[0:1], v16 offset:16384
buffer_store_dwordx2 v[88:89], v36, s[24:27], 0 offen sc1
v_mfma_f32_16x16x32_bf16 v[120:123], a[20:23], a[196:199], v[120:123]
buffer_load_dwordx4 v3, s[12:15], s32 offen offset:0  lds
v_mfma_f32_16x16x32_bf16 v[152:155], a[16:19], a[200:203], v[152:155]
ds_read_b64_tr_b16 a[2:3], v16 offset:17408
v_lshl_add_u32 v15, v243, 5, v244
v_mfma_f32_16x16x32_bf16 v[152:155], a[20:23], a[204:207], v[152:155]
ds_read_b128 a[240:243], v24 offset:4096
v_sub_f32 v60, v60, v80
v_mfma_f32_16x16x32_bf16 v[184:187], a[16:19], a[208:211], v[184:187]
ds_read_b64_tr_b16 a[4:5], v16 offset:24576
v_sub_f32 v61, v61, v80
v_mfma_f32_16x16x32_bf16 v[184:187], a[20:23], a[212:215], v[184:187]
ds_read_b128 a[244:247], v25 offset:4096
v_sub_f32 v62, v62, v80
v_mfma_f32_16x16x32_bf16 v[216:219], a[16:19], a[216:219], v[216:219]
ds_read_b64_tr_b16 a[6:7], v16 offset:25600
v_sub_f32 v63, v63, v80
v_mfma_f32_16x16x32_bf16 v[216:219], a[20:23], a[220:223], v[216:219]
s_mov_b32 s32, 2653184
ds_read_b128 a[248:251], v24 offset:6144
v_sub_f32 v64, v64, v80
v_mfma_f32_16x16x32_bf16 v[124:127], a[24:27], a[192:195], v[124:127]
s_waitcnt lgkmcnt(5)
s_add_u32 m0, s33, 114688
ds_read_b64_tr_b16 a[8:9], v16 offset:16392
v_sub_f32 v65, v65, v80
v_mfma_f32_16x16x32_bf16 v[124:127], a[28:31], a[196:199], v[124:127]
buffer_load_dwordx4 v3, s[12:15], s32 offen offset:1024  lds
v_mfma_f32_16x16x32_bf16 v[156:159], a[24:27], a[200:203], v[156:159]
ds_read_b64_tr_b16 a[10:11], v16 offset:17416
v_sub_f32 v66, v66, v80
v_mfma_f32_16x16x32_bf16 v[156:159], a[28:31], a[204:207], v[156:159]
ds_read_b128 a[252:255], v25 offset:6144
v_sub_f32 v67, v67, v80
v_mfma_f32_16x16x32_bf16 v[188:191], a[24:27], a[208:211], v[188:191]
ds_read_b64_tr_b16 a[12:13], v16 offset:24584
v_sub_f32 v68, v68, v80
v_mfma_f32_16x16x32_bf16 v[188:191], a[28:31], a[212:215], v[188:191]
v_sub_f32 v69, v69, v80
v_sub_f32 v70, v70, v80
v_mfma_f32_16x16x32_bf16 v[220:223], a[24:27], a[216:219], v[220:223]
ds_read_b64_tr_b16 a[14:15], v16 offset:25608
v_sub_f32 v71, v71, v80
v_mfma_f32_16x16x32_bf16 v[220:223], a[28:31], a[220:223], v[220:223]
v_sub_f32 v72, v72, v80
v_sub_f32 v73, v73, v80
v_mfma_f32_16x16x32_bf16 v[96:99], a[0:3], a[224:227], v[96:99]
s_waitcnt lgkmcnt(3)
ds_read_b64_tr_b16 a[16:17], v17 offset:16384
v_sub_f32 v74, v74, v80
v_mfma_f32_16x16x32_bf16 v[96:99], a[4:7], a[228:231], v[96:99]
s_mov_b32 s62, 640
v_sub_f32 v75, v75, v80
v_sub_f32 v76, v76, v80
v_mfma_f32_16x16x32_bf16 v[128:131], a[0:3], a[232:235], v[128:131]
s_waitcnt lgkmcnt(2)
s_add_u32 m0, s75, 32768
ds_read_b64_tr_b16 a[18:19], v17 offset:17408
v_sub_f32 v77, v77, v80
v_mfma_f32_16x16x32_bf16 v[128:131], a[4:7], a[236:239], v[128:131]
buffer_load_dwordx4 v20, s[16:19], s62 offen offset:0  lds
v_mfma_f32_16x16x32_bf16 v[160:163], a[0:3], a[240:243], v[160:163]
ds_read_b64_tr_b16 a[20:21], v17 offset:24576
v_sub_f32 v78, v78, v80
v_mfma_f32_16x16x32_bf16 v[160:163], a[4:7], a[244:247], v[160:163]
v_sub_f32 v79, v79, v80
v_cvt_pk_bf16_f32 v40, v60, v61
v_mfma_f32_16x16x32_bf16 v[192:195], a[0:3], a[248:251], v[192:195]
s_add_u32 m0, s75, 32768
ds_read_b64_tr_b16 a[22:23], v17 offset:25600
v_cvt_pk_bf16_f32 v41, v62, v63
v_mfma_f32_16x16x32_bf16 v[192:195], a[4:7], a[252:255], v[192:195]
buffer_load_dwordx4 v21, s[16:19], s62 offen offset:1024  lds
v_mfma_f32_16x16x32_bf16 v[224:227], a[0:3], v[26:29], v[224:227]
v_cvt_pk_bf16_f32 v42, v64, v65
v_cvt_pk_bf16_f32 v43, v66, v67
v_mfma_f32_16x16x32_bf16 v[224:227], a[4:7], v[26:29], v[224:227]
s_mov_b32 s32, 2684928
v_cvt_pk_bf16_f32 v44, v68, v69
v_cvt_pk_bf16_f32 v45, v70, v71
v_mfma_f32_16x16x32_bf16 v[100:103], a[8:11], a[224:227], v[100:103]
s_waitcnt lgkmcnt(1)
s_add_u32 m0, s33, 114688
ds_read_b64_tr_b16 a[24:25], v17 offset:16392
v_cvt_pk_bf16_f32 v46, v72, v73
v_mfma_f32_16x16x32_bf16 v[100:103], a[12:15], a[228:231], v[100:103]
buffer_load_dwordx4 v3, s[12:15], s32 offen offset:2048  lds
v_mfma_f32_16x16x32_bf16 v[132:135], a[8:11], a[232:235], v[132:135]
ds_read_b64_tr_b16 a[26:27], v17 offset:17416
v_cvt_pk_bf16_f32 v47, v74, v75
v_mfma_f32_16x16x32_bf16 v[132:135], a[12:15], a[236:239], v[132:135]
s_mov_b32 s62, 21120
v_cvt_pk_bf16_f32 v48, v76, v77
v_cvt_pk_bf16_f32 v49, v78, v79
v_mfma_f32_16x16x32_bf16 v[164:167], a[8:11], a[240:243], v[164:167]
s_add_u32 m0, s75, 34816
ds_read_b64_tr_b16 a[28:29], v17 offset:24584
v_lshlrev_b32 v60, 16, v40
v_mfma_f32_16x16x32_bf16 v[164:167], a[12:15], a[244:247], v[164:167]
buffer_load_dwordx4 v20, s[16:19], s62 offen offset:0  lds
v_mfma_f32_16x16x32_bf16 v[196:199], a[8:11], a[248:251], v[196:199]
ds_read_b64_tr_b16 a[30:31], v17 offset:25608
v_and_b32 v61, s101, v40
v_mfma_f32_16x16x32_bf16 v[196:199], a[12:15], a[252:255], v[196:199]
s_mov_b32 s32, 2716672
v_lshlrev_b32 v62, 16, v41
v_and_b32 v63, s101, v41
v_mfma_f32_16x16x32_bf16 v[228:231], a[8:11], v[26:29], v[228:231]
s_add_u32 m0, s33, 114688
v_lshlrev_b32 v64, 16, v42
v_and_b32 v65, s101, v42
v_mfma_f32_16x16x32_bf16 v[228:231], a[12:15], v[26:29], v[228:231]
buffer_load_dwordx4 v3, s[12:15], s32 offen offset:3072  lds
v_mfma_f32_16x16x32_bf16 v[104:107], a[16:19], a[224:227], v[104:107]
s_waitcnt lgkmcnt(1)
ds_read_b64_tr_b16 a[0:1], v18 offset:16384
v_lshlrev_b32 v66, 16, v43
v_mfma_f32_16x16x32_bf16 v[104:107], a[20:23], a[228:231], v[104:107]
v_and_b32 v67, s101, v43
v_lshlrev_b32 v68, 16, v44
v_mfma_f32_16x16x32_bf16 v[136:139], a[16:19], a[232:235], v[136:139]
s_add_u32 m0, s75, 34816
ds_read_b64_tr_b16 a[2:3], v18 offset:17408
v_and_b32 v69, s101, v44
v_mfma_f32_16x16x32_bf16 v[136:139], a[20:23], a[236:239], v[136:139]
buffer_load_dwordx4 v21, s[16:19], s62 offen offset:1024  lds
v_mfma_f32_16x16x32_bf16 v[168:171], a[16:19], a[240:243], v[168:171]
ds_read_b64_tr_b16 a[4:5], v18 offset:24576
v_lshlrev_b32 v70, 16, v45
v_mfma_f32_16x16x32_bf16 v[168:171], a[20:23], a[244:247], v[168:171]
s_mov_b32 s62, 41600
v_and_b32 v71, s101, v45
v_lshlrev_b32 v72, 16, v46
v_mfma_f32_16x16x32_bf16 v[200:203], a[16:19], a[248:251], v[200:203]
s_add_u32 m0, s75, 36864
ds_read_b64_tr_b16 a[6:7], v18 offset:25600
v_and_b32 v73, s101, v46
v_mfma_f32_16x16x32_bf16 v[200:203], a[20:23], a[252:255], v[200:203]
buffer_load_dwordx4 v20, s[16:19], s62 offen offset:0  lds
v_mfma_f32_16x16x32_bf16 v[108:111], a[24:27], a[224:227], v[108:111]
s_waitcnt lgkmcnt(2)
ds_read_b64_tr_b16 a[8:9], v18 offset:16392
v_lshlrev_b32 v74, 16, v47
v_mfma_f32_16x16x32_bf16 v[108:111], a[28:31], a[228:231], v[108:111]
v_and_b32 v75, s101, v47
v_lshlrev_b32 v76, 16, v48
v_mfma_f32_16x16x32_bf16 v[140:143], a[24:27], a[232:235], v[140:143]
s_add_u32 m0, s75, 36864
ds_read_b64_tr_b16 a[10:11], v18 offset:17416
v_and_b32 v77, s101, v48
v_mfma_f32_16x16x32_bf16 v[140:143], a[28:31], a[236:239], v[140:143]
buffer_load_dwordx4 v21, s[16:19], s62 offen offset:1024  lds
v_mfma_f32_16x16x32_bf16 v[172:175], a[24:27], a[240:243], v[172:175]
ds_read_b64_tr_b16 a[12:13], v18 offset:24584
v_lshlrev_b32 v78, 16, v49
v_mfma_f32_16x16x32_bf16 v[172:175], a[28:31], a[244:247], v[172:175]
s_mov_b32 s62, 62080
v_and_b32 v79, s101, v49
v_mul_f32 v60, v60, v82
v_mfma_f32_16x16x32_bf16 v[204:207], a[24:27], a[248:251], v[204:207]
s_add_u32 m0, s75, 38912
ds_read_b64_tr_b16 a[14:15], v18 offset:25608
v_mul_f32 v61, v61, v82
v_mfma_f32_16x16x32_bf16 v[204:207], a[28:31], a[252:255], v[204:207]
buffer_load_dwordx4 v20, s[16:19], s62 offen offset:0  lds
v_mfma_f32_16x16x32_bf16 v[112:115], a[0:3], a[224:227], v[112:115]
s_waitcnt lgkmcnt(2)
ds_read_b64_tr_b16 a[16:17], v19 offset:16384
v_mul_f32 v62, v62, v82
v_mfma_f32_16x16x32_bf16 v[112:115], a[4:7], a[228:231], v[112:115]
v_mul_f32 v63, v63, v82
v_mul_f32 v64, v64, v82
v_mfma_f32_16x16x32_bf16 v[144:147], a[0:3], a[232:235], v[144:147]
s_add_u32 m0, s75, 38912
ds_read_b64_tr_b16 a[18:19], v19 offset:17408
v_mul_f32 v65, v65, v82
v_mfma_f32_16x16x32_bf16 v[144:147], a[4:7], a[236:239], v[144:147]
buffer_load_dwordx4 v21, s[16:19], s62 offen offset:1024  lds
v_mfma_f32_16x16x32_bf16 v[176:179], a[0:3], a[240:243], v[176:179]
ds_read_b64_tr_b16 a[20:21], v19 offset:24576
v_mul_f32 v66, v66, v82
v_mfma_f32_16x16x32_bf16 v[176:179], a[4:7], a[244:247], v[176:179]
v_mul_f32 v67, v67, v82
v_mul_f32 v68, v68, v82
v_mfma_f32_16x16x32_bf16 v[208:211], a[0:3], a[248:251], v[208:211]
ds_read_b64_tr_b16 a[22:23], v19 offset:25600
v_mul_f32 v69, v69, v82
v_mfma_f32_16x16x32_bf16 v[208:211], a[4:7], a[252:255], v[208:211]
s_waitcnt vmcnt(13)
ds_read_b128 a[192:195], v22 offset:0
v_mul_f32 v70, v70, v82
v_mfma_f32_16x16x32_bf16 v[116:119], a[8:11], a[224:227], v[116:119]
s_waitcnt lgkmcnt(3)
ds_read_b64_tr_b16 a[24:25], v19 offset:16392
v_mul_f32 v71, v71, v82
v_mfma_f32_16x16x32_bf16 v[116:119], a[12:15], a[228:231], v[116:119]
ds_read_b128 a[196:199], v23 offset:0
v_mul_f32 v72, v72, v82
v_mfma_f32_16x16x32_bf16 v[148:151], a[8:11], a[232:235], v[148:151]
ds_read_b64_tr_b16 a[26:27], v19 offset:17416
v_mul_f32 v73, v73, v82
v_mfma_f32_16x16x32_bf16 v[148:151], a[12:15], a[236:239], v[148:151]
ds_read_b128 a[200:203], v22 offset:2048
v_mul_f32 v74, v74, v82
v_mfma_f32_16x16x32_bf16 v[180:183], a[8:11], a[240:243], v[180:183]
ds_read_b64_tr_b16 a[28:29], v19 offset:24584
v_mul_f32 v75, v75, v82
v_mfma_f32_16x16x32_bf16 v[180:183], a[12:15], a[244:247], v[180:183]
ds_read_b128 a[204:207], v23 offset:2048
v_mul_f32 v76, v76, v82
v_mfma_f32_16x16x32_bf16 v[212:215], a[8:11], a[248:251], v[212:215]
ds_read_b64_tr_b16 a[30:31], v19 offset:25608
v_mul_f32 v77, v77, v82
v_mfma_f32_16x16x32_bf16 v[212:215], a[12:15], a[252:255], v[212:215]
s_mov_b32 s32, 3145728
v_mul_f32 v78, v78, v82
v_mul_f32 v79, v79, v82
s_waitcnt vmcnt(12)
s_barrier
s_lshr_b32 s72, s63, 2
s_mul_i32 s72, s72, 112
s_lshl_b32 s73, s63, 2
s_add_u32 s72, s72, s73
v_mov_b32 v253, s72
s_cmp_lg_u32 s28, 0
s_cbranch_scc1 ASIGW
s_mov_b32 s73, 1
s_atomic_add s73, s[58:59], s72
ASIGW:
v_mfma_f32_16x16x32_bf16 v[120:123], a[16:19], a[224:227], v[120:123]
s_waitcnt lgkmcnt(4)
s_add_u32 m0, s33, 65536
ds_read_b64_tr_b16 a[0:1], v16 offset:32768
v_cvt_pk_bf16_f32 v40, v60, v61
v_mfma_f32_16x16x32_bf16 v[120:123], a[20:23], a[228:231], v[120:123]
buffer_load_dwordx4 v3, s[12:15], s32 offen offset:0  lds
v_mfma_f32_16x16x32_bf16 v[152:155], a[16:19], a[232:235], v[152:155]
ds_read_b64_tr_b16 a[2:3], v16 offset:33792
v_cvt_pk_bf16_f32 v41, v62, v63
v_mfma_f32_16x16x32_bf16 v[152:155], a[20:23], a[236:239], v[152:155]
ds_read_b128 a[208:211], v22 offset:4096
v_cvt_pk_bf16_f32 v42, v64, v65
v_mfma_f32_16x16x32_bf16 v[184:187], a[16:19], a[240:243], v[184:187]
ds_read_b64_tr_b16 a[4:5], v16 offset:40960
v_cvt_pk_bf16_f32 v43, v66, v67
v_mfma_f32_16x16x32_bf16 v[184:187], a[20:23], a[244:247], v[184:187]
ds_read_b128 a[212:215], v23 offset:4096
v_cvt_pk_bf16_f32 v44, v68, v69
v_mfma_f32_16x16x32_bf16 v[216:219], a[16:19], a[248:251], v[216:219]
ds_read_b64_tr_b16 a[6:7], v16 offset:41984
v_cvt_pk_bf16_f32 v45, v70, v71
v_mfma_f32_16x16x32_bf16 v[216:219], a[20:23], a[252:255], v[216:219]
s_mov_b32 s32, 3177472
ds_read_b128 a[216:219], v22 offset:6144
v_cvt_pk_bf16_f32 v46, v72, v73
v_mfma_f32_16x16x32_bf16 v[124:127], a[24:27], a[224:227], v[124:127]
s_waitcnt lgkmcnt(5)
s_add_u32 m0, s33, 65536
ds_read_b64_tr_b16 a[8:9], v16 offset:32776
v_cvt_pk_bf16_f32 v47, v74, v75
v_mfma_f32_16x16x32_bf16 v[124:127], a[28:31], a[228:231], v[124:127]
buffer_load_dwordx4 v3, s[12:15], s32 offen offset:1024  lds
v_mfma_f32_16x16x32_bf16 v[156:159], a[24:27], a[232:235], v[156:159]
ds_read_b64_tr_b16 a[10:11], v16 offset:33800
v_cvt_pk_bf16_f32 v48, v76, v77
v_mfma_f32_16x16x32_bf16 v[156:159], a[28:31], a[236:239], v[156:159]
ds_read_b128 a[220:223], v23 offset:6144
v_cvt_pk_bf16_f32 v49, v78, v79
v_mfma_f32_16x16x32_bf16 v[188:191], a[24:27], a[240:243], v[188:191]
ds_read_b64_tr_b16 a[12:13], v16 offset:40968
v_lshlrev_b32 v60, 16, v40
v_mfma_f32_16x16x32_bf16 v[188:191], a[28:31], a[244:247], v[188:191]
v_and_b32 v61, s101, v40
v_lshlrev_b32 v62, 16, v41
v_mfma_f32_16x16x32_bf16 v[220:223], a[24:27], a[248:251], v[220:223]
ds_read_b64_tr_b16 a[14:15], v16 offset:41992
v_and_b32 v63, s101, v41
v_mfma_f32_16x16x32_bf16 v[220:223], a[28:31], a[252:255], v[220:223]
v_lshlrev_b32 v64, 16, v42
v_and_b32 v65, s101, v42
v_mfma_f32_16x16x32_bf16 v[96:99], a[0:3], a[192:195], v[96:99]
s_waitcnt lgkmcnt(3)
ds_read_b64_tr_b16 a[16:17], v17 offset:32768
v_lshlrev_b32 v66, 16, v43
v_mfma_f32_16x16x32_bf16 v[96:99], a[4:7], a[196:199], v[96:99]
s_mov_b32 s62, 768
v_and_b32 v67, s101, v43
v_lshlrev_b32 v68, 16, v44
v_mfma_f32_16x16x32_bf16 v[128:131], a[0:3], a[200:203], v[128:131]
s_waitcnt lgkmcnt(2)
s_add_u32 m0, s75, 131072
ds_read_b64_tr_b16 a[18:19], v17 offset:33792
v_and_b32 v69, s101, v44
v_mfma_f32_16x16x32_bf16 v[128:131], a[4:7], a[204:207], v[128:131]
buffer_load_dwordx4 v20, s[16:19], s62 offen offset:0  lds
v_mfma_f32_16x16x32_bf16 v[160:163], a[0:3], a[208:211], v[160:163]
ds_read_b64_tr_b16 a[20:21], v17 offset:40960
v_lshlrev_b32 v70, 16, v45
v_mfma_f32_16x16x32_bf16 v[160:163], a[4:7], a[212:215], v[160:163]
v_and_b32 v71, s101, v45
v_lshlrev_b32 v72, 16, v46
v_mfma_f32_16x16x32_bf16 v[192:195], a[0:3], a[216:219], v[192:195]
s_add_u32 m0, s75, 131072
ds_read_b64_tr_b16 a[22:23], v17 offset:41984
v_and_b32 v73, s101, v46
v_mfma_f32_16x16x32_bf16 v[192:195], a[4:7], a[220:223], v[192:195]
buffer_load_dwordx4 v21, s[16:19], s62 offen offset:1024  lds
v_mfma_f32_16x16x32_bf16 v[224:227], a[0:3], v[26:29], v[224:227]
v_lshlrev_b32 v74, 16, v47
v_and_b32 v75, s101, v47
v_mfma_f32_16x16x32_bf16 v[224:227], a[4:7], v[26:29], v[224:227]
s_mov_b32 s32, 3209216
v_lshlrev_b32 v76, 16, v48
v_and_b32 v77, s101, v48
v_mfma_f32_16x16x32_bf16 v[100:103], a[8:11], a[192:195], v[100:103]
s_waitcnt lgkmcnt(1)
s_add_u32 m0, s33, 65536
ds_read_b64_tr_b16 a[24:25], v17 offset:32776
v_lshlrev_b32 v78, 16, v49
v_mfma_f32_16x16x32_bf16 v[100:103], a[12:15], a[196:199], v[100:103]
buffer_load_dwordx4 v3, s[12:15], s32 offen offset:2048  lds
v_mfma_f32_16x16x32_bf16 v[132:135], a[8:11], a[200:203], v[132:135]
ds_read_b64_tr_b16 a[26:27], v17 offset:33800
v_and_b32 v79, s101, v49
v_mfma_f32_16x16x32_bf16 v[132:135], a[12:15], a[204:207], v[132:135]
s_mov_b32 s62, 21248
v_lshlrev_b32 v86, 16, v50
v_and_b32 v87, s101, v50
v_mfma_f32_16x16x32_bf16 v[164:167], a[8:11], a[208:211], v[164:167]
s_add_u32 m0, s75, 133120
ds_read_b64_tr_b16 a[28:29], v17 offset:40968
v_mul_f32 v82, v60, v86
v_mfma_f32_16x16x32_bf16 v[164:167], a[12:15], a[212:215], v[164:167]
buffer_load_dwordx4 v20, s[16:19], s62 offen offset:0  lds
v_mfma_f32_16x16x32_bf16 v[196:199], a[8:11], a[216:219], v[196:199]
ds_read_b64_tr_b16 a[30:31], v17 offset:41992
v_mul_f32 v83, v61, v87
v_mfma_f32_16x16x32_bf16 v[196:199], a[12:15], a[220:223], v[196:199]
s_mov_b32 s32, 3240960
v_lshlrev_b32 v86, 16, v51
v_and_b32 v87, s101, v51
v_mfma_f32_16x16x32_bf16 v[228:231], a[8:11], v[26:29], v[228:231]
s_add_u32 m0, s33, 65536
v_mul_f32 v84, v62, v86
v_mul_f32 v85, v63, v87
v_mfma_f32_16x16x32_bf16 v[228:231], a[12:15], v[26:29], v[228:231]
buffer_load_dwordx4 v3, s[12:15], s32 offen offset:3072  lds
v_mfma_f32_16x16x32_bf16 v[104:107], a[16:19], a[192:195], v[104:107]
s_waitcnt lgkmcnt(1)
ds_read_b64_tr_b16 a[0:1], v18 offset:32768
v_lshlrev_b32 v86, 16, v52
v_mfma_f32_16x16x32_bf16 v[104:107], a[20:23], a[196:199], v[104:107]
v_and_b32 v87, s101, v52
v_fmac_f32 v82, v64, v86
v_mfma_f32_16x16x32_bf16 v[136:139], a[16:19], a[200:203], v[136:139]
s_add_u32 m0, s75, 133120
ds_read_b64_tr_b16 a[2:3], v18 offset:33792
v_fmac_f32 v83, v65, v87
v_mfma_f32_16x16x32_bf16 v[136:139], a[20:23], a[204:207], v[136:139]
buffer_load_dwordx4 v21, s[16:19], s62 offen offset:1024  lds
v_mfma_f32_16x16x32_bf16 v[168:171], a[16:19], a[208:211], v[168:171]
ds_read_b64_tr_b16 a[4:5], v18 offset:40960
v_lshlrev_b32 v86, 16, v53
v_mfma_f32_16x16x32_bf16 v[168:171], a[20:23], a[212:215], v[168:171]
s_mov_b32 s62, 41728
v_and_b32 v87, s101, v53
v_fmac_f32 v84, v66, v86
v_mfma_f32_16x16x32_bf16 v[200:203], a[16:19], a[216:219], v[200:203]
s_add_u32 m0, s75, 135168
ds_read_b64_tr_b16 a[6:7], v18 offset:41984
v_fmac_f32 v85, v67, v87
v_mfma_f32_16x16x32_bf16 v[200:203], a[20:23], a[220:223], v[200:203]
buffer_load_dwordx4 v20, s[16:19], s62 offen offset:0  lds
v_mfma_f32_16x16x32_bf16 v[108:111], a[24:27], a[192:195], v[108:111]
s_waitcnt lgkmcnt(2)
ds_read_b64_tr_b16 a[8:9], v18 offset:32776
v_lshlrev_b32 v86, 16, v54
v_mfma_f32_16x16x32_bf16 v[108:111], a[28:31], a[196:199], v[108:111]
v_and_b32 v87, s101, v54
v_fmac_f32 v82, v68, v86
v_mfma_f32_16x16x32_bf16 v[140:143], a[24:27], a[200:203], v[140:143]
s_add_u32 m0, s75, 135168
ds_read_b64_tr_b16 a[10:11], v18 offset:33800
v_fmac_f32 v83, v69, v87
v_mfma_f32_16x16x32_bf16 v[140:143], a[28:31], a[204:207], v[140:143]
buffer_load_dwordx4 v21, s[16:19], s62 offen offset:1024  lds
v_mfma_f32_16x16x32_bf16 v[172:175], a[24:27], a[208:211], v[172:175]
ds_read_b64_tr_b16 a[12:13], v18 offset:40968
v_lshlrev_b32 v86, 16, v55
v_mfma_f32_16x16x32_bf16 v[172:175], a[28:31], a[212:215], v[172:175]
s_mov_b32 s62, 62208
v_and_b32 v87, s101, v55
v_fmac_f32 v84, v70, v86
v_mfma_f32_16x16x32_bf16 v[204:207], a[24:27], a[216:219], v[204:207]
s_add_u32 m0, s75, 137216
ds_read_b64_tr_b16 a[14:15], v18 offset:41992
v_fmac_f32 v85, v71, v87
v_mfma_f32_16x16x32_bf16 v[204:207], a[28:31], a[220:223], v[204:207]
buffer_load_dwordx4 v20, s[16:19], s62 offen offset:0  lds
v_mfma_f32_16x16x32_bf16 v[112:115], a[0:3], a[192:195], v[112:115]
s_waitcnt lgkmcnt(2)
ds_read_b64_tr_b16 a[16:17], v19 offset:32768
v_lshlrev_b32 v86, 16, v56
v_mfma_f32_16x16x32_bf16 v[112:115], a[4:7], a[196:199], v[112:115]
v_and_b32 v87, s101, v56
v_fmac_f32 v82, v72, v86
v_mfma_f32_16x16x32_bf16 v[144:147], a[0:3], a[200:203], v[144:147]
s_add_u32 m0, s75, 137216
ds_read_b64_tr_b16 a[18:19], v19 offset:33792
v_fmac_f32 v83, v73, v87
v_mfma_f32_16x16x32_bf16 v[144:147], a[4:7], a[204:207], v[144:147]
buffer_load_dwordx4 v21, s[16:19], s62 offen offset:1024  lds
v_mfma_f32_16x16x32_bf16 v[176:179], a[0:3], a[208:211], v[176:179]
ds_read_b64_tr_b16 a[20:21], v19 offset:40960
v_lshlrev_b32 v86, 16, v57
v_mfma_f32_16x16x32_bf16 v[176:179], a[4:7], a[212:215], v[176:179]
v_and_b32 v87, s101, v57
v_fmac_f32 v84, v74, v86
v_mfma_f32_16x16x32_bf16 v[208:211], a[0:3], a[216:219], v[208:211]
ds_read_b64_tr_b16 a[22:23], v19 offset:41984
v_fmac_f32 v85, v75, v87
v_mfma_f32_16x16x32_bf16 v[208:211], a[4:7], a[220:223], v[208:211]
s_waitcnt vmcnt(12)
ds_read_b128 a[224:227], v24 offset:0
v_lshlrev_b32 v86, 16, v58
v_mfma_f32_16x16x32_bf16 v[116:119], a[8:11], a[192:195], v[116:119]
s_waitcnt lgkmcnt(3)
ds_read_b64_tr_b16 a[24:25], v19 offset:32776
v_and_b32 v87, s101, v58
v_mfma_f32_16x16x32_bf16 v[116:119], a[12:15], a[196:199], v[116:119]
ds_read_b128 a[228:231], v25 offset:0
v_fmac_f32 v82, v76, v86
v_mfma_f32_16x16x32_bf16 v[148:151], a[8:11], a[200:203], v[148:151]
ds_read_b64_tr_b16 a[26:27], v19 offset:33800
v_fmac_f32 v83, v77, v87
v_mfma_f32_16x16x32_bf16 v[148:151], a[12:15], a[204:207], v[148:151]
ds_read_b128 a[232:235], v24 offset:2048
v_lshlrev_b32 v86, 16, v59
v_mfma_f32_16x16x32_bf16 v[180:183], a[8:11], a[208:211], v[180:183]
ds_read_b64_tr_b16 a[28:29], v19 offset:40968
v_and_b32 v87, s101, v59
v_mfma_f32_16x16x32_bf16 v[180:183], a[12:15], a[212:215], v[180:183]
ds_read_b128 a[236:239], v25 offset:2048
v_fmac_f32 v84, v78, v86
v_mfma_f32_16x16x32_bf16 v[212:215], a[8:11], a[216:219], v[212:215]
ds_read_b64_tr_b16 a[30:31], v19 offset:41992
v_fmac_f32 v85, v79, v87
v_mfma_f32_16x16x32_bf16 v[212:215], a[12:15], a[220:223], v[212:215]
s_mov_b32 s32, 3670016
v_add_f32 v82, v82, v83
v_add_f32 v84, v84, v85
s_barrier
v_mfma_f32_16x16x32_bf16 v[120:123], a[16:19], a[192:195], v[120:123]
s_waitcnt lgkmcnt(4)
s_add_u32 m0, s33, 81920
ds_read_b64_tr_b16 a[0:1], v16 offset:49152
v_add_f32 v82, v82, v84
v_mfma_f32_16x16x32_bf16 v[120:123], a[20:23], a[196:199], v[120:123]
buffer_load_dwordx4 v3, s[12:15], s32 offen offset:0  lds
v_mfma_f32_16x16x32_bf16 v[152:155], a[16:19], a[200:203], v[152:155]
ds_read_b64_tr_b16 a[2:3], v16 offset:50176
v_mfma_f32_16x16x32_bf16 v[152:155], a[20:23], a[204:207], v[152:155]
s_nop 0
ds_read_b128 a[240:243], v24 offset:4096
v_add_f32_dpp v82, v82, v82 row_ror:8 row_mask:0xf bank_mask:0xf
v_mfma_f32_16x16x32_bf16 v[184:187], a[16:19], a[208:211], v[184:187]
ds_read_b64_tr_b16 a[4:5], v16 offset:57344
v_mfma_f32_16x16x32_bf16 v[184:187], a[20:23], a[212:215], v[184:187]
s_nop 0
ds_read_b128 a[244:247], v25 offset:4096
v_add_f32_dpp v82, v82, v82 row_ror:4 row_mask:0xf bank_mask:0xf
v_mfma_f32_16x16x32_bf16 v[216:219], a[16:19], a[216:219], v[216:219]
ds_read_b64_tr_b16 a[6:7], v16 offset:58368
v_mfma_f32_16x16x32_bf16 v[216:219], a[20:23], a[220:223], v[216:219]
s_mov_b32 s32, 3701760
s_nop 0
ds_read_b128 a[248:251], v24 offset:6144
v_add_f32_dpp v82, v82, v82 row_ror:2 row_mask:0xf bank_mask:0xf
v_mfma_f32_16x16x32_bf16 v[124:127], a[24:27], a[192:195], v[124:127]
s_waitcnt lgkmcnt(5)
s_add_u32 m0, s33, 81920
ds_read_b64_tr_b16 a[8:9], v16 offset:49160
v_mfma_f32_16x16x32_bf16 v[124:127], a[28:31], a[196:199], v[124:127]
s_nop 0
buffer_load_dwordx4 v3, s[12:15], s32 offen offset:1024  lds
v_mfma_f32_16x16x32_bf16 v[156:159], a[24:27], a[200:203], v[156:159]
ds_read_b64_tr_b16 a[10:11], v16 offset:50184
v_add_f32_dpp v82, v82, v82 row_ror:1 row_mask:0xf bank_mask:0xf
v_mfma_f32_16x16x32_bf16 v[156:159], a[28:31], a[204:207], v[156:159]
ds_read_b128 a[252:255], v25 offset:6144
v_mov_b32 v83, v82
v_mfma_f32_16x16x32_bf16 v[188:191], a[24:27], a[208:211], v[188:191]
ds_read_b64_tr_b16 a[12:13], v16 offset:57352
v_mfma_f32_16x16x32_bf16 v[188:191], a[28:31], a[212:215], v[188:191]
s_nop 0
v_permlane16_swap_b32 v82, v83
v_mfma_f32_16x16x32_bf16 v[220:223], a[24:27], a[216:219], v[220:223]
s_nop 0
ds_read_b64_tr_b16 a[14:15], v16 offset:58376
v_add_f32 v82, v82, v83
v_mfma_f32_16x16x32_bf16 v[220:223], a[28:31], a[220:223], v[220:223]
v_cvt_pk_bf16_f32 v82, v82, v82
v_ashrrev_i32 v83, 31, v82
v_mfma_f32_16x16x32_bf16 v[96:99], a[0:3], a[224:227], v[96:99]
s_waitcnt lgkmcnt(3)
ds_read_b64_tr_b16 a[16:17], v17 offset:49152
v_and_b32 v83, 0x7fff, v83
v_mfma_f32_16x16x32_bf16 v[96:99], a[4:7], a[228:231], v[96:99]
s_mov_b32 s62, 896
v_or_b32 v83, 0x8000, v83
v_and_b32 v82, 0xffff, v82
v_mfma_f32_16x16x32_bf16 v[128:131], a[0:3], a[232:235], v[128:131]
s_waitcnt lgkmcnt(2)
s_add_u32 m0, s75, 32768
ds_read_b64_tr_b16 a[18:19], v17 offset:50176
v_xor_b32 v82, v82, v83
v_mfma_f32_16x16x32_bf16 v[128:131], a[4:7], a[236:239], v[128:131]
buffer_load_dwordx4 v20, s[16:19], s62 offen offset:0  lds
v_mfma_f32_16x16x32_bf16 v[160:163], a[0:3], a[240:243], v[160:163]
ds_read_b64_tr_b16 a[20:21], v17 offset:57344
v_sub_u32 v83, 2047, v32
v_mfma_f32_16x16x32_bf16 v[160:163], a[4:7], a[244:247], v[160:163]
v_lshl_or_b32 v82, v82, 11, v83
v_mov_b32 v37, 16384
v_mfma_f32_16x16x32_bf16 v[192:195], a[0:3], a[248:251], v[192:195]
s_add_u32 m0, s75, 32768
ds_read_b64_tr_b16 a[22:23], v17 offset:58368
s_mov_b32 exec_lo, 1
s_mov_b32 exec_hi, 1
ds_max_u32 v37, v82
s_mov_b64 exec, -1
s_waitcnt lgkmcnt(0)
v_mfma_f32_16x16x32_bf16 v[192:195], a[4:7], a[252:255], v[192:195]
buffer_load_dwordx4 v21, s[16:19], s62 offen offset:1024  lds
v_mfma_f32_16x16x32_bf16 v[224:227], a[0:3], v[26:29], v[224:227]
v_mov_b32 v83, 0
v_lshl_add_u32 v37, v0, 2, s47
v_mfma_f32_16x16x32_bf16 v[224:227], a[4:7], v[26:29], v[224:227]
s_mov_b32 s32, 3733504
v_accvgpr_write_b32 a32, 0
v_accvgpr_write_b32 a33, 0
v_mfma_f32_16x16x32_bf16 v[100:103], a[8:11], a[224:227], v[100:103]
s_waitcnt lgkmcnt(1)
s_add_u32 m0, s33, 81920
ds_read_b64_tr_b16 a[24:25], v17 offset:49160
v_accvgpr_write_b32 a34, 0
v_mfma_f32_16x16x32_bf16 v[100:103], a[12:15], a[228:231], v[100:103]
buffer_load_dwordx4 v3, s[12:15], s32 offen offset:2048  lds
v_mfma_f32_16x16x32_bf16 v[132:135], a[8:11], a[232:235], v[132:135]
ds_read_b64_tr_b16 a[26:27], v17 offset:50184
v_accvgpr_write_b32 a35, 0
v_mfma_f32_16x16x32_bf16 v[132:135], a[12:15], a[236:239], v[132:135]
s_mov_b32 s62, 21376
v_accvgpr_write_b32 a36, 0
v_accvgpr_write_b32 a37, 0
v_mfma_f32_16x16x32_bf16 v[164:167], a[8:11], a[240:243], v[164:167]
s_add_u32 m0, s75, 34816
ds_read_b64_tr_b16 a[28:29], v17 offset:57352
v_accvgpr_write_b32 a38, 0
v_mfma_f32_16x16x32_bf16 v[164:167], a[12:15], a[244:247], v[164:167]
buffer_load_dwordx4 v20, s[16:19], s62 offen offset:0  lds
v_mfma_f32_16x16x32_bf16 v[196:199], a[8:11], a[248:251], v[196:199]
ds_read_b64_tr_b16 a[30:31], v17 offset:58376
v_accvgpr_write_b32 a39, 0
v_mfma_f32_16x16x32_bf16 v[196:199], a[12:15], a[252:255], v[196:199]
s_mov_b32 s32, 3765248
v_accvgpr_write_b32 a40, 0
v_accvgpr_write_b32 a41, 0
v_mfma_f32_16x16x32_bf16 v[228:231], a[8:11], v[26:29], v[228:231]
s_add_u32 m0, s33, 81920
v_accvgpr_write_b32 a42, 0
v_accvgpr_write_b32 a43, 0
v_mfma_f32_16x16x32_bf16 v[228:231], a[12:15], v[26:29], v[228:231]
buffer_load_dwordx4 v3, s[12:15], s32 offen offset:3072  lds
v_mfma_f32_16x16x32_bf16 v[104:107], a[16:19], a[224:227], v[104:107]
s_waitcnt lgkmcnt(1)
ds_read_b64_tr_b16 a[0:1], v18 offset:49152
v_accvgpr_write_b32 a44, 0
v_mfma_f32_16x16x32_bf16 v[104:107], a[20:23], a[228:231], v[104:107]
v_accvgpr_write_b32 a45, 0
v_accvgpr_write_b32 a46, 0
v_mfma_f32_16x16x32_bf16 v[136:139], a[16:19], a[232:235], v[136:139]
s_add_u32 m0, s75, 34816
ds_read_b64_tr_b16 a[2:3], v18 offset:50176
v_accvgpr_write_b32 a47, 0
v_mfma_f32_16x16x32_bf16 v[136:139], a[20:23], a[236:239], v[136:139]
buffer_load_dwordx4 v21, s[16:19], s62 offen offset:1024  lds
v_mfma_f32_16x16x32_bf16 v[168:171], a[16:19], a[240:243], v[168:171]
ds_read_b64_tr_b16 a[4:5], v18 offset:57344
v_accvgpr_write_b32 a48, 0
v_mfma_f32_16x16x32_bf16 v[168:171], a[20:23], a[244:247], v[168:171]
s_mov_b32 s62, 41856
v_accvgpr_write_b32 a49, 0
v_accvgpr_write_b32 a50, 0
v_mfma_f32_16x16x32_bf16 v[200:203], a[16:19], a[248:251], v[200:203]
s_add_u32 m0, s75, 36864
ds_read_b64_tr_b16 a[6:7], v18 offset:58368
v_accvgpr_write_b32 a51, 0
v_mfma_f32_16x16x32_bf16 v[200:203], a[20:23], a[252:255], v[200:203]
buffer_load_dwordx4 v20, s[16:19], s62 offen offset:0  lds
v_mfma_f32_16x16x32_bf16 v[108:111], a[24:27], a[224:227], v[108:111]
s_waitcnt lgkmcnt(2)
ds_read_b64_tr_b16 a[8:9], v18 offset:49160
v_accvgpr_write_b32 a52, 0
v_mfma_f32_16x16x32_bf16 v[108:111], a[28:31], a[228:231], v[108:111]
v_accvgpr_write_b32 a53, 0
v_accvgpr_write_b32 a54, 0
v_mfma_f32_16x16x32_bf16 v[140:143], a[24:27], a[232:235], v[140:143]
s_add_u32 m0, s75, 36864
ds_read_b64_tr_b16 a[10:11], v18 offset:50184
v_accvgpr_write_b32 a55, 0
v_mfma_f32_16x16x32_bf16 v[140:143], a[28:31], a[236:239], v[140:143]
buffer_load_dwordx4 v21, s[16:19], s62 offen offset:1024  lds
v_mfma_f32_16x16x32_bf16 v[172:175], a[24:27], a[240:243], v[172:175]
ds_read_b64_tr_b16 a[12:13], v18 offset:57352
v_accvgpr_write_b32 a56, 0
v_mfma_f32_16x16x32_bf16 v[172:175], a[28:31], a[244:247], v[172:175]
s_mov_b32 s62, 62336
v_accvgpr_write_b32 a57, 0
v_accvgpr_write_b32 a58, 0
v_mfma_f32_16x16x32_bf16 v[204:207], a[24:27], a[248:251], v[204:207]
s_add_u32 m0, s75, 38912
ds_read_b64_tr_b16 a[14:15], v18 offset:58376
v_accvgpr_write_b32 a59, 0
v_mfma_f32_16x16x32_bf16 v[204:207], a[28:31], a[252:255], v[204:207]
buffer_load_dwordx4 v20, s[16:19], s62 offen offset:0  lds
v_mfma_f32_16x16x32_bf16 v[112:115], a[0:3], a[224:227], v[112:115]
s_waitcnt lgkmcnt(2)
ds_read_b64_tr_b16 a[16:17], v19 offset:49152
v_accvgpr_write_b32 a60, 0
v_mfma_f32_16x16x32_bf16 v[112:115], a[4:7], a[228:231], v[112:115]
v_accvgpr_write_b32 a61, 0
v_accvgpr_write_b32 a62, 0
v_mfma_f32_16x16x32_bf16 v[144:147], a[0:3], a[232:235], v[144:147]
s_add_u32 m0, s75, 38912
ds_read_b64_tr_b16 a[18:19], v19 offset:50176
v_accvgpr_write_b32 a63, 0
v_mfma_f32_16x16x32_bf16 v[144:147], a[4:7], a[236:239], v[144:147]
buffer_load_dwordx4 v21, s[16:19], s62 offen offset:1024  lds
v_mfma_f32_16x16x32_bf16 v[176:179], a[0:3], a[240:243], v[176:179]
ds_read_b64_tr_b16 a[20:21], v19 offset:57344
v_accvgpr_write_b32 a64, 0
v_mfma_f32_16x16x32_bf16 v[176:179], a[4:7], a[244:247], v[176:179]
v_accvgpr_write_b32 a65, 0
v_accvgpr_write_b32 a66, 0
v_mfma_f32_16x16x32_bf16 v[208:211], a[0:3], a[248:251], v[208:211]
ds_read_b64_tr_b16 a[22:23], v19 offset:58368
v_accvgpr_write_b32 a67, 0
v_mfma_f32_16x16x32_bf16 v[208:211], a[4:7], a[252:255], v[208:211]
s_waitcnt vmcnt(12)
ds_read_b128 a[192:195], v22 offset:0
v_accvgpr_write_b32 a68, 0
v_mfma_f32_16x16x32_bf16 v[116:119], a[8:11], a[224:227], v[116:119]
s_waitcnt lgkmcnt(3)
ds_read_b64_tr_b16 a[24:25], v19 offset:49160
v_accvgpr_write_b32 a69, 0
v_mfma_f32_16x16x32_bf16 v[116:119], a[12:15], a[228:231], v[116:119]
ds_read_b128 a[196:199], v23 offset:0
v_accvgpr_write_b32 a70, 0
v_mfma_f32_16x16x32_bf16 v[148:151], a[8:11], a[232:235], v[148:151]
ds_read_b64_tr_b16 a[26:27], v19 offset:50184
v_accvgpr_write_b32 a71, 0
v_mfma_f32_16x16x32_bf16 v[148:151], a[12:15], a[236:239], v[148:151]
ds_read_b128 a[200:203], v22 offset:2048
v_accvgpr_write_b32 a72, 0
v_mfma_f32_16x16x32_bf16 v[180:183], a[8:11], a[240:243], v[180:183]
ds_read_b64_tr_b16 a[28:29], v19 offset:57352
v_accvgpr_write_b32 a73, 0
v_mfma_f32_16x16x32_bf16 v[180:183], a[12:15], a[244:247], v[180:183]
ds_read_b128 a[204:207], v23 offset:2048
v_accvgpr_write_b32 a74, 0
v_mfma_f32_16x16x32_bf16 v[212:215], a[8:11], a[248:251], v[212:215]
ds_read_b64_tr_b16 a[30:31], v19 offset:58376
v_accvgpr_write_b32 a75, 0
v_mfma_f32_16x16x32_bf16 v[212:215], a[12:15], a[252:255], v[212:215]
s_mov_b32 s32, 4194304
v_accvgpr_write_b32 a76, 0
v_accvgpr_write_b32 a77, 0
s_barrier
v_mfma_f32_16x16x32_bf16 v[120:123], a[16:19], a[224:227], v[120:123]
s_waitcnt lgkmcnt(4)
s_add_u32 m0, s33, 98304
ds_read_b64_tr_b16 a[0:1], v16 offset:0
v_accvgpr_write_b32 a78, 0
v_mfma_f32_16x16x32_bf16 v[120:123], a[20:23], a[228:231], v[120:123]
buffer_load_dwordx4 v3, s[12:15], s32 offen offset:0  lds
v_mfma_f32_16x16x32_bf16 v[152:155], a[16:19], a[232:235], v[152:155]
ds_read_b64_tr_b16 a[2:3], v16 offset:1024
v_accvgpr_write_b32 a79, 0
v_mfma_f32_16x16x32_bf16 v[152:155], a[20:23], a[236:239], v[152:155]
ds_read_b128 a[208:211], v22 offset:4096
v_accvgpr_write_b32 a80, 0
v_mfma_f32_16x16x32_bf16 v[184:187], a[16:19], a[240:243], v[184:187]
ds_read_b64_tr_b16 a[4:5], v16 offset:8192
v_accvgpr_write_b32 a81, 0
v_mfma_f32_16x16x32_bf16 v[184:187], a[20:23], a[244:247], v[184:187]
ds_read_b128 a[212:215], v23 offset:4096
v_accvgpr_write_b32 a82, 0
v_mfma_f32_16x16x32_bf16 v[216:219], a[16:19], a[248:251], v[216:219]
ds_read_b64_tr_b16 a[6:7], v16 offset:9216
v_accvgpr_write_b32 a83, 0
v_mfma_f32_16x16x32_bf16 v[216:219], a[20:23], a[252:255], v[216:219]
s_mov_b32 s32, 4226048
ds_read_b128 a[216:219], v22 offset:6144
v_accvgpr_write_b32 a84, 0
v_mfma_f32_16x16x32_bf16 v[124:127], a[24:27], a[224:227], v[124:127]
s_waitcnt lgkmcnt(5)
s_add_u32 m0, s33, 98304
ds_read_b64_tr_b16 a[8:9], v16 offset:8
v_accvgpr_write_b32 a85, 0
v_mfma_f32_16x16x32_bf16 v[124:127], a[28:31], a[228:231], v[124:127]
buffer_load_dwordx4 v3, s[12:15], s32 offen offset:1024  lds
v_mfma_f32_16x16x32_bf16 v[156:159], a[24:27], a[232:235], v[156:159]
ds_read_b64_tr_b16 a[10:11], v16 offset:1032
v_accvgpr_write_b32 a86, 0
v_mfma_f32_16x16x32_bf16 v[156:159], a[28:31], a[236:239], v[156:159]
ds_read_b128 a[220:223], v23 offset:6144
v_accvgpr_write_b32 a87, 0
v_mfma_f32_16x16x32_bf16 v[188:191], a[24:27], a[240:243], v[188:191]
ds_read_b64_tr_b16 a[12:13], v16 offset:8200
v_accvgpr_write_b32 a88, 0
v_mfma_f32_16x16x32_bf16 v[188:191], a[28:31], a[244:247], v[188:191]
v_accvgpr_write_b32 a89, 0
v_accvgpr_write_b32 a90, 0
v_mfma_f32_16x16x32_bf16 v[220:223], a[24:27], a[248:251], v[220:223]
ds_read_b64_tr_b16 a[14:15], v16 offset:9224
v_accvgpr_write_b32 a91, 0
v_mfma_f32_16x16x32_bf16 v[220:223], a[28:31], a[252:255], v[220:223]
v_accvgpr_write_b32 a92, 0
v_accvgpr_write_b32 a93, 0
v_mfma_f32_16x16x32_bf16 v[96:99], a[0:3], a[192:195], v[96:99]
s_waitcnt lgkmcnt(3)
ds_read_b64_tr_b16 a[16:17], v17 offset:0
v_accvgpr_write_b32 a94, 0
v_mfma_f32_16x16x32_bf16 v[96:99], a[4:7], a[196:199], v[96:99]
s_mov_b32 s62, 1024
v_accvgpr_write_b32 a95, 0
v_accvgpr_write_b32 a96, 0
v_mfma_f32_16x16x32_bf16 v[128:131], a[0:3], a[200:203], v[128:131]
s_waitcnt lgkmcnt(2)
s_add_u32 m0, s75, 131072
ds_read_b64_tr_b16 a[18:19], v17 offset:1024
v_accvgpr_write_b32 a97, 0
v_mfma_f32_16x16x32_bf16 v[128:131], a[4:7], a[204:207], v[128:131]
buffer_load_dwordx4 v20, s[16:19], s62 offen offset:0  lds
v_mfma_f32_16x16x32_bf16 v[160:163], a[0:3], a[208:211], v[160:163]
ds_read_b64_tr_b16 a[20:21], v17 offset:8192
v_accvgpr_write_b32 a98, 0
v_mfma_f32_16x16x32_bf16 v[160:163], a[4:7], a[212:215], v[160:163]
v_accvgpr_write_b32 a99, 0
v_accvgpr_write_b32 a100, 0
v_mfma_f32_16x16x32_bf16 v[192:195], a[0:3], a[216:219], v[192:195]
s_add_u32 m0, s75, 131072
ds_read_b64_tr_b16 a[22:23], v17 offset:9216
v_accvgpr_write_b32 a101, 0
v_mfma_f32_16x16x32_bf16 v[192:195], a[4:7], a[220:223], v[192:195]
buffer_load_dwordx4 v21, s[16:19], s62 offen offset:1024  lds
v_mfma_f32_16x16x32_bf16 v[224:227], a[0:3], v[26:29], v[224:227]
v_accvgpr_write_b32 a102, 0
v_accvgpr_write_b32 a103, 0
v_mfma_f32_16x16x32_bf16 v[224:227], a[4:7], v[26:29], v[224:227]
s_mov_b32 s32, 4257792
v_accvgpr_write_b32 a104, 0
v_accvgpr_write_b32 a105, 0
v_mfma_f32_16x16x32_bf16 v[100:103], a[8:11], a[192:195], v[100:103]
s_waitcnt lgkmcnt(1)
s_add_u32 m0, s33, 98304
ds_read_b64_tr_b16 a[24:25], v17 offset:8
v_accvgpr_write_b32 a106, 0
v_mfma_f32_16x16x32_bf16 v[100:103], a[12:15], a[196:199], v[100:103]
buffer_load_dwordx4 v3, s[12:15], s32 offen offset:2048  lds
v_mfma_f32_16x16x32_bf16 v[132:135], a[8:11], a[200:203], v[132:135]
ds_read_b64_tr_b16 a[26:27], v17 offset:1032
v_accvgpr_write_b32 a107, 0
v_mfma_f32_16x16x32_bf16 v[132:135], a[12:15], a[204:207], v[132:135]
s_mov_b32 s62, 21504
v_accvgpr_write_b32 a108, 0
v_accvgpr_write_b32 a109, 0
v_mfma_f32_16x16x32_bf16 v[164:167], a[8:11], a[208:211], v[164:167]
s_add_u32 m0, s75, 133120
ds_read_b64_tr_b16 a[28:29], v17 offset:8200
v_accvgpr_write_b32 a110, 0
v_mfma_f32_16x16x32_bf16 v[164:167], a[12:15], a[212:215], v[164:167]
buffer_load_dwordx4 v20, s[16:19], s62 offen offset:0  lds
v_mfma_f32_16x16x32_bf16 v[196:199], a[8:11], a[216:219], v[196:199]
ds_read_b64_tr_b16 a[30:31], v17 offset:9224
v_accvgpr_write_b32 a111, 0
v_mfma_f32_16x16x32_bf16 v[196:199], a[12:15], a[220:223], v[196:199]
s_mov_b32 s32, 4289536
v_accvgpr_write_b32 a112, 0
v_accvgpr_write_b32 a113, 0
v_mfma_f32_16x16x32_bf16 v[228:231], a[8:11], v[26:29], v[228:231]
s_add_u32 m0, s33, 98304
v_accvgpr_write_b32 a114, 0
v_accvgpr_write_b32 a115, 0
v_mfma_f32_16x16x32_bf16 v[228:231], a[12:15], v[26:29], v[228:231]
buffer_load_dwordx4 v3, s[12:15], s32 offen offset:3072  lds
v_mfma_f32_16x16x32_bf16 v[104:107], a[16:19], a[192:195], v[104:107]
s_waitcnt lgkmcnt(1)
ds_read_b64_tr_b16 a[0:1], v18 offset:0
v_accvgpr_write_b32 a116, 0
v_mfma_f32_16x16x32_bf16 v[104:107], a[20:23], a[196:199], v[104:107]
v_accvgpr_write_b32 a117, 0
v_accvgpr_write_b32 a118, 0
v_mfma_f32_16x16x32_bf16 v[136:139], a[16:19], a[200:203], v[136:139]
s_add_u32 m0, s75, 133120
ds_read_b64_tr_b16 a[2:3], v18 offset:1024
v_accvgpr_write_b32 a119, 0
v_mfma_f32_16x16x32_bf16 v[136:139], a[20:23], a[204:207], v[136:139]
buffer_load_dwordx4 v21, s[16:19], s62 offen offset:1024  lds
v_mfma_f32_16x16x32_bf16 v[168:171], a[16:19], a[208:211], v[168:171]
ds_read_b64_tr_b16 a[4:5], v18 offset:8192
v_accvgpr_write_b32 a120, 0
v_mfma_f32_16x16x32_bf16 v[168:171], a[20:23], a[212:215], v[168:171]
s_mov_b32 s62, 41984
v_accvgpr_write_b32 a121, 0
v_accvgpr_write_b32 a122, 0
v_mfma_f32_16x16x32_bf16 v[200:203], a[16:19], a[216:219], v[200:203]
s_add_u32 m0, s75, 135168
ds_read_b64_tr_b16 a[6:7], v18 offset:9216
v_accvgpr_write_b32 a123, 0
v_mfma_f32_16x16x32_bf16 v[200:203], a[20:23], a[220:223], v[200:203]
buffer_load_dwordx4 v20, s[16:19], s62 offen offset:0  lds
v_mfma_f32_16x16x32_bf16 v[108:111], a[24:27], a[192:195], v[108:111]
s_waitcnt lgkmcnt(2)
ds_read_b64_tr_b16 a[8:9], v18 offset:8
v_accvgpr_write_b32 a124, 0
v_mfma_f32_16x16x32_bf16 v[108:111], a[28:31], a[196:199], v[108:111]
v_accvgpr_write_b32 a125, 0
v_accvgpr_write_b32 a126, 0
v_mfma_f32_16x16x32_bf16 v[140:143], a[24:27], a[200:203], v[140:143]
s_add_u32 m0, s75, 135168
ds_read_b64_tr_b16 a[10:11], v18 offset:1032
v_accvgpr_write_b32 a127, 0
v_mfma_f32_16x16x32_bf16 v[140:143], a[28:31], a[204:207], v[140:143]
buffer_load_dwordx4 v21, s[16:19], s62 offen offset:1024  lds
v_mfma_f32_16x16x32_bf16 v[172:175], a[24:27], a[208:211], v[172:175]
ds_read_b64_tr_b16 a[12:13], v18 offset:8200
v_mfma_f32_16x16x32_bf16 v[172:175], a[28:31], a[212:215], v[172:175]
s_mov_b32 s62, 62464
v_mfma_f32_16x16x32_bf16 v[204:207], a[24:27], a[216:219], v[204:207]
s_add_u32 m0, s75, 137216
ds_read_b64_tr_b16 a[14:15], v18 offset:9224
v_mfma_f32_16x16x32_bf16 v[204:207], a[28:31], a[220:223], v[204:207]
buffer_load_dwordx4 v20, s[16:19], s62 offen offset:0  lds
v_mfma_f32_16x16x32_bf16 v[112:115], a[0:3], a[192:195], v[112:115]
s_waitcnt lgkmcnt(2)
ds_read_b64_tr_b16 a[16:17], v19 offset:0
v_mfma_f32_16x16x32_bf16 v[112:115], a[4:7], a[196:199], v[112:115]
v_mfma_f32_16x16x32_bf16 v[144:147], a[0:3], a[200:203], v[144:147]
s_add_u32 m0, s75, 137216
ds_read_b64_tr_b16 a[18:19], v19 offset:1024
v_mfma_f32_16x16x32_bf16 v[144:147], a[4:7], a[204:207], v[144:147]
buffer_load_dwordx4 v21, s[16:19], s62 offen offset:1024  lds
v_mfma_f32_16x16x32_bf16 v[176:179], a[0:3], a[208:211], v[176:179]
s_mov_b32 s34, 0
ds_read_b64_tr_b16 a[20:21], v19 offset:8192
v_mfma_f32_16x16x32_bf16 v[176:179], a[4:7], a[212:215], v[176:179]
s_add_u32 m0, s33, 0
v_mfma_f32_16x16x32_bf16 v[208:211], a[0:3], a[216:219], v[208:211]
ds_read_b64_tr_b16 a[22:23], v19 offset:9216
buffer_load_dwordx4 v1, s[4:7], s34 offen offset:0 sc1 lds
v_mfma_f32_16x16x32_bf16 v[208:211], a[4:7], a[220:223], v[208:211]
s_waitcnt vmcnt(13)
ds_read_b128 a[224:227], v24 offset:0
v_mfma_f32_16x16x32_bf16 v[116:119], a[8:11], a[192:195], v[116:119]
s_waitcnt lgkmcnt(3)
ds_read_b64_tr_b16 a[24:25], v19 offset:8
v_mfma_f32_16x16x32_bf16 v[116:119], a[12:15], a[196:199], v[116:119]
s_add_u32 m0, s33, 0
ds_read_b128 a[228:231], v25 offset:0
v_mfma_f32_16x16x32_bf16 v[148:151], a[8:11], a[200:203], v[148:151]
ds_read_b64_tr_b16 a[26:27], v19 offset:1032
buffer_load_dwordx4 v1, s[4:7], s34 offen offset:1024 sc1 lds
v_mfma_f32_16x16x32_bf16 v[148:151], a[12:15], a[204:207], v[148:151]
ds_read_b128 a[232:235], v24 offset:2048
v_mfma_f32_16x16x32_bf16 v[180:183], a[8:11], a[208:211], v[180:183]
ds_read_b64_tr_b16 a[28:29], v19 offset:8200
v_mfma_f32_16x16x32_bf16 v[180:183], a[12:15], a[212:215], v[180:183]
ds_read_b128 a[236:239], v25 offset:2048
v_mfma_f32_16x16x32_bf16 v[212:215], a[8:11], a[216:219], v[212:215]
ds_read_b64_tr_b16 a[30:31], v19 offset:9224
v_mfma_f32_16x16x32_bf16 v[212:215], a[12:15], a[220:223], v[212:215]
s_mov_b32 s32, 4718592
s_barrier
s_cmp_lg_u32 s28, 0
s_cbranch_scc1 APOL0W
buffer_load_dword v252, v253, s[64:67], 0 offen sc1
APOL0W:
v_mfma_f32_16x16x32_bf16 v[120:123], a[16:19], a[192:195], v[120:123]
s_waitcnt lgkmcnt(4)
s_add_u32 m0, s33, 114688
ds_read_b64_tr_b16 a[0:1], v16 offset:16384
v_mfma_f32_16x16x32_bf16 v[120:123], a[20:23], a[196:199], v[120:123]
buffer_load_dwordx4 v3, s[12:15], s32 offen offset:0  lds
v_mfma_f32_16x16x32_bf16 v[152:155], a[16:19], a[200:203], v[152:155]
ds_read_b64_tr_b16 a[2:3], v16 offset:17408
v_mfma_f32_16x16x32_bf16 v[152:155], a[20:23], a[204:207], v[152:155]
ds_read_b128 a[240:243], v24 offset:4096
v_mfma_f32_16x16x32_bf16 v[184:187], a[16:19], a[208:211], v[184:187]
ds_read_b64_tr_b16 a[4:5], v16 offset:24576
v_mfma_f32_16x16x32_bf16 v[184:187], a[20:23], a[212:215], v[184:187]
ds_read_b128 a[244:247], v25 offset:4096
v_mfma_f32_16x16x32_bf16 v[216:219], a[16:19], a[216:219], v[216:219]
ds_read_b64_tr_b16 a[6:7], v16 offset:25600
v_mfma_f32_16x16x32_bf16 v[216:219], a[20:23], a[220:223], v[216:219]
s_mov_b32 s32, 4750336
ds_read_b128 a[248:251], v24 offset:6144
v_mfma_f32_16x16x32_bf16 v[124:127], a[24:27], a[192:195], v[124:127]
s_waitcnt lgkmcnt(5)
s_add_u32 m0, s33, 114688
ds_read_b64_tr_b16 a[8:9], v16 offset:16392
v_mfma_f32_16x16x32_bf16 v[124:127], a[28:31], a[196:199], v[124:127]
buffer_load_dwordx4 v3, s[12:15], s32 offen offset:1024  lds
v_mfma_f32_16x16x32_bf16 v[156:159], a[24:27], a[200:203], v[156:159]
ds_read_b64_tr_b16 a[10:11], v16 offset:17416
v_mfma_f32_16x16x32_bf16 v[156:159], a[28:31], a[204:207], v[156:159]
ds_read_b128 a[252:255], v25 offset:6144
v_mfma_f32_16x16x32_bf16 v[188:191], a[24:27], a[208:211], v[188:191]
s_add_u32 m0, s33, 0
ds_read_b64_tr_b16 a[12:13], v16 offset:24584
v_mfma_f32_16x16x32_bf16 v[188:191], a[28:31], a[212:215], v[188:191]
buffer_load_dwordx4 v1, s[4:7], s34 offen offset:2048 sc1 lds
v_mfma_f32_16x16x32_bf16 v[220:223], a[24:27], a[216:219], v[220:223]
s_add_u32 m0, s33, 0
ds_read_b64_tr_b16 a[14:15], v16 offset:25608
v_mfma_f32_16x16x32_bf16 v[220:223], a[28:31], a[220:223], v[220:223]
buffer_load_dwordx4 v1, s[4:7], s34 offen offset:3072 sc1 lds
v_mfma_f32_16x16x32_bf16 v[96:99], a[0:3], a[224:227], v[96:99]
s_waitcnt lgkmcnt(3)
ds_read_b64_tr_b16 a[16:17], v17 offset:16384
v_mfma_f32_16x16x32_bf16 v[96:99], a[4:7], a[228:231], v[96:99]
s_mov_b32 s62, 1152
v_mfma_f32_16x16x32_bf16 v[128:131], a[0:3], a[232:235], v[128:131]
s_waitcnt lgkmcnt(2)
s_add_u32 m0, s75, 32768
ds_read_b64_tr_b16 a[18:19], v17 offset:17408
v_mfma_f32_16x16x32_bf16 v[128:131], a[4:7], a[236:239], v[128:131]
buffer_load_dwordx4 v20, s[16:19], s62 offen offset:0  lds
v_mfma_f32_16x16x32_bf16 v[160:163], a[0:3], a[240:243], v[160:163]
ds_read_b64_tr_b16 a[20:21], v17 offset:24576
v_mfma_f32_16x16x32_bf16 v[160:163], a[4:7], a[244:247], v[160:163]
v_mfma_f32_16x16x32_bf16 v[192:195], a[0:3], a[248:251], v[192:195]
s_add_u32 m0, s75, 32768
ds_read_b64_tr_b16 a[22:23], v17 offset:25600
v_mfma_f32_16x16x32_bf16 v[192:195], a[4:7], a[252:255], v[192:195]
buffer_load_dwordx4 v21, s[16:19], s62 offen offset:1024  lds
v_mfma_f32_16x16x32_bf16 v[224:227], a[0:3], v[26:29], v[224:227]
v_mfma_f32_16x16x32_bf16 v[224:227], a[4:7], v[26:29], v[224:227]
s_mov_b32 s32, 4782080
v_mfma_f32_16x16x32_bf16 v[100:103], a[8:11], a[224:227], v[100:103]
s_waitcnt lgkmcnt(1)
s_add_u32 m0, s33, 114688
ds_read_b64_tr_b16 a[24:25], v17 offset:16392
v_mfma_f32_16x16x32_bf16 v[100:103], a[12:15], a[228:231], v[100:103]
buffer_load_dwordx4 v3, s[12:15], s32 offen offset:2048  lds
v_mfma_f32_16x16x32_bf16 v[132:135], a[8:11], a[232:235], v[132:135]
ds_read_b64_tr_b16 a[26:27], v17 offset:17416
v_mfma_f32_16x16x32_bf16 v[132:135], a[12:15], a[236:239], v[132:135]
s_mov_b32 s62, 21632
v_mfma_f32_16x16x32_bf16 v[164:167], a[8:11], a[240:243], v[164:167]
s_add_u32 m0, s75, 34816
ds_read_b64_tr_b16 a[28:29], v17 offset:24584
v_mfma_f32_16x16x32_bf16 v[164:167], a[12:15], a[244:247], v[164:167]
buffer_load_dwordx4 v20, s[16:19], s62 offen offset:0  lds
v_mfma_f32_16x16x32_bf16 v[196:199], a[8:11], a[248:251], v[196:199]
ds_read_b64_tr_b16 a[30:31], v17 offset:25608
v_mfma_f32_16x16x32_bf16 v[196:199], a[12:15], a[252:255], v[196:199]
s_mov_b32 s32, 4813824
v_mfma_f32_16x16x32_bf16 v[228:231], a[8:11], v[26:29], v[228:231]
s_add_u32 m0, s33, 114688
v_mfma_f32_16x16x32_bf16 v[228:231], a[12:15], v[26:29], v[228:231]
buffer_load_dwordx4 v3, s[12:15], s32 offen offset:3072  lds
v_mfma_f32_16x16x32_bf16 v[104:107], a[16:19], a[224:227], v[104:107]
s_waitcnt lgkmcnt(1)
ds_read_b64_tr_b16 a[0:1], v18 offset:16384
v_mfma_f32_16x16x32_bf16 v[104:107], a[20:23], a[228:231], v[104:107]
v_mfma_f32_16x16x32_bf16 v[136:139], a[16:19], a[232:235], v[136:139]
s_add_u32 m0, s75, 34816
ds_read_b64_tr_b16 a[2:3], v18 offset:17408
v_mfma_f32_16x16x32_bf16 v[136:139], a[20:23], a[236:239], v[136:139]
buffer_load_dwordx4 v21, s[16:19], s62 offen offset:1024  lds
v_mfma_f32_16x16x32_bf16 v[168:171], a[16:19], a[240:243], v[168:171]
ds_read_b64_tr_b16 a[4:5], v18 offset:24576
v_mfma_f32_16x16x32_bf16 v[168:171], a[20:23], a[244:247], v[168:171]
s_mov_b32 s62, 42112
v_mfma_f32_16x16x32_bf16 v[200:203], a[16:19], a[248:251], v[200:203]
s_add_u32 m0, s75, 36864
ds_read_b64_tr_b16 a[6:7], v18 offset:25600
v_mfma_f32_16x16x32_bf16 v[200:203], a[20:23], a[252:255], v[200:203]
buffer_load_dwordx4 v20, s[16:19], s62 offen offset:0  lds
v_mfma_f32_16x16x32_bf16 v[108:111], a[24:27], a[224:227], v[108:111]
s_waitcnt lgkmcnt(2)
ds_read_b64_tr_b16 a[8:9], v18 offset:16392
v_mfma_f32_16x16x32_bf16 v[108:111], a[28:31], a[228:231], v[108:111]
v_mfma_f32_16x16x32_bf16 v[140:143], a[24:27], a[232:235], v[140:143]
s_add_u32 m0, s75, 36864
ds_read_b64_tr_b16 a[10:11], v18 offset:17416
v_mfma_f32_16x16x32_bf16 v[140:143], a[28:31], a[236:239], v[140:143]
buffer_load_dwordx4 v21, s[16:19], s62 offen offset:1024  lds
v_mfma_f32_16x16x32_bf16 v[172:175], a[24:27], a[240:243], v[172:175]
ds_read_b64_tr_b16 a[12:13], v18 offset:24584
v_mfma_f32_16x16x32_bf16 v[172:175], a[28:31], a[244:247], v[172:175]
s_mov_b32 s62, 62592
v_mfma_f32_16x16x32_bf16 v[204:207], a[24:27], a[248:251], v[204:207]
s_add_u32 m0, s75, 38912
ds_read_b64_tr_b16 a[14:15], v18 offset:25608
v_mfma_f32_16x16x32_bf16 v[204:207], a[28:31], a[252:255], v[204:207]
buffer_load_dwordx4 v20, s[16:19], s62 offen offset:0  lds
v_mfma_f32_16x16x32_bf16 v[112:115], a[0:3], a[224:227], v[112:115]
s_waitcnt lgkmcnt(2)
ds_read_b64_tr_b16 a[16:17], v19 offset:16384
v_mfma_f32_16x16x32_bf16 v[112:115], a[4:7], a[228:231], v[112:115]
v_mfma_f32_16x16x32_bf16 v[144:147], a[0:3], a[232:235], v[144:147]
s_add_u32 m0, s75, 38912
ds_read_b64_tr_b16 a[18:19], v19 offset:17408
v_mfma_f32_16x16x32_bf16 v[144:147], a[4:7], a[236:239], v[144:147]
buffer_load_dwordx4 v21, s[16:19], s62 offen offset:1024  lds
v_mfma_f32_16x16x32_bf16 v[176:179], a[0:3], a[240:243], v[176:179]
ds_read_b64_tr_b16 a[20:21], v19 offset:24576
v_mfma_f32_16x16x32_bf16 v[176:179], a[4:7], a[244:247], v[176:179]
v_mfma_f32_16x16x32_bf16 v[208:211], a[0:3], a[248:251], v[208:211]
ds_read_b64_tr_b16 a[22:23], v19 offset:25600
v_mfma_f32_16x16x32_bf16 v[208:211], a[4:7], a[252:255], v[208:211]
s_waitcnt vmcnt(16)
ds_read_b128 a[192:195], v22 offset:0
v_mfma_f32_16x16x32_bf16 v[116:119], a[8:11], a[224:227], v[116:119]
s_waitcnt lgkmcnt(3)
ds_read_b64_tr_b16 a[24:25], v19 offset:16392
v_mfma_f32_16x16x32_bf16 v[116:119], a[12:15], a[228:231], v[116:119]
ds_read_b128 a[196:199], v23 offset:0
v_mfma_f32_16x16x32_bf16 v[148:151], a[8:11], a[232:235], v[148:151]
ds_read_b64_tr_b16 a[26:27], v19 offset:17416
v_mfma_f32_16x16x32_bf16 v[148:151], a[12:15], a[236:239], v[148:151]
ds_read_b128 a[200:203], v22 offset:2048
v_mfma_f32_16x16x32_bf16 v[180:183], a[8:11], a[240:243], v[180:183]
ds_read_b64_tr_b16 a[28:29], v19 offset:24584
v_mfma_f32_16x16x32_bf16 v[180:183], a[12:15], a[244:247], v[180:183]
ds_read_b128 a[204:207], v23 offset:2048
v_mfma_f32_16x16x32_bf16 v[212:215], a[8:11], a[248:251], v[212:215]
ds_read_b64_tr_b16 a[30:31], v19 offset:25608
v_mfma_f32_16x16x32_bf16 v[212:215], a[12:15], a[252:255], v[212:215]
s_mov_b32 s35, 0
s_cmp_lg_u32 s28, 0
s_cbranch_scc1 APOLLW
s_waitcnt vmcnt(14)
s_mov_b32 s32, 0x100000
APOLL:
v_cmp_gt_u32 vcc, 32, v252
s_sub_u32 s32, s32, 1
s_cbranch_scc1 APOLL_OK
s_cbranch_vccz APOLL_OK
s_sleep 1
buffer_load_dword v252, v253, s[64:67], 0 offen sc1
s_waitcnt vmcnt(0)
s_branch APOLL
APOLL_OK:
APOLLW:
s_barrier
s_cmp_lg_u32 s28, 0
s_cbranch_scc1 KEYW
v_mov_b32 v94, 16384
ds_read_b32 v95, v94
s_lshr_b32 s72, s2, 3
s_lshl_b32 s72, s72, 5
s_and_b32 s73, s2, 7
s_add_u32 s72, s72, s73
s_lshl_b32 s72, s72, 2
s_add_u32 s72, s72, 3145728
v_mov_b32 v94, s72
s_waitcnt lgkmcnt(0)
KEYW:
v_mfma_f32_16x16x32_bf16 v[120:123], a[16:19], a[224:227], v[120:123]
s_waitcnt lgkmcnt(4)
s_add_u32 m0, s33, 65536
ds_read_b64_tr_b16 a[0:1], v16 offset:32768
v_mfma_f32_16x16x32_bf16 v[120:123], a[20:23], a[228:231], v[120:123]
buffer_load_dwordx4 v2, s[8:11], s35 offen offset:0 sc1 lds
v_mfma_f32_16x16x32_bf16 v[152:155], a[16:19], a[232:235], v[152:155]
ds_read_b64_tr_b16 a[2:3], v16 offset:33792
v_and_b32 v252, 15, v0
v_lshlrev_b32 v252, 4, v252
v_mfma_f32_16x16x32_bf16 v[152:155], a[20:23], a[236:239], v[152:155]
s_lshl_b32 s72, s30, 8
s_add_u32 s72, s72, 3162112
ds_read_b128 a[208:211], v22 offset:4096
v_mfma_f32_16x16x32_bf16 v[184:187], a[16:19], a[240:243], v[184:187]
ds_read_b64_tr_b16 a[4:5], v16 offset:40960
buffer_load_dwordx2 v[244:245], v252, s[24:27], s72 offen offset:0 sc1
v_mfma_f32_16x16x32_bf16 v[184:187], a[20:23], a[244:247], v[184:187]
ds_read_b128 a[212:215], v23 offset:4096
v_mfma_f32_16x16x32_bf16 v[216:219], a[16:19], a[248:251], v[216:219]
ds_read_b64_tr_b16 a[6:7], v16 offset:41984
buffer_load_dwordx2 v[246:247], v252, s[24:27], s72 offen offset:256 sc1
v_mfma_f32_16x16x32_bf16 v[216:219], a[20:23], a[252:255], v[216:219]
ds_read_b128 a[216:219], v22 offset:6144
v_mfma_f32_16x16x32_bf16 v[124:127], a[24:27], a[224:227], v[124:127]
s_waitcnt lgkmcnt(5)
s_add_u32 m0, s33, 65536
ds_read_b64_tr_b16 a[8:9], v16 offset:32776
v_mfma_f32_16x16x32_bf16 v[124:127], a[28:31], a[228:231], v[124:127]
buffer_load_dwordx4 v2, s[8:11], s35 offen offset:1024 sc1 lds
v_mfma_f32_16x16x32_bf16 v[156:159], a[24:27], a[232:235], v[156:159]
ds_read_b64_tr_b16 a[10:11], v16 offset:33800
v_mfma_f32_16x16x32_bf16 v[156:159], a[28:31], a[236:239], v[156:159]
ds_read_b128 a[220:223], v23 offset:6144
v_mfma_f32_16x16x32_bf16 v[188:191], a[24:27], a[240:243], v[188:191]
ds_read_b64_tr_b16 a[12:13], v16 offset:40968
v_mfma_f32_16x16x32_bf16 v[188:191], a[28:31], a[244:247], v[188:191]
buffer_load_dwordx2 v[248:249], v252, s[24:27], s72 offen offset:512 sc1
v_mfma_f32_16x16x32_bf16 v[220:223], a[24:27], a[248:251], v[220:223]
ds_read_b64_tr_b16 a[14:15], v16 offset:41992
v_mfma_f32_16x16x32_bf16 v[220:223], a[28:31], a[252:255], v[220:223]
buffer_load_dwordx2 v[250:251], v252, s[24:27], s72 offen offset:768 sc1
v_mfma_f32_16x16x32_bf16 v[96:99], a[0:3], a[192:195], v[96:99]
s_waitcnt lgkmcnt(3)
ds_read_b64_tr_b16 a[16:17], v17 offset:32768
v_mfma_f32_16x16x32_bf16 v[96:99], a[4:7], a[196:199], v[96:99]
s_mov_b32 s34, 16384
v_mfma_f32_16x16x32_bf16 v[128:131], a[0:3], a[200:203], v[128:131]
s_add_u32 m0, s33, 16384
ds_read_b64_tr_b16 a[18:19], v17 offset:33792
v_mfma_f32_16x16x32_bf16 v[128:131], a[4:7], a[204:207], v[128:131]
buffer_load_dwordx4 v1, s[4:7], s34 offen offset:0 sc1 lds
v_mfma_f32_16x16x32_bf16 v[160:163], a[0:3], a[208:211], v[160:163]
ds_read_b64_tr_b16 a[20:21], v17 offset:40960
v_mfma_f32_16x16x32_bf16 v[160:163], a[4:7], a[212:215], v[160:163]
v_mfma_f32_16x16x32_bf16 v[192:195], a[0:3], a[216:219], v[192:195]
s_waitcnt lgkmcnt(2)
ds_read_b64_tr_b16 a[22:23], v17 offset:41984
v_mfma_f32_16x16x32_bf16 v[192:195], a[4:7], a[220:223], v[192:195]
v_mfma_f32_16x16x32_bf16 v[224:227], a[0:3], v[26:29], v[224:227]
v_mfma_f32_16x16x32_bf16 v[224:227], a[4:7], v[26:29], v[224:227]
s_mov_b32 s35, 0
v_mfma_f32_16x16x32_bf16 v[100:103], a[8:11], a[192:195], v[100:103]
s_add_u32 m0, s33, 65536
ds_read_b64_tr_b16 a[24:25], v17 offset:32776
v_mfma_f32_16x16x32_bf16 v[100:103], a[12:15], a[196:199], v[100:103]
buffer_load_dwordx4 v2, s[8:11], s35 offen offset:2048 sc1 lds
v_mfma_f32_16x16x32_bf16 v[132:135], a[8:11], a[200:203], v[132:135]
ds_read_b64_tr_b16 a[26:27], v17 offset:33800
v_mfma_f32_16x16x32_bf16 v[132:135], a[12:15], a[204:207], v[132:135]
v_mfma_f32_16x16x32_bf16 v[164:167], a[8:11], a[208:211], v[164:167]
s_add_u32 m0, s33, 16384
ds_read_b64_tr_b16 a[28:29], v17 offset:40968
v_mfma_f32_16x16x32_bf16 v[164:167], a[12:15], a[212:215], v[164:167]
buffer_load_dwordx4 v1, s[4:7], s34 offen offset:1024 sc1 lds
v_mfma_f32_16x16x32_bf16 v[196:199], a[8:11], a[216:219], v[196:199]
ds_read_b64_tr_b16 a[30:31], v17 offset:41992
v_mfma_f32_16x16x32_bf16 v[196:199], a[12:15], a[220:223], v[196:199]
v_mfma_f32_16x16x32_bf16 v[228:231], a[8:11], v[26:29], v[228:231]
s_add_u32 m0, s33, 65536
v_mfma_f32_16x16x32_bf16 v[228:231], a[12:15], v[26:29], v[228:231]
s_waitcnt lgkmcnt(2)
buffer_load_dwordx4 v2, s[8:11], s35 offen offset:3072 sc1 lds
v_mfma_f32_16x16x32_bf16 v[104:107], a[16:19], a[192:195], v[104:107]
ds_read_b64_tr_b16 a[0:1], v18 offset:32768
v_mfma_f32_16x16x32_bf16 v[104:107], a[20:23], a[196:199], v[104:107]
v_mfma_f32_16x16x32_bf16 v[136:139], a[16:19], a[200:203], v[136:139]
ds_read_b64_tr_b16 a[2:3], v18 offset:33792
v_mfma_f32_16x16x32_bf16 v[136:139], a[20:23], a[204:207], v[136:139]
v_mfma_f32_16x16x32_bf16 v[168:171], a[16:19], a[208:211], v[168:171]
ds_read_b64_tr_b16 a[4:5], v18 offset:40960
v_mfma_f32_16x16x32_bf16 v[168:171], a[20:23], a[212:215], v[168:171]
v_mfma_f32_16x16x32_bf16 v[200:203], a[16:19], a[216:219], v[200:203]
s_add_u32 m0, s33, 16384
ds_read_b64_tr_b16 a[6:7], v18 offset:41984
v_mfma_f32_16x16x32_bf16 v[200:203], a[20:23], a[220:223], v[200:203]
buffer_load_dwordx4 v1, s[4:7], s34 offen offset:2048 sc1 lds
v_mfma_f32_16x16x32_bf16 v[108:111], a[24:27], a[192:195], v[108:111]
s_waitcnt lgkmcnt(2)
ds_read_b64_tr_b16 a[8:9], v18 offset:32776
v_mfma_f32_16x16x32_bf16 v[108:111], a[28:31], a[196:199], v[108:111]
v_mfma_f32_16x16x32_bf16 v[140:143], a[24:27], a[200:203], v[140:143]
ds_read_b64_tr_b16 a[10:11], v18 offset:33800
v_mfma_f32_16x16x32_bf16 v[140:143], a[28:31], a[204:207], v[140:143]
v_mfma_f32_16x16x32_bf16 v[172:175], a[24:27], a[208:211], v[172:175]
ds_read_b64_tr_b16 a[12:13], v18 offset:40968
v_mfma_f32_16x16x32_bf16 v[172:175], a[28:31], a[212:215], v[172:175]
v_mfma_f32_16x16x32_bf16 v[204:207], a[24:27], a[216:219], v[204:207]
ds_read_b64_tr_b16 a[14:15], v18 offset:41992
v_mfma_f32_16x16x32_bf16 v[204:207], a[28:31], a[220:223], v[204:207]
v_mfma_f32_16x16x32_bf16 v[112:115], a[0:3], a[192:195], v[112:115]
s_waitcnt lgkmcnt(2)
ds_read_b64_tr_b16 a[16:17], v19 offset:32768
v_mfma_f32_16x16x32_bf16 v[112:115], a[4:7], a[196:199], v[112:115]
v_mfma_f32_16x16x32_bf16 v[144:147], a[0:3], a[200:203], v[144:147]
s_add_u32 m0, s33, 16384
ds_read_b64_tr_b16 a[18:19], v19 offset:33792
v_mfma_f32_16x16x32_bf16 v[144:147], a[4:7], a[204:207], v[144:147]
buffer_load_dwordx4 v1, s[4:7], s34 offen offset:3072 sc1 lds
v_mfma_f32_16x16x32_bf16 v[176:179], a[0:3], a[208:211], v[176:179]
ds_read_b64_tr_b16 a[20:21], v19 offset:40960
v_mfma_f32_16x16x32_bf16 v[176:179], a[4:7], a[212:215], v[176:179]
v_mfma_f32_16x16x32_bf16 v[208:211], a[0:3], a[216:219], v[208:211]
ds_read_b64_tr_b16 a[22:23], v19 offset:41984
v_mfma_f32_16x16x32_bf16 v[208:211], a[4:7], a[220:223], v[208:211]
s_waitcnt vmcnt(12)
ds_read_b128 a[224:227], v24 offset:0
v_mfma_f32_16x16x32_bf16 v[116:119], a[8:11], a[192:195], v[116:119]
s_waitcnt lgkmcnt(3)
ds_read_b64_tr_b16 a[24:25], v19 offset:32776
v_mfma_f32_16x16x32_bf16 v[116:119], a[12:15], a[196:199], v[116:119]
ds_read_b128 a[228:231], v25 offset:0
v_mfma_f32_16x16x32_bf16 v[148:151], a[8:11], a[200:203], v[148:151]
ds_read_b64_tr_b16 a[26:27], v19 offset:33800
v_mfma_f32_16x16x32_bf16 v[148:151], a[12:15], a[204:207], v[148:151]
ds_read_b128 a[232:235], v24 offset:2048
v_mfma_f32_16x16x32_bf16 v[180:183], a[8:11], a[208:211], v[180:183]
ds_read_b64_tr_b16 a[28:29], v19 offset:40968
v_mfma_f32_16x16x32_bf16 v[180:183], a[12:15], a[212:215], v[180:183]
ds_read_b128 a[236:239], v25 offset:2048
v_mfma_f32_16x16x32_bf16 v[212:215], a[8:11], a[216:219], v[212:215]
ds_read_b64_tr_b16 a[30:31], v19 offset:41992
v_mfma_f32_16x16x32_bf16 v[212:215], a[12:15], a[220:223], v[212:215]
s_mov_b32 s35, 16384
s_barrier
s_cmp_lg_u32 s28, 0
s_cbranch_scc1 KEYS
buffer_store_dword v95, v94, s[24:27], 0 offen sc1
KEYS:
v_mfma_f32_16x16x32_bf16 v[120:123], a[16:19], a[192:195], v[120:123]
s_waitcnt lgkmcnt(4)
s_add_u32 m0, s33, 81920
ds_read_b64_tr_b16 a[0:1], v16 offset:49152
v_mfma_f32_16x16x32_bf16 v[120:123], a[20:23], a[196:199], v[120:123]
buffer_load_dwordx4 v2, s[8:11], s35 offen offset:0 sc1 lds
v_mfma_f32_16x16x32_bf16 v[152:155], a[16:19], a[200:203], v[152:155]
ds_read_b64_tr_b16 a[2:3], v16 offset:50176
v_mfma_f32_16x16x32_bf16 v[152:155], a[20:23], a[204:207], v[152:155]
ds_read_b128 a[240:243], v24 offset:4096
v_mfma_f32_16x16x32_bf16 v[184:187], a[16:19], a[208:211], v[184:187]
ds_read_b64_tr_b16 a[4:5], v16 offset:57344
buffer_store_dwordx2 v[40:41], v34, s[24:27], 0 offen offset:0 sc1
v_mfma_f32_16x16x32_bf16 v[184:187], a[20:23], a[212:215], v[184:187]
ds_read_b128 a[244:247], v25 offset:4096
v_mfma_f32_16x16x32_bf16 v[216:219], a[16:19], a[216:219], v[216:219]
ds_read_b64_tr_b16 a[6:7], v16 offset:58368
buffer_store_dwordx2 v[42:43], v34, s[24:27], 0 offen offset:256 sc1
v_mfma_f32_16x16x32_bf16 v[216:219], a[20:23], a[220:223], v[216:219]
ds_read_b128 a[248:251], v24 offset:6144
v_mfma_f32_16x16x32_bf16 v[124:127], a[24:27], a[192:195], v[124:127]
s_waitcnt lgkmcnt(5)
s_add_u32 m0, s33, 81920
ds_read_b64_tr_b16 a[8:9], v16 offset:49160
buffer_store_dwordx2 v[44:45], v34, s[24:27], 0 offen offset:512 sc1
v_mfma_f32_16x16x32_bf16 v[124:127], a[28:31], a[196:199], v[124:127]
buffer_load_dwordx4 v2, s[8:11], s35 offen offset:1024 sc1 lds
v_mfma_f32_16x16x32_bf16 v[156:159], a[24:27], a[200:203], v[156:159]
ds_read_b64_tr_b16 a[10:11], v16 offset:50184
v_mfma_f32_16x16x32_bf16 v[156:159], a[28:31], a[204:207], v[156:159]
ds_read_b128 a[252:255], v25 offset:6144
v_mfma_f32_16x16x32_bf16 v[188:191], a[24:27], a[208:211], v[188:191]
ds_read_b64_tr_b16 a[12:13], v16 offset:57352
buffer_store_dwordx2 v[46:47], v34, s[24:27], 0 offen offset:768 sc1
v_mfma_f32_16x16x32_bf16 v[188:191], a[28:31], a[212:215], v[188:191]
v_mfma_f32_16x16x32_bf16 v[220:223], a[24:27], a[216:219], v[220:223]
ds_read_b64_tr_b16 a[14:15], v16 offset:58376
buffer_store_dwordx2 v[48:49], v34, s[24:27], 0 offen offset:1024 sc1
v_mfma_f32_16x16x32_bf16 v[220:223], a[28:31], a[220:223], v[220:223]
buffer_store_dword v83, v37, s[24:27], 0 offen sc1
v_mfma_f32_16x16x32_bf16 v[96:99], a[0:3], a[224:227], v[96:99]
s_waitcnt lgkmcnt(3)
s_waitcnt vmcnt(14)
ds_read_b64_tr_b16 a[16:17], v17 offset:49152
v_mfma_f32_16x16x32_bf16 v[96:99], a[4:7], a[228:231], v[96:99]
s_mov_b32 s35, 16384
v_mfma_f32_16x16x32_bf16 v[128:131], a[0:3], a[232:235], v[128:131]
s_add_u32 m0, s33, 81920
ds_read_b64_tr_b16 a[18:19], v17 offset:50176
v_mfma_f32_16x16x32_bf16 v[128:131], a[4:7], a[236:239], v[128:131]
buffer_load_dwordx4 v2, s[8:11], s35 offen offset:2048 sc1 lds
v_mfma_f32_16x16x32_bf16 v[160:163], a[0:3], a[240:243], v[160:163]
ds_read_b64_tr_b16 a[20:21], v17 offset:57344
v_mfma_f32_16x16x32_bf16 v[160:163], a[4:7], a[244:247], v[160:163]
v_mfma_f32_16x16x32_bf16 v[192:195], a[0:3], a[248:251], v[192:195]
s_waitcnt lgkmcnt(2)
s_add_u32 m0, s33, 81920
ds_read_b64_tr_b16 a[22:23], v17 offset:58368
v_mfma_f32_16x16x32_bf16 v[192:195], a[4:7], a[252:255], v[192:195]
buffer_load_dwordx4 v2, s[8:11], s35 offen offset:3072 sc1 lds
v_mfma_f32_16x16x32_bf16 v[224:227], a[0:3], v[26:29], v[224:227]
v_mfma_f32_16x16x32_bf16 v[224:227], a[4:7], v[26:29], v[224:227]
s_barrier
v_mfma_f32_16x16x32_bf16 v[100:103], a[8:11], a[224:227], v[100:103]
ds_read_b64_tr_b16 a[24:25], v17 offset:49160
v_mfma_f32_16x16x32_bf16 v[100:103], a[12:15], a[228:231], v[100:103]
s_mov_b32 s34, 32768
ds_read_b128 a[128:131], v4 offset:0
v_mfma_f32_16x16x32_bf16 v[132:135], a[8:11], a[232:235], v[132:135]
s_add_u32 m0, s33, 32768
ds_read_b64_tr_b16 a[26:27], v17 offset:50184
v_mul_f32 v96, v244, v96
v_mfma_f32_16x16x32_bf16 v[132:135], a[12:15], a[236:239], v[132:135]
buffer_load_dwordx4 v1, s[4:7], s34 offen offset:0 sc1 lds
v_mfma_f32_16x16x32_bf16 v[164:167], a[8:11], a[240:243], v[164:167]
ds_read_b64_tr_b16 a[28:29], v17 offset:57352
v_mul_f32 v97, v244, v97
v_mfma_f32_16x16x32_bf16 v[164:167], a[12:15], a[244:247], v[164:167]
ds_read_b128 a[132:135], v5 offset:0
v_mul_f32 v98, v244, v98
v_mfma_f32_16x16x32_bf16 v[196:199], a[8:11], a[248:251], v[196:199]
ds_read_b64_tr_b16 a[30:31], v17 offset:58376
v_mul_f32 v99, v244, v99
v_mfma_f32_16x16x32_bf16 v[196:199], a[12:15], a[252:255], v[196:199]
s_add_u32 m0, s33, 32768
v_mul_f32 v128, v246, v128
v_mul_f32 v129, v246, v129
v_mfma_f32_16x16x32_bf16 v[228:231], a[8:11], v[26:29], v[228:231]
buffer_load_dwordx4 v1, s[4:7], s34 offen offset:1024 sc1 lds
v_mfma_f32_16x16x32_bf16 v[228:231], a[12:15], v[26:29], v[228:231]
s_waitcnt lgkmcnt(3)
ds_read_b128 a[136:139], v6 offset:0
v_mul_f32 v130, v246, v130
v_mfma_f32_16x16x32_bf16 v[104:107], a[16:19], a[224:227], v[104:107]
ds_read_b64_tr_b16 a[0:1], v18 offset:49152
v_mul_f32 v131, v246, v131
v_mfma_f32_16x16x32_bf16 v[104:107], a[20:23], a[228:231], v[104:107]
ds_read_b128 a[140:143], v7 offset:0
v_mfma_f32_16x16x32_bf16 v[136:139], a[16:19], a[232:235], v[136:139]
s_add_u32 m0, s33, 32768
ds_read_b64_tr_b16 a[2:3], v18 offset:50176
v_mul_f32 v100, v244, v100
v_mfma_f32_16x16x32_bf16 v[136:139], a[20:23], a[236:239], v[136:139]
buffer_load_dwordx4 v1, s[4:7], s34 offen offset:2048 sc1 lds
v_mfma_f32_16x16x32_bf16 v[168:171], a[16:19], a[240:243], v[168:171]
ds_read_b64_tr_b16 a[4:5], v18 offset:57344
v_lshrrev_b32 v252, 4, v0
v_lshlrev_b32 v252, 4, v252
s_lshl_b32 s72, s28, 7
s_add_u32 s72, s72, 163328
v_add_u32 v253, s72, v252
v_mov_b32 v254, 155136
v_mov_b32 v255, 0
v_mfma_f32_16x16x32_bf16 v[168:171], a[20:23], a[244:247], v[168:171]
ds_read_b128 a[144:147], v4 offset:1024
v_mul_f32 v101, v244, v101
v_mfma_f32_16x16x32_bf16 v[200:203], a[16:19], a[248:251], v[200:203]
ds_read_b64_tr_b16 a[6:7], v18 offset:58368
ds_write_b128 v253, v[224:227]
ds_write_b128 v253, v[228:231] offset:64
ds_write_b32 v254, v255
v_mfma_f32_16x16x32_bf16 v[200:203], a[20:23], a[252:255], v[200:203]
s_add_u32 m0, s33, 32768
ds_read_b128 a[148:151], v5 offset:1024
v_mul_f32 v102, v244, v102
v_mfma_f32_16x16x32_bf16 v[108:111], a[24:27], a[224:227], v[108:111]
s_waitcnt lgkmcnt(4)
ds_read_b64_tr_b16 a[8:9], v18 offset:49160
buffer_load_dwordx4 v1, s[4:7], s34 offen offset:3072 sc1 lds
v_mfma_f32_16x16x32_bf16 v[108:111], a[28:31], a[228:231], v[108:111]
v_mul_f32 v103, v244, v103
v_mul_f32 v132, v246, v132
v_mfma_f32_16x16x32_bf16 v[140:143], a[24:27], a[232:235], v[140:143]
ds_read_b64_tr_b16 a[10:11], v18 offset:50184
v_mul_f32 v133, v246, v133
v_mfma_f32_16x16x32_bf16 v[140:143], a[28:31], a[236:239], v[140:143]
s_mov_b32 s35, 32768
ds_read_b128 a[152:155], v6 offset:1024
v_mul_f32 v134, v246, v134
v_mfma_f32_16x16x32_bf16 v[172:175], a[24:27], a[240:243], v[172:175]
s_add_u32 m0, s33, 98304
ds_read_b64_tr_b16 a[12:13], v18 offset:57352
v_mul_f32 v135, v246, v135
v_mfma_f32_16x16x32_bf16 v[172:175], a[28:31], a[244:247], v[172:175]
buffer_load_dwordx4 v2, s[8:11], s35 offen offset:0 sc1 lds
v_mfma_f32_16x16x32_bf16 v[204:207], a[24:27], a[248:251], v[204:207]
ds_read_b64_tr_b16 a[14:15], v18 offset:58376
s_waitcnt lgkmcnt(0)
s_barrier
v_mfma_f32_16x16x32_bf16 v[204:207], a[28:31], a[252:255], v[204:207]
ds_read_b128 a[156:159], v7 offset:1024
v_mul_f32 v104, v244, v104
v_mfma_f32_16x16x32_bf16 v[112:115], a[0:3], a[224:227], v[112:115]
s_waitcnt lgkmcnt(4)
ds_read_b64_tr_b16 a[16:17], v19 offset:49152
s_lshl_b32 s72, s76, 5
s_add_u32 s72, s72, 163328
v_add_u32 v28, s72, v252
v_mfma_f32_16x16x32_bf16 v[112:115], a[4:7], a[228:231], v[112:115]
s_add_u32 m0, s33, 98304
v_mul_f32 v105, v244, v105
v_mul_f32 v106, v244, v106
v_mfma_f32_16x16x32_bf16 v[144:147], a[0:3], a[232:235], v[144:147]
ds_read_b64_tr_b16 a[18:19], v19 offset:50176
buffer_load_dwordx4 v2, s[8:11], s35 offen offset:1024 sc1 lds
s_lshl_b32 s72, s77, 5
s_add_u32 s72, s72, 163328
v_add_u32 v29, s72, v252
v_mfma_f32_16x16x32_bf16 v[144:147], a[4:7], a[236:239], v[144:147]
ds_read_b128 a[160:163], v4 offset:2048
v_mul_f32 v107, v244, v107
v_mfma_f32_16x16x32_bf16 v[176:179], a[0:3], a[240:243], v[176:179]
ds_read_b64_tr_b16 a[20:21], v19 offset:57344
s_lshl_b32 s72, s78, 5
s_add_u32 s72, s72, 163328
v_add_u32 v254, s72, v252
v_mfma_f32_16x16x32_bf16 v[176:179], a[4:7], a[244:247], v[176:179]
ds_read_b128 a[164:167], v5 offset:2048
v_mul_f32 v136, v246, v136
v_mfma_f32_16x16x32_bf16 v[208:211], a[0:3], a[248:251], v[208:211]
s_add_u32 m0, s33, 98304
ds_read_b64_tr_b16 a[22:23], v19 offset:58368
s_lshl_b32 s72, s79, 5
s_add_u32 s72, s72, 163328
v_add_u32 v255, s72, v252
v_mfma_f32_16x16x32_bf16 v[208:211], a[4:7], a[252:255], v[208:211]
buffer_load_dwordx4 v2, s[8:11], s35 offen offset:2048 sc1 lds
v_mfma_f32_16x16x32_bf16 v[116:119], a[8:11], a[224:227], v[116:119]
s_waitcnt lgkmcnt(4)
ds_read_b64_tr_b16 a[24:25], v19 offset:49160
ds_read_b128 v[224:227], v28 offset:0
v_mfma_f32_16x16x32_bf16 v[116:119], a[12:15], a[228:231], v[116:119]
ds_read_b128 a[168:171], v6 offset:2048
v_mul_f32 v137, v246, v137
v_mfma_f32_16x16x32_bf16 v[148:151], a[8:11], a[232:235], v[148:151]
ds_read_b64_tr_b16 a[26:27], v19 offset:50184
ds_read_b128 v[228:231], v28 offset:64
v_mfma_f32_16x16x32_bf16 v[148:151], a[12:15], a[236:239], v[148:151]
s_add_u32 m0, s33, 98304
ds_read_b128 a[172:175], v7 offset:2048
v_mul_f32 v138, v246, v138
v_mfma_f32_16x16x32_bf16 v[180:183], a[8:11], a[240:243], v[180:183]
ds_read_b64_tr_b16 a[28:29], v19 offset:57352
buffer_load_dwordx4 v2, s[8:11], s35 offen offset:3072 sc1 lds
v_mfma_f32_16x16x32_bf16 v[180:183], a[12:15], a[244:247], v[180:183]
ds_read_b128 v[232:235], v29 offset:0
v_mul_f32 v139, v246, v139
v_mfma_f32_16x16x32_bf16 v[212:215], a[8:11], a[248:251], v[212:215]
ds_read_b64_tr_b16 a[30:31], v19 offset:58376
ds_read_b128 v[236:239], v29 offset:64
v_mfma_f32_16x16x32_bf16 v[212:215], a[12:15], a[252:255], v[212:215]
s_mov_b32 s34, 49152
ds_read_b128 a[176:179], v4 offset:3072
v_mul_f32 v108, v244, v108
v_mfma_f32_16x16x32_bf16 v[120:123], a[16:19], a[224:227], v[120:123]
s_waitcnt lgkmcnt(6)
s_add_u32 m0, s33, 49152
ds_read_b128 v[240:243], v254 offset:0
v_mul_f32 v109, v244, v109
v_mfma_f32_16x16x32_bf16 v[120:123], a[20:23], a[228:231], v[120:123]
buffer_load_dwordx4 v1, s[4:7], s34 offen offset:0 sc1 lds
v_mfma_f32_16x16x32_bf16 v[152:155], a[16:19], a[232:235], v[152:155]
v_mul_f32 v110, v244, v110
v_mul_f32 v111, v244, v111
v_mfma_f32_16x16x32_bf16 v[152:155], a[20:23], a[236:239], v[152:155]
ds_read_b128 a[180:183], v5 offset:3072
v_mul_f32 v140, v246, v140
v_mfma_f32_16x16x32_bf16 v[184:187], a[16:19], a[240:243], v[184:187]
v_mul_f32 v141, v246, v141
v_mul_f32 v142, v246, v142
v_mfma_f32_16x16x32_bf16 v[184:187], a[20:23], a[244:247], v[184:187]
s_add_u32 m0, s33, 49152
ds_read_b128 a[184:187], v6 offset:3072
v_mul_f32 v143, v246, v143
v_mfma_f32_16x16x32_bf16 v[216:219], a[16:19], a[248:251], v[216:219]
buffer_load_dwordx4 v1, s[4:7], s34 offen offset:1024 sc1 lds
v_mfma_f32_16x16x32_bf16 v[216:219], a[20:23], a[252:255], v[216:219]
ds_read_b128 v[16:19], v254 offset:64
v_mul_f32 v112, v244, v112
v_mfma_f32_16x16x32_bf16 v[124:127], a[24:27], a[224:227], v[124:127]
s_waitcnt lgkmcnt(3)
ds_read_b128 a[188:191], v7 offset:3072
v_mul_f32 v113, v244, v113
v_mfma_f32_16x16x32_bf16 v[124:127], a[28:31], a[228:231], v[124:127]
s_add_u32 m0, s33, 49152
ds_read_b128 v[20:23], v255 offset:0
v_mul_f32 v114, v244, v114
v_mfma_f32_16x16x32_bf16 v[156:159], a[24:27], a[232:235], v[156:159]
buffer_load_dwordx4 v1, s[4:7], s34 offen offset:2048 sc1 lds
v_mfma_f32_16x16x32_bf16 v[156:159], a[28:31], a[236:239], v[156:159]
ds_read_b128 v[24:27], v255 offset:64
v_mul_f32 v115, v244, v115
v_mfma_f32_16x16x32_bf16 v[188:191], a[24:27], a[240:243], v[188:191]
v_mul_f32 v144, v246, v144
v_mul_f32 v145, v246, v145
v_mfma_f32_16x16x32_bf16 v[188:191], a[28:31], a[244:247], v[188:191]
s_add_u32 m0, s33, 49152
v_mul_f32 v146, v246, v146
v_mul_f32 v147, v246, v147
v_mfma_f32_16x16x32_bf16 v[220:223], a[24:27], a[248:251], v[220:223]
buffer_load_dwordx4 v1, s[4:7], s34 offen offset:3072 sc1 lds
v_mfma_f32_16x16x32_bf16 v[220:223], a[28:31], a[252:255], v[220:223]
s_mov_b32 s34, 0x10000
s_mov_b32 s35, 0xc000
s_waitcnt lgkmcnt(0)
v_fmac_f32 v96, v224, v245
v_fmac_f32 v97, v225, v245
v_fmac_f32 v98, v226, v245
v_fmac_f32 v99, v227, v245
v_cvt_pk_bf16_f32 v32, v96, v97
v_cvt_pk_bf16_f32 v33, v98, v99
v_fmac_f32 v100, v228, v245
v_fmac_f32 v101, v229, v245
v_fmac_f32 v102, v230, v245
v_fmac_f32 v103, v231, v245
v_cvt_pk_bf16_f32 v34, v100, v101
v_cvt_pk_bf16_f32 v35, v102, v103
v_fmac_f32 v104, v232, v245
v_fmac_f32 v105, v233, v245
v_fmac_f32 v106, v234, v245
v_fmac_f32 v107, v235, v245
v_cvt_pk_bf16_f32 v36, v104, v105
v_cvt_pk_bf16_f32 v37, v106, v107
v_fmac_f32 v108, v236, v245
v_fmac_f32 v109, v237, v245
v_fmac_f32 v110, v238, v245
v_fmac_f32 v111, v239, v245
v_cvt_pk_bf16_f32 v38, v108, v109
v_cvt_pk_bf16_f32 v39, v110, v111
v_fmac_f32 v112, v240, v245
v_fmac_f32 v113, v241, v245
v_fmac_f32 v114, v242, v245
v_fmac_f32 v115, v243, v245
v_cvt_pk_bf16_f32 v40, v112, v113
v_cvt_pk_bf16_f32 v41, v114, v115
v_mfma_f32_16x16x32_bf16 v[112:115], a[128:131], v[32:35], 0
v_mul_f32 v116, v244, v116
v_mul_f32 v117, v244, v117
v_mfma_f32_16x16x32_bf16 v[112:115], a[132:135], v[36:39], v[112:115]
v_mul_f32 v118, v244, v118
v_mul_f32 v119, v244, v119
v_fmac_f32 v116, v16, v245
v_fmac_f32 v117, v17, v245
v_fmac_f32 v118, v18, v245
v_fmac_f32 v119, v19, v245
v_cvt_pk_bf16_f32 v42, v116, v117
v_cvt_pk_bf16_f32 v43, v118, v119
v_mul_f32 v120, v244, v120
v_mul_f32 v121, v244, v121
v_mfma_f32_16x16x32_bf16 v[112:115], a[136:139], v[40:43], v[112:115]
v_mul_f32 v122, v244, v122
v_mul_f32 v123, v244, v123
v_fmac_f32 v120, v20, v245
v_fmac_f32 v121, v21, v245
v_fmac_f32 v122, v22, v245
v_fmac_f32 v123, v23, v245
v_cvt_pk_bf16_f32 v44, v120, v121
v_cvt_pk_bf16_f32 v45, v122, v123
v_mul_f32 v124, v244, v124
v_mul_f32 v125, v244, v125
v_mul_f32 v126, v244, v126
v_mul_f32 v127, v244, v127
v_fmac_f32 v124, v24, v245
v_fmac_f32 v125, v25, v245
v_fmac_f32 v126, v26, v245
v_fmac_f32 v127, v27, v245
v_cvt_pk_bf16_f32 v46, v124, v125
v_cvt_pk_bf16_f32 v47, v126, v127
v_fmac_f32 v128, v224, v247
v_fmac_f32 v129, v225, v247
v_mfma_f32_16x16x32_bf16 v[112:115], a[140:143], v[44:47], v[112:115]
v_fmac_f32 v130, v226, v247
v_fmac_f32 v131, v227, v247
v_cvt_pk_bf16_f32 v48, v128, v129
v_cvt_pk_bf16_f32 v49, v130, v131
v_fmac_f32 v132, v228, v247
v_fmac_f32 v133, v229, v247
v_fmac_f32 v134, v230, v247
v_fmac_f32 v135, v231, v247
v_cvt_pk_bf16_f32 v50, v132, v133
v_cvt_pk_bf16_f32 v51, v134, v135
v_fmac_f32 v136, v232, v247
v_fmac_f32 v137, v233, v247
v_mfma_f32_16x16x32_bf16 v[116:119], a[128:131], v[48:51], 0
v_fmac_f32 v138, v234, v247
v_fmac_f32 v139, v235, v247
v_cvt_pk_bf16_f32 v52, v136, v137
v_cvt_pk_bf16_f32 v53, v138, v139
v_fmac_f32 v140, v236, v247
v_fmac_f32 v141, v237, v247
v_fmac_f32 v142, v238, v247
v_fmac_f32 v143, v239, v247
v_cvt_pk_bf16_f32 v54, v140, v141
v_cvt_pk_bf16_f32 v55, v142, v143
v_fmac_f32 v144, v240, v247
v_fmac_f32 v145, v241, v247
v_mfma_f32_16x16x32_bf16 v[116:119], a[132:135], v[52:55], v[116:119]
v_fmac_f32 v146, v242, v247
v_fmac_f32 v147, v243, v247
v_cvt_pk_bf16_f32 v56, v144, v145
v_cvt_pk_bf16_f32 v57, v146, v147
v_mul_f32 v148, v246, v148
v_mul_f32 v149, v246, v149
v_mul_f32 v150, v246, v150
v_mul_f32 v151, v246, v151
v_fmac_f32 v148, v16, v247
v_fmac_f32 v149, v17, v247
v_fmac_f32 v150, v18, v247
v_fmac_f32 v151, v19, v247
v_cvt_pk_bf16_f32 v58, v148, v149
v_cvt_pk_bf16_f32 v59, v150, v151
v_mul_f32 v152, v246, v152
v_mul_f32 v153, v246, v153
v_mfma_f32_16x16x32_bf16 v[116:119], a[136:139], v[56:59], v[116:119]
v_mul_f32 v154, v246, v154
v_mul_f32 v155, v246, v155
v_fmac_f32 v152, v20, v247
v_fmac_f32 v153, v21, v247
v_fmac_f32 v154, v22, v247
v_fmac_f32 v155, v23, v247
v_cvt_pk_bf16_f32 v60, v152, v153
v_cvt_pk_bf16_f32 v61, v154, v155
v_mul_f32 v156, v246, v156
v_mul_f32 v157, v246, v157
v_mul_f32 v158, v246, v158
v_mul_f32 v159, v246, v159
v_fmac_f32 v156, v24, v247
v_fmac_f32 v157, v25, v247
v_fmac_f32 v158, v26, v247
v_fmac_f32 v159, v27, v247
v_cvt_pk_bf16_f32 v62, v156, v157
v_cvt_pk_bf16_f32 v63, v158, v159
v_max3_f32 v112, v112, v113, v114
v_max_f32 v112, v112, v115
v_mfma_f32_16x16x32_bf16 v[116:119], a[140:143], v[60:63], v[116:119]
v_mov_b32 v113, v112
v_mul_f32 v160, v248, v160
v_mul_f32 v161, v248, v161
v_permlane16_swap_b32 v112, v113
v_max_f32 v112, v112, v113
v_mov_b32 v113, v112
v_mul_f32 v162, v248, v162
v_mul_f32 v163, v248, v163
v_permlane32_swap_b32 v112, v113
v_max_f32 v112, v112, v113
v_sub_f32 v144, 0, v112
v_sub_f32 v145, 0, v112
v_sub_f32 v146, 0, v112
v_sub_f32 v147, 0, v112
v_fmac_f32 v160, v224, v249
v_fmac_f32 v161, v225, v249
v_mfma_f32_16x16x32_bf16 v[96:99], a[128:131], v[32:35], v[144:147]
v_fmac_f32 v162, v226, v249
v_fmac_f32 v163, v227, v249
v_mfma_f32_16x16x32_bf16 v[96:99], a[132:135], v[36:39], v[96:99]
v_cvt_pk_bf16_f32 v64, v160, v161
v_cvt_pk_bf16_f32 v65, v162, v163
v_mfma_f32_16x16x32_bf16 v[96:99], a[136:139], v[40:43], v[96:99]
v_mul_f32 v164, v248, v164
v_mul_f32 v165, v248, v165
v_mfma_f32_16x16x32_bf16 v[96:99], a[140:143], v[44:47], v[96:99]
v_mul_f32 v166, v248, v166
v_mul_f32 v167, v248, v167
v_mfma_f32_16x16x32_bf16 v[100:103], a[156:159], v[44:47], v[144:147]
v_fmac_f32 v164, v228, v249
v_fmac_f32 v165, v229, v249
v_mfma_f32_16x16x32_bf16 v[100:103], a[152:155], v[40:43], v[100:103]
v_fmac_f32 v166, v230, v249
v_fmac_f32 v167, v231, v249
v_mfma_f32_16x16x32_bf16 v[100:103], a[148:151], v[36:39], v[100:103]
v_cvt_pk_bf16_f32 v66, v164, v165
v_cvt_pk_bf16_f32 v67, v166, v167
v_mfma_f32_16x16x32_bf16 v[100:103], a[144:147], v[32:35], v[100:103]
v_mul_f32 v168, v248, v168
v_mul_f32 v169, v248, v169
v_mfma_f32_16x16x32_bf16 v[104:107], a[160:163], v[32:35], v[144:147]
v_mul_f32 v170, v248, v170
v_mul_f32 v171, v248, v171
v_mfma_f32_16x16x32_bf16 v[104:107], a[164:167], v[36:39], v[104:107]
v_fmac_f32 v168, v232, v249
v_fmac_f32 v169, v233, v249
v_mfma_f32_16x16x32_bf16 v[104:107], a[168:171], v[40:43], v[104:107]
v_fmac_f32 v170, v234, v249
v_fmac_f32 v171, v235, v249
v_mfma_f32_16x16x32_bf16 v[104:107], a[172:175], v[44:47], v[104:107]
v_cvt_pk_bf16_f32 v68, v168, v169
v_cvt_pk_bf16_f32 v69, v170, v171
v_mfma_f32_16x16x32_bf16 v[108:111], a[188:191], v[44:47], v[144:147]
v_mul_f32 v172, v248, v172
v_mul_f32 v173, v248, v173
v_mfma_f32_16x16x32_bf16 v[108:111], a[184:187], v[40:43], v[108:111]
v_mul_f32 v174, v248, v174
v_mul_f32 v175, v248, v175
v_mfma_f32_16x16x32_bf16 v[108:111], a[180:183], v[36:39], v[108:111]
v_fmac_f32 v172, v236, v249
v_fmac_f32 v173, v237, v249
v_mfma_f32_16x16x32_bf16 v[108:111], a[176:179], v[32:35], v[108:111]
v_fmac_f32 v174, v238, v249
v_fmac_f32 v175, v239, v249
v_mfma_f32_16x16x32_bf16 v[136:139], a[128:131], v[64:67], 0
v_cvt_pk_bf16_f32 v70, v172, v173
v_cvt_pk_bf16_f32 v71, v174, v175
v_mul_f32 v176, v248, v176
v_mul_f32 v177, v248, v177
v_mfma_f32_16x16x32_bf16 v[136:139], a[132:135], v[68:71], v[136:139]
v_mul_f32 v178, v248, v178
v_mul_f32 v179, v248, v179
v_fmac_f32 v176, v240, v249
v_fmac_f32 v177, v241, v249
v_fmac_f32 v178, v242, v249
v_fmac_f32 v179, v243, v249
v_cvt_pk_bf16_f32 v72, v176, v177
v_cvt_pk_bf16_f32 v73, v178, v179
v_mul_f32 v180, v248, v180
v_mul_f32 v181, v248, v181
v_mul_f32 v182, v248, v182
v_mul_f32 v183, v248, v183
v_fmac_f32 v180, v16, v249
v_fmac_f32 v181, v17, v249
v_fmac_f32 v182, v18, v249
v_fmac_f32 v183, v19, v249
v_cvt_pk_bf16_f32 v74, v180, v181
v_cvt_pk_bf16_f32 v75, v182, v183
v_mul_f32 v184, v248, v184
v_mul_f32 v185, v248, v185
v_mfma_f32_16x16x32_bf16 v[136:139], a[136:139], v[72:75], v[136:139]
v_mul_f32 v186, v248, v186
v_mul_f32 v187, v248, v187
v_fmac_f32 v184, v20, v249
v_fmac_f32 v185, v21, v249
v_fmac_f32 v186, v22, v249
v_fmac_f32 v187, v23, v249
v_cvt_pk_bf16_f32 v76, v184, v185
v_cvt_pk_bf16_f32 v77, v186, v187
v_mul_f32 v188, v248, v188
v_mul_f32 v189, v248, v189
v_mul_f32 v190, v248, v190
v_mul_f32 v191, v248, v191
v_fmac_f32 v188, v24, v249
v_fmac_f32 v189, v25, v249
v_fmac_f32 v190, v26, v249
v_fmac_f32 v191, v27, v249
v_cvt_pk_bf16_f32 v78, v188, v189
v_cvt_pk_bf16_f32 v79, v190, v191
v_max3_f32 v116, v116, v117, v118
v_max_f32 v116, v116, v119
v_mfma_f32_16x16x32_bf16 v[136:139], a[140:143], v[76:79], v[136:139]
v_mov_b32 v117, v116
v_accvgpr_write_b32 a0, 0
v_accvgpr_write_b32 a1, 0
v_permlane16_swap_b32 v116, v117
v_max_f32 v116, v116, v117
v_mov_b32 v117, v116
v_accvgpr_write_b32 a2, 0
v_accvgpr_write_b32 a3, 0
v_permlane32_swap_b32 v116, v117
v_max_f32 v116, v116, v117
v_sub_f32 v148, 0, v116
v_sub_f32 v149, 0, v116
v_sub_f32 v150, 0, v116
v_sub_f32 v151, 0, v116
v_accvgpr_write_b32 a4, 0
v_accvgpr_write_b32 a5, 0
v_mfma_f32_16x16x32_bf16 v[112:115], a[128:131], v[48:51], v[148:151]
v_accvgpr_write_b32 a6, 0
v_accvgpr_write_b32 a7, 0
v_mfma_f32_16x16x32_bf16 v[112:115], a[132:135], v[52:55], v[112:115]
v_accvgpr_write_b32 a8, 0
v_accvgpr_write_b32 a9, 0
v_mfma_f32_16x16x32_bf16 v[112:115], a[136:139], v[56:59], v[112:115]
v_accvgpr_write_b32 a10, 0
v_accvgpr_write_b32 a11, 0
v_mfma_f32_16x16x32_bf16 v[112:115], a[140:143], v[60:63], v[112:115]
v_accvgpr_write_b32 a12, 0
v_accvgpr_write_b32 a13, 0
v_mfma_f32_16x16x32_bf16 v[116:119], a[156:159], v[60:63], v[148:151]
v_accvgpr_write_b32 a14, 0
v_accvgpr_write_b32 a15, 0
v_mfma_f32_16x16x32_bf16 v[116:119], a[152:155], v[56:59], v[116:119]
v_accvgpr_write_b32 a16, 0
v_accvgpr_write_b32 a17, 0
v_mfma_f32_16x16x32_bf16 v[116:119], a[148:151], v[52:55], v[116:119]
v_accvgpr_write_b32 a18, 0
v_accvgpr_write_b32 a19, 0
v_mfma_f32_16x16x32_bf16 v[116:119], a[144:147], v[48:51], v[116:119]
v_accvgpr_write_b32 a20, 0
v_accvgpr_write_b32 a21, 0
v_mfma_f32_16x16x32_bf16 v[120:123], a[160:163], v[48:51], v[148:151]
v_accvgpr_write_b32 a22, 0
v_accvgpr_write_b32 a23, 0
v_mfma_f32_16x16x32_bf16 v[120:123], a[164:167], v[52:55], v[120:123]
v_accvgpr_write_b32 a24, 0
v_accvgpr_write_b32 a25, 0
v_mfma_f32_16x16x32_bf16 v[120:123], a[168:171], v[56:59], v[120:123]
v_accvgpr_write_b32 a26, 0
v_accvgpr_write_b32 a27, 0
v_mfma_f32_16x16x32_bf16 v[120:123], a[172:175], v[60:63], v[120:123]
v_accvgpr_write_b32 a28, 0
v_accvgpr_write_b32 a29, 0
v_mfma_f32_16x16x32_bf16 v[124:127], a[188:191], v[60:63], v[148:151]
v_accvgpr_write_b32 a30, 0
v_accvgpr_write_b32 a31, 0
v_mfma_f32_16x16x32_bf16 v[124:127], a[184:187], v[56:59], v[124:127]
v_exp_f32 v96, v96
v_mfma_f32_16x16x32_bf16 v[124:127], a[180:183], v[52:55], v[124:127]
v_exp_f32 v97, v97
v_mfma_f32_16x16x32_bf16 v[124:127], a[176:179], v[48:51], v[124:127]
v_cvt_pk_bf16_f32 v128, v96, v97
v_exp_f32 v98, v98
v_exp_f32 v99, v99
v_exp_f32 v100, v100
v_cvt_pk_bf16_f32 v129, v98, v99
v_exp_f32 v101, v101
v_exp_f32 v102, v102
v_cvt_pk_bf16_f32 v130, v100, v101
v_exp_f32 v103, v103
v_exp_f32 v104, v104
v_cvt_pk_bf16_f32 v131, v102, v103
v_exp_f32 v105, v105
v_exp_f32 v106, v106
v_cvt_pk_bf16_f32 v132, v104, v105
v_exp_f32 v107, v107
v_exp_f32 v108, v108
v_cvt_pk_bf16_f32 v133, v106, v107
v_exp_f32 v109, v109
v_exp_f32 v110, v110
v_cvt_pk_bf16_f32 v134, v108, v109
v_exp_f32 v111, v111
v_max3_f32 v136, v136, v137, v138
v_cvt_pk_bf16_f32 v135, v110, v111
v_max_f32 v136, v136, v139
v_mov_b32 v137, v136
s_nop 0
s_nop 0
v_permlane16_swap_b32 v136, v137
v_max_f32 v136, v136, v137
v_mov_b32 v137, v136
s_nop 0
s_nop 0
v_permlane32_swap_b32 v136, v137
v_max_f32 v136, v136, v137
v_sub_f32 v152, 0, v136
v_sub_f32 v153, 0, v136
v_sub_f32 v154, 0, v136
v_sub_f32 v155, 0, v136
s_waitcnt vmcnt(14)
s_barrier
ds_read_b64_tr_b16 a[224:225], v8 offset:2048
ds_read_b64_tr_b16 a[192:193], v8 offset:0
ds_read_b64_tr_b16 a[198:199], v9 offset:1024
ds_read_b64_tr_b16 a[226:227], v8 offset:3072
ds_read_b64_tr_b16 a[196:197], v9 offset:0
ds_read_b64_tr_b16 a[230:231], v9 offset:3072
ds_read_b64_tr_b16 a[204:205], v11 offset:0
ds_read_b64_tr_b16 a[234:235], v10 offset:3072
ds_read_b64_tr_b16 a[240:241], v12 offset:2048
ds_read_b64_tr_b16 a[232:233], v10 offset:2048
ds_read_b64_tr_b16 a[202:203], v10 offset:1024
ds_read_b64_tr_b16 a[200:201], v10 offset:0
ds_read_b64_tr_b16 a[236:237], v11 offset:2048
ds_read_b64_tr_b16 a[214:215], v13 offset:1024
s_cmp_lg_u32 s28, 0
s_cbranch_scc1 BSIGW
s_and_b32 s72, s2, 1
s_lshl_b32 s72, s72, 7
s_add_u32 s72, s72, 40
s_mov_b64 exec, 1
v_mov_b32 v252, 1
v_mov_b32 v253, s72
buffer_atomic_add v252, v253, s[64:67], 0 offen sc1
s_mov_b64 exec, -1
BSIGW:
v_mul_f32 v192, v250, v192
v_mul_f32 v193, v250, v193
v_mul_f32 v194, v250, v194
v_mul_f32 v195, v250, v195
v_fmac_f32 v192, v224, v251
v_fmac_f32 v193, v225, v251
v_fmac_f32 v194, v226, v251
v_fmac_f32 v195, v227, v251
v_cvt_pk_bf16_f32 v80, v192, v193
v_cvt_pk_bf16_f32 v81, v194, v195
v_mul_f32 v196, v250, v196
v_mul_f32 v197, v250, v197
v_mul_f32 v198, v250, v198
v_mul_f32 v199, v250, v199
v_fmac_f32 v196, v228, v251
v_fmac_f32 v197, v229, v251
v_fmac_f32 v198, v230, v251
v_fmac_f32 v199, v231, v251
v_cvt_pk_bf16_f32 v82, v196, v197
v_cvt_pk_bf16_f32 v83, v198, v199
v_mul_f32 v200, v250, v200
v_mul_f32 v201, v250, v201
v_mfma_f32_16x16x32_bf16 v[140:143], a[128:131], v[80:83], 0
v_mul_f32 v202, v250, v202
v_mul_f32 v203, v250, v203
v_fmac_f32 v200, v232, v251
v_fmac_f32 v201, v233, v251
v_fmac_f32 v202, v234, v251
v_fmac_f32 v203, v235, v251
v_cvt_pk_bf16_f32 v84, v200, v201
v_cvt_pk_bf16_f32 v85, v202, v203
v_mul_f32 v204, v250, v204
v_mul_f32 v205, v250, v205
v_mul_f32 v206, v250, v206
v_mul_f32 v207, v250, v207
v_fmac_f32 v204, v236, v251
v_fmac_f32 v205, v237, v251
v_fmac_f32 v206, v238, v251
v_fmac_f32 v207, v239, v251
v_cvt_pk_bf16_f32 v86, v204, v205
v_cvt_pk_bf16_f32 v87, v206, v207
v_mul_f32 v208, v250, v208
v_mul_f32 v209, v250, v209
v_mfma_f32_16x16x32_bf16 v[140:143], a[132:135], v[84:87], v[140:143]
v_mul_f32 v210, v250, v210
v_mul_f32 v211, v250, v211
v_fmac_f32 v208, v240, v251
v_fmac_f32 v209, v241, v251
v_fmac_f32 v210, v242, v251
v_fmac_f32 v211, v243, v251
v_cvt_pk_bf16_f32 v88, v208, v209
v_cvt_pk_bf16_f32 v89, v210, v211
v_mul_f32 v212, v250, v212
v_mul_f32 v213, v250, v213
v_mul_f32 v214, v250, v214
v_mul_f32 v215, v250, v215
v_fmac_f32 v212, v16, v251
v_fmac_f32 v213, v17, v251
v_fmac_f32 v214, v18, v251
v_fmac_f32 v215, v19, v251
v_cvt_pk_bf16_f32 v90, v212, v213
v_cvt_pk_bf16_f32 v91, v214, v215
v_mul_f32 v216, v250, v216
v_mul_f32 v217, v250, v217
v_mfma_f32_16x16x32_bf16 v[140:143], a[136:139], v[88:91], v[140:143]
v_mul_f32 v218, v250, v218
v_mul_f32 v219, v250, v219
v_fmac_f32 v216, v20, v251
v_fmac_f32 v217, v21, v251
v_fmac_f32 v218, v22, v251
v_fmac_f32 v219, v23, v251
v_cvt_pk_bf16_f32 v92, v216, v217
v_cvt_pk_bf16_f32 v93, v218, v219
v_mul_f32 v220, v250, v220
v_mul_f32 v221, v250, v221
v_mul_f32 v222, v250, v222
v_mul_f32 v223, v250, v223
v_fmac_f32 v220, v24, v251
v_fmac_f32 v221, v25, v251
v_fmac_f32 v222, v26, v251
v_fmac_f32 v223, v27, v251
v_cvt_pk_bf16_f32 v94, v220, v221
v_cvt_pk_bf16_f32 v95, v222, v223
v_mov_b32 v160, 0
v_mov_b32 v161, 0
v_mfma_f32_16x16x32_bf16 v[140:143], a[140:143], v[92:95], v[140:143]
v_mov_b32 v162, 0
v_mov_b32 v163, 0
v_mov_b32 v164, 0
v_mov_b32 v165, 0
v_mov_b32 v166, 0
v_mov_b32 v167, 0
v_mov_b32 v216, 0
v_mov_b32 v217, 0
v_mov_b32 v218, 0
v_mov_b32 v219, 0
v_mov_b32 v220, 0
v_max3_f32 v140, v140, v141, v142
v_max_f32 v140, v140, v143
v_mov_b32 v141, v140
v_mov_b32 v221, 0
v_mov_b32 v222, 0
v_permlane16_swap_b32 v140, v141
v_max_f32 v140, v140, v141
v_mov_b32 v141, v140
v_mov_b32 v223, 0
v_mov_b32 v208, 0x3f803f80
v_permlane32_swap_b32 v140, v141
v_max_f32 v140, v140, v141
v_sub_f32 v156, 0, v140
v_sub_f32 v157, 0, v140
v_sub_f32 v158, 0, v140
v_sub_f32 v159, 0, v140
v_mov_b32 v209, 0x3f803f80
v_mov_b32 v210, 0x3f803f80
v_mov_b32 v211, 0x3f803f80
s_movk_i32 s49, 0xfe
s_mov_b32 s63, 0
s_mov_b32 s62, 8
s_waitcnt lgkmcnt(0)
s_branch LOOPM
.p2align 5
LOOPW:
s_waitcnt vmcnt(16)
LOOP:
v_mfma_f32_16x16x32_bf16 v[112:115], a[128:131], v[48:51], v[148:151]
v_exp_f32 v96, v96
v_mfma_f32_16x16x32_bf16 v[112:115], a[132:135], v[52:55], v[112:115]
v_exp_f32 v97, v97
v_mfma_f32_16x16x32_bf16 v[112:115], a[136:139], v[56:59], v[112:115]
v_exp_f32 v98, v98
v_mfma_f32_16x16x32_bf16 v[112:115], a[140:143], v[60:63], v[112:115]
v_mfma_f32_16x16x32_bf16 v[116:119], a[156:159], v[60:63], v[148:151]
v_exp_f32 v99, v99
v_mfma_f32_16x16x32_bf16 v[116:119], a[152:155], v[56:59], v[116:119]
v_cvt_pk_bf16_f32 v128, v96, v97
v_mfma_f32_16x16x32_bf16 v[116:119], a[148:151], v[52:55], v[116:119]
v_exp_f32 v100, v100
v_mfma_f32_16x16x32_bf16 v[116:119], a[144:147], v[48:51], v[116:119]
v_exp_f32 v101, v101
v_mfma_f32_16x16x32_bf16 v[120:123], a[160:163], v[48:51], v[148:151]
v_exp_f32 v102, v102
v_mfma_f32_16x16x32_bf16 v[120:123], a[164:167], v[52:55], v[120:123]
v_exp_f32 v103, v103
v_mfma_f32_16x16x32_bf16 v[120:123], a[168:171], v[56:59], v[120:123]
v_cvt_pk_bf16_f32 v130, v100, v101
v_mfma_f32_16x16x32_bf16 v[120:123], a[172:175], v[60:63], v[120:123]
v_exp_f32 v104, v104
v_mfma_f32_16x16x32_bf16 v[124:127], a[188:191], v[60:63], v[148:151]
v_exp_f32 v105, v105
v_mfma_f32_16x16x32_bf16 v[124:127], a[184:187], v[56:59], v[124:127]
v_exp_f32 v106, v106
v_mfma_f32_16x16x32_bf16 v[124:127], a[180:183], v[52:55], v[124:127]
v_exp_f32 v107, v107
v_mfma_f32_16x16x32_bf16 v[124:127], a[176:179], v[48:51], v[124:127]
v_exp_f32 v108, v108
v_mfma_f32_16x16x32_bf16 a[12:15], a[192:195], v[136:139], a[12:15]
s_barrier
v_exp_f32 v109, v109
v_mfma_f32_16x16x32_bf16 a[12:15], a[224:227], v[140:143], a[12:15]
ds_read_b64_tr_b16 a[224:225], v8 offset:2048
v_mfma_f32_16x16x32_bf16 a[28:31], a[228:231], v[140:143], a[28:31]
ds_read_b64_tr_b16 a[192:193], v8 offset:0
v_mfma_f32_16x16x32_bf16 a[28:31], a[196:199], v[136:139], a[28:31]
ds_read_b64_tr_b16 a[198:199], v9 offset:1024
v_mfma_f32_16x16x32_bf16 a[44:47], a[200:203], v[136:139], a[44:47]
v_exp_f32 v110, v110
v_mfma_f32_16x16x32_bf16 a[44:47], a[232:235], v[140:143], a[44:47]
ds_read_b64_tr_b16 a[226:227], v8 offset:3072
ds_read_b64_tr_b16 a[196:197], v9 offset:0
v_mfma_f32_16x16x32_bf16 a[60:63], a[236:239], v[140:143], a[60:63]
v_mfma_f32_16x16x32_bf16 a[60:63], a[204:207], v[136:139], a[60:63]
ds_read_b64_tr_b16 a[230:231], v9 offset:3072
ds_read_b64_tr_b16 a[204:205], v11 offset:0
v_mfma_f32_16x16x32_bf16 a[76:79], a[208:211], v[136:139], a[76:79]
v_exp_f32 v111, v111
v_mfma_f32_16x16x32_bf16 a[76:79], a[240:243], v[140:143], a[76:79]
ds_read_b64_tr_b16 a[234:235], v10 offset:3072
ds_read_b64_tr_b16 a[240:241], v12 offset:2048
v_mfma_f32_16x16x32_bf16 a[92:95], a[244:247], v[140:143], a[92:95]
v_cvt_pk_bf16_f32 v129, v98, v99
v_cvt_pk_bf16_f32 v132, v104, v105
v_mfma_f32_16x16x32_bf16 a[92:95], a[212:215], v[136:139], a[92:95]
ds_read_b64_tr_b16 a[232:233], v10 offset:2048
v_cvt_pk_bf16_f32 v135, v110, v111
v_mfma_f32_16x16x32_bf16 a[108:111], a[216:219], v[136:139], a[108:111]
ds_read_b64_tr_b16 a[202:203], v10 offset:1024
v_cvt_pk_bf16_f32 v133, v106, v107
v_mfma_f32_16x16x32_bf16 a[108:111], a[248:251], v[140:143], a[108:111]
ds_read_b64_tr_b16 a[200:201], v10 offset:0
v_cvt_pk_bf16_f32 v134, v108, v109
v_mfma_f32_16x16x32_bf16 a[124:127], a[252:255], v[140:143], a[124:127]
ds_read_b64_tr_b16 a[236:237], v11 offset:2048
v_mfma_f32_16x16x32_bf16 a[124:127], a[220:223], v[136:139], a[124:127]
ds_read_b64_tr_b16 a[214:215], v13 offset:1024
v_cvt_pk_bf16_f32 v131, v102, v103
LOOPM:
v_mfma_f32_16x16x32_bf16 v[96:99], a[128:131], v[64:67], v[152:155]
ds_read_b64_tr_b16 a[228:229], v9 offset:2048
v_mfma_f32_16x16x32_bf16 v[96:99], a[132:135], v[68:71], v[96:99]
v_exp_f32 v112, v112
v_mfma_f32_16x16x32_bf16 v[96:99], a[136:139], v[72:75], v[96:99]
ds_read_b64_tr_b16 a[210:211], v12 offset:1024
ds_read_b64_tr_b16 a[254:255], v15 offset:3072
v_mfma_f32_16x16x32_bf16 v[96:99], a[140:143], v[76:79], v[96:99]
v_exp_f32 v113, v113
v_mfma_f32_16x16x32_bf16 v[100:103], a[156:159], v[76:79], v[152:155]
v_exp_f32 v114, v114
v_mfma_f32_16x16x32_bf16 v[100:103], a[152:155], v[72:75], v[100:103]
ds_read_b64_tr_b16 a[244:245], v13 offset:2048
ds_read_b64_tr_b16 a[212:213], v13 offset:0
v_mfma_f32_16x16x32_bf16 v[100:103], a[148:151], v[68:71], v[100:103]
v_exp_f32 v115, v115
v_mfma_f32_16x16x32_bf16 v[100:103], a[144:147], v[64:67], v[100:103]
ds_read_b64_tr_b16 a[194:195], v8 offset:1024
ds_read_b64_tr_b16 a[238:239], v11 offset:3072
v_mfma_f32_16x16x32_bf16 v[104:107], a[160:163], v[64:67], v[152:155]
v_exp_f32 v116, v116
v_mfma_f32_16x16x32_bf16 v[104:107], a[164:167], v[68:71], v[104:107]
ds_read_b64_tr_b16 a[216:217], v14 offset:0
ds_read_b64_tr_b16 a[218:219], v14 offset:1024
v_mfma_f32_16x16x32_bf16 v[104:107], a[168:171], v[72:75], v[104:107]
v_exp_f32 v117, v117
v_mfma_f32_16x16x32_bf16 v[104:107], a[172:175], v[76:79], v[104:107]
v_exp_f32 v118, v118
v_mfma_f32_16x16x32_bf16 v[108:111], a[188:191], v[76:79], v[152:155]
v_exp_f32 v119, v119
v_mfma_f32_16x16x32_bf16 v[108:111], a[184:187], v[72:75], v[108:111]
ds_read_b64_tr_b16 a[206:207], v11 offset:1024
ds_read_b64_tr_b16 a[242:243], v12 offset:3072
v_mfma_f32_16x16x32_bf16 v[108:111], a[180:183], v[68:71], v[108:111]
v_exp_f32 v120, v120
v_mfma_f32_16x16x32_bf16 v[108:111], a[176:179], v[64:67], v[108:111]
s_waitcnt lgkmcnt(2)
s_cmp_lt_u32 s35, 0x80000
ds_read_b64_tr_b16 a[208:209], v12 offset:0
ds_read_b64_tr_b16 a[248:249], v14 offset:2048
v_mfma_f32_16x16x32_bf16 a[0:3], a[192:195], v[128:131], a[0:3]
s_cselect_b32 s8, s40, s36
v_exp_f32 v121, v121
v_mfma_f32_16x16x32_bf16 a[0:3], a[224:227], v[132:135], a[0:3]
s_cselect_b32 s9, s41, s37
ds_read_b64_tr_b16 a[246:247], v13 offset:3072
ds_read_b64_tr_b16 a[250:251], v14 offset:3072
v_mfma_f32_16x16x32_bf16 a[16:19], a[228:231], v[132:135], a[16:19]
s_cselect_b32 s3, 0x4000, s48
v_exp_f32 v122, v122
v_mfma_f32_16x16x32_bf16 a[16:19], a[196:199], v[128:131], a[16:19]
s_add_u32 m0, s33, 114688
ds_read_b64_tr_b16 a[252:253], v15 offset:2048
ds_read_b64_tr_b16 a[220:221], v15 offset:0
v_mfma_f32_16x16x32_bf16 a[32:35], a[200:203], v[128:131], a[32:35]
buffer_load_dwordx4 v2, s[8:11], s35 offen offset:0 sc1 lds
v_mfma_f32_16x16x32_bf16 a[32:35], a[232:235], v[132:135], a[32:35]
ds_read_b64_tr_b16 a[222:223], v15 offset:1024
v_cvt_pk_bf16_f32 v140, v120, v121
v_mfma_f32_16x16x32_bf16 a[48:51], a[236:239], v[132:135], a[48:51]
s_waitcnt lgkmcnt(5)
v_exp_f32 v123, v123
v_mfma_f32_16x16x32_bf16 a[48:51], a[204:207], v[128:131], a[48:51]
v_cvt_pk_bf16_f32 v136, v112, v113
v_mfma_f32_16x16x32_bf16 a[64:67], a[208:211], v[128:131], a[64:67]
buffer_load_dwordx4 v2, s[8:11], s35 offen offset:1024 sc1 lds
v_mfma_f32_16x16x32_bf16 a[64:67], a[240:243], v[132:135], a[64:67]
s_waitcnt lgkmcnt(1)
v_exp_f32 v124, v124
v_mfma_f32_16x16x32_bf16 a[80:83], a[244:247], v[132:135], a[80:83]
v_cvt_pk_bf16_f32 v137, v114, v115
v_cvt_pk_bf16_f32 v138, v116, v117
v_mfma_f32_16x16x32_bf16 a[80:83], a[212:215], v[128:131], a[80:83]
v_exp_f32 v125, v125
v_mfma_f32_16x16x32_bf16 a[96:99], a[216:219], v[128:131], a[96:99]
buffer_load_dwordx4 v2, s[8:11], s35 offen offset:2048 sc1 lds
v_mfma_f32_16x16x32_bf16 a[96:99], a[248:251], v[132:135], a[96:99]
v_cvt_pk_bf16_f32 v139, v118, v119
v_cvt_pk_bf16_f32 v141, v122, v123
v_mfma_f32_16x16x32_bf16 a[112:115], a[252:255], v[132:135], a[112:115]
s_waitcnt lgkmcnt(0)
v_exp_f32 v126, v126
v_mfma_f32_16x16x32_bf16 a[112:115], a[220:223], v[128:131], a[112:115]
buffer_load_dwordx4 v2, s[8:11], s35 offen offset:3072 sc1 lds
v_mfma_f32_16x16x32_bf16 v[216:219], v[208:211], v[128:131], v[216:219]
v_exp_f32 v127, v127
v_mfma_f32_16x16x32_bf16 v[216:219], v[208:211], v[132:135], v[216:219]
v_cvt_pk_bf16_f32 v142, v124, v125
v_cvt_pk_bf16_f32 v143, v126, v127
v_mfma_f32_16x16x32_bf16 v[112:115], a[128:131], v[80:83], v[156:159]
v_exp_f32 v96, v96
v_mfma_f32_16x16x32_bf16 v[112:115], a[132:135], v[84:87], v[112:115]
v_exp_f32 v97, v97
v_mfma_f32_16x16x32_bf16 v[112:115], a[136:139], v[88:91], v[112:115]
v_exp_f32 v98, v98
v_mfma_f32_16x16x32_bf16 v[112:115], a[140:143], v[92:95], v[112:115]
v_exp_f32 v99, v99
v_mfma_f32_16x16x32_bf16 v[116:119], a[156:159], v[92:95], v[156:159]
ds_read_b128 a[128:131], v4 offset:16384
v_cvt_pk_bf16_f32 v129, v98, v99
v_mfma_f32_16x16x32_bf16 v[116:119], a[152:155], v[88:91], v[116:119]
v_exp_f32 v100, v100
v_mfma_f32_16x16x32_bf16 v[116:119], a[148:151], v[84:87], v[116:119]
ds_read_b128 a[140:143], v7 offset:16384
v_add_f32 v165, v165, v99
v_mfma_f32_16x16x32_bf16 v[116:119], a[144:147], v[80:83], v[116:119]
v_exp_f32 v101, v101
v_mfma_f32_16x16x32_bf16 v[120:123], a[160:163], v[80:83], v[156:159]
v_exp_f32 v102, v102
v_mfma_f32_16x16x32_bf16 v[120:123], a[164:167], v[84:87], v[120:123]
ds_read_b128 a[160:163], v4 offset:18432
v_exp_f32 v103, v103
v_mfma_f32_16x16x32_bf16 v[120:123], a[168:171], v[88:91], v[120:123]
v_exp_f32 v104, v104
v_mfma_f32_16x16x32_bf16 v[120:123], a[172:175], v[92:95], v[120:123]
ds_read_b128 a[156:159], v7 offset:17408
v_add_f32 v164, v164, v100
v_mfma_f32_16x16x32_bf16 v[124:127], a[188:191], v[92:95], v[156:159]
v_exp_f32 v105, v105
v_mfma_f32_16x16x32_bf16 v[124:127], a[184:187], v[88:91], v[124:127]
s_add_u32 s35, s35, s3
v_exp_f32 v106, v106
v_mfma_f32_16x16x32_bf16 v[124:127], a[180:183], v[84:87], v[124:127]
s_cmp_lt_u32 s34, 0x80000
ds_read_b128 a[152:155], v6 offset:17408
v_add_f32 v164, v164, v96
v_mfma_f32_16x16x32_bf16 v[124:127], a[176:179], v[80:83], v[124:127]
s_cselect_b32 s4, s38, s42
v_exp_f32 v107, v107
v_mfma_f32_16x16x32_bf16 a[4:7], a[192:195], v[136:139], a[4:7]
s_cselect_b32 s5, s39, s43
ds_read_b128 a[148:151], v5 offset:17408
v_add_f32 v165, v165, v105
v_mfma_f32_16x16x32_bf16 a[4:7], a[224:227], v[140:143], a[4:7]
s_cselect_b32 s3, 0x4000, s48
v_add_f32 v164, v164, v106
v_cvt_pk_bf16_f32 v133, v106, v107
v_mfma_f32_16x16x32_bf16 a[20:23], a[228:231], v[140:143], a[20:23]
s_add_u32 m0, s33, 0
ds_read_b128 a[136:139], v6 offset:16384
v_exp_f32 v108, v108
v_mfma_f32_16x16x32_bf16 a[20:23], a[196:199], v[136:139], a[20:23]
buffer_load_dwordx4 v1, s[4:7], s34 offen offset:0 sc1 lds
v_mfma_f32_16x16x32_bf16 a[36:39], a[200:203], v[136:139], a[36:39]
ds_read_b128 a[184:187], v6 offset:19456
v_cvt_pk_bf16_f32 v130, v100, v101
v_mfma_f32_16x16x32_bf16 a[36:39], a[232:235], v[140:143], a[36:39]
v_exp_f32 v109, v109
v_mfma_f32_16x16x32_bf16 a[52:55], a[236:239], v[140:143], a[52:55]
ds_read_b128 a[188:191], v7 offset:19456
v_exp_f32 v110, v110
v_mfma_f32_16x16x32_bf16 a[52:55], a[204:207], v[136:139], a[52:55]
v_exp_f32 v111, v111
v_mfma_f32_16x16x32_bf16 a[68:71], a[208:211], v[136:139], a[68:71]
ds_read_b128 a[168:171], v6 offset:18432
v_cvt_pk_bf16_f32 v128, v96, v97
v_mfma_f32_16x16x32_bf16 a[68:71], a[240:243], v[140:143], a[68:71]
v_add_f32 v164, v164, v98
v_cvt_pk_bf16_f32 v132, v104, v105
v_mfma_f32_16x16x32_bf16 a[84:87], a[244:247], v[140:143], a[84:87]
v_cvt_pk_bf16_f32 v131, v102, v103
v_add_f32 v165, v165, v111
v_mfma_f32_16x16x32_bf16 a[84:87], a[212:215], v[136:139], a[84:87]
ds_read_b128 a[132:135], v5 offset:16384
v_add_f32 v164, v164, v108
v_mfma_f32_16x16x32_bf16 a[100:103], a[216:219], v[136:139], a[100:103]
v_add_f32 v165, v165, v107
v_cvt_pk_bf16_f32 v134, v108, v109
v_mfma_f32_16x16x32_bf16 a[100:103], a[248:251], v[140:143], a[100:103]
ds_read_b128 a[164:167], v5 offset:18432
v_add_f32 v164, v164, v110
v_mfma_f32_16x16x32_bf16 a[116:119], a[252:255], v[140:143], a[116:119]
v_add_f32 v164, v164, v102
v_add_f32 v164, v164, v104
v_mfma_f32_16x16x32_bf16 a[116:119], a[220:223], v[136:139], a[116:119]
ds_read_b128 a[144:147], v4 offset:17408
v_add_f32 v165, v165, v101
v_mfma_f32_16x16x32_bf16 v[220:223], v[208:211], v[136:139], v[220:223]
v_add_f32 v165, v165, v97
v_add_f32 v165, v165, v109
v_mfma_f32_16x16x32_bf16 v[220:223], v[208:211], v[140:143], v[220:223]
s_waitcnt lgkmcnt(2)
v_add_f32 v165, v165, v103
v_cvt_pk_bf16_f32 v135, v110, v111
v_mfma_f32_16x16x32_bf16 v[96:99], a[128:131], v[32:35], v[144:147]
ds_read_b128 a[172:175], v7 offset:18432
v_exp_f32 v112, v112
v_mfma_f32_16x16x32_bf16 v[96:99], a[132:135], v[36:39], v[96:99]
v_exp_f32 v113, v113
v_mfma_f32_16x16x32_bf16 v[96:99], a[136:139], v[40:43], v[96:99]
ds_read_b128 a[180:183], v5 offset:19456
v_cvt_pk_bf16_f32 v136, v112, v113
v_mfma_f32_16x16x32_bf16 v[96:99], a[140:143], v[44:47], v[96:99]
v_exp_f32 v114, v114
v_mfma_f32_16x16x32_bf16 v[100:103], a[156:159], v[44:47], v[144:147]
v_exp_f32 v115, v115
v_mfma_f32_16x16x32_bf16 v[100:103], a[152:155], v[40:43], v[100:103]
v_exp_f32 v116, v116
v_mfma_f32_16x16x32_bf16 v[100:103], a[148:151], v[36:39], v[100:103]
s_waitcnt lgkmcnt(1)
v_exp_f32 v117, v117
v_mfma_f32_16x16x32_bf16 v[100:103], a[144:147], v[32:35], v[100:103]
ds_read_b128 a[176:179], v4 offset:19456
v_add_f32 v167, v167, v113
v_mfma_f32_16x16x32_bf16 v[104:107], a[160:163], v[32:35], v[144:147]
v_exp_f32 v118, v118
v_mfma_f32_16x16x32_bf16 v[104:107], a[164:167], v[36:39], v[104:107]
buffer_load_dwordx4 v1, s[4:7], s34 offen offset:1024 sc1 lds
v_mfma_f32_16x16x32_bf16 v[104:107], a[168:171], v[40:43], v[104:107]
v_exp_f32 v119, v119
v_mfma_f32_16x16x32_bf16 v[104:107], a[172:175], v[44:47], v[104:107]
v_cvt_pk_bf16_f32 v137, v114, v115
v_add_f32 v167, v167, v117
v_mfma_f32_16x16x32_bf16 v[108:111], a[188:191], v[44:47], v[144:147]
buffer_load_dwordx4 v1, s[4:7], s34 offen offset:2048 sc1 lds
v_mfma_f32_16x16x32_bf16 v[108:111], a[184:187], v[40:43], v[108:111]
s_waitcnt lgkmcnt(0)
v_add_f32 v166, v166, v118
v_add_f32 v167, v167, v119
v_mfma_f32_16x16x32_bf16 v[108:111], a[180:183], v[36:39], v[108:111]
v_exp_f32 v120, v120
v_mfma_f32_16x16x32_bf16 v[108:111], a[176:179], v[32:35], v[108:111]
v_exp_f32 v121, v121
v_mfma_f32_16x16x32_bf16 a[8:11], a[192:195], v[128:131], a[8:11]
v_exp_f32 v122, v122
v_mfma_f32_16x16x32_bf16 a[8:11], a[224:227], v[132:135], a[8:11]
v_exp_f32 v123, v123
v_mfma_f32_16x16x32_bf16 a[24:27], a[228:231], v[132:135], a[24:27]
v_add_f32 v167, v167, v115
v_add_f32 v167, v167, v123
v_mfma_f32_16x16x32_bf16 a[24:27], a[196:199], v[128:131], a[24:27]
v_exp_f32 v124, v124
v_mfma_f32_16x16x32_bf16 a[40:43], a[200:203], v[128:131], a[40:43]
v_exp_f32 v125, v125
v_mfma_f32_16x16x32_bf16 a[40:43], a[232:235], v[132:135], a[40:43]
v_add_f32 v166, v166, v116
v_cvt_pk_bf16_f32 v139, v118, v119
v_mfma_f32_16x16x32_bf16 a[56:59], a[236:239], v[132:135], a[56:59]
v_exp_f32 v126, v126
v_mfma_f32_16x16x32_bf16 a[56:59], a[204:207], v[128:131], a[56:59]
v_add_f32 v166, v166, v124
v_add_f32 v167, v167, v125
v_mfma_f32_16x16x32_bf16 a[72:75], a[208:211], v[128:131], a[72:75]
v_cvt_pk_bf16_f32 v138, v116, v117
v_add_f32 v166, v166, v122
v_mfma_f32_16x16x32_bf16 a[72:75], a[240:243], v[132:135], a[72:75]
buffer_load_dwordx4 v1, s[4:7], s34 offen offset:3072 sc1 lds
v_mfma_f32_16x16x32_bf16 a[88:91], a[244:247], v[132:135], a[88:91]
s_add_u32 s34, s34, s3
v_add_f32 v167, v167, v121
v_cvt_pk_bf16_f32 v140, v120, v121
v_mfma_f32_16x16x32_bf16 a[88:91], a[212:215], v[128:131], a[88:91]
v_exp_f32 v127, v127
v_mfma_f32_16x16x32_bf16 a[104:107], a[216:219], v[128:131], a[104:107]
v_add_f32 v166, v166, v112
v_cvt_pk_bf16_f32 v142, v124, v125
v_mfma_f32_16x16x32_bf16 a[104:107], a[248:251], v[132:135], a[104:107]
v_add_f32 v166, v166, v126
v_cvt_pk_bf16_f32 v143, v126, v127
v_mfma_f32_16x16x32_bf16 a[120:123], a[252:255], v[132:135], a[120:123]
v_cvt_pk_bf16_f32 v141, v122, v123
v_add_f32 v167, v167, v127
v_mfma_f32_16x16x32_bf16 a[120:123], a[220:223], v[128:131], a[120:123]
v_add_f32 v166, v166, v114
v_add_f32 v166, v166, v120
v_mfma_f32_16x16x32_bf16 v[112:115], a[128:131], v[48:51], v[148:151]
v_exp_f32 v96, v96
v_mfma_f32_16x16x32_bf16 v[112:115], a[132:135], v[52:55], v[112:115]
v_exp_f32 v97, v97
v_mfma_f32_16x16x32_bf16 v[112:115], a[136:139], v[56:59], v[112:115]
v_exp_f32 v98, v98
v_mfma_f32_16x16x32_bf16 v[112:115], a[140:143], v[60:63], v[112:115]
v_exp_f32 v99, v99
v_mfma_f32_16x16x32_bf16 v[116:119], a[156:159], v[60:63], v[148:151]
v_exp_f32 v100, v100
v_mfma_f32_16x16x32_bf16 v[116:119], a[152:155], v[56:59], v[116:119]
v_cvt_pk_bf16_f32 v128, v96, v97
v_cvt_pk_bf16_f32 v129, v98, v99
v_mfma_f32_16x16x32_bf16 v[116:119], a[148:151], v[52:55], v[116:119]
v_exp_f32 v101, v101
v_mfma_f32_16x16x32_bf16 v[116:119], a[144:147], v[48:51], v[116:119]
v_exp_f32 v102, v102
v_mfma_f32_16x16x32_bf16 v[120:123], a[160:163], v[48:51], v[148:151]
v_exp_f32 v103, v103
v_mfma_f32_16x16x32_bf16 v[120:123], a[164:167], v[52:55], v[120:123]
v_cvt_pk_bf16_f32 v130, v100, v101
v_cvt_pk_bf16_f32 v131, v102, v103
v_mfma_f32_16x16x32_bf16 v[120:123], a[168:171], v[56:59], v[120:123]
v_exp_f32 v104, v104
v_mfma_f32_16x16x32_bf16 v[120:123], a[172:175], v[60:63], v[120:123]
v_exp_f32 v105, v105
v_mfma_f32_16x16x32_bf16 v[124:127], a[188:191], v[60:63], v[148:151]
v_exp_f32 v106, v106
v_mfma_f32_16x16x32_bf16 v[124:127], a[184:187], v[56:59], v[124:127]
v_exp_f32 v107, v107
v_mfma_f32_16x16x32_bf16 v[124:127], a[180:183], v[52:55], v[124:127]
v_exp_f32 v108, v108
v_mfma_f32_16x16x32_bf16 v[124:127], a[176:179], v[48:51], v[124:127]
s_waitcnt vmcnt(16)
v_exp_f32 v109, v109
v_mfma_f32_16x16x32_bf16 a[12:15], a[192:195], v[136:139], a[12:15]
s_barrier
v_cvt_pk_bf16_f32 v134, v108, v109
v_mfma_f32_16x16x32_bf16 a[12:15], a[224:227], v[140:143], a[12:15]
ds_read_b64_tr_b16 a[224:225], v8 offset:18432
v_mfma_f32_16x16x32_bf16 a[28:31], a[228:231], v[140:143], a[28:31]
ds_read_b64_tr_b16 a[194:195], v8 offset:17408
v_mfma_f32_16x16x32_bf16 a[28:31], a[196:199], v[136:139], a[28:31]
v_exp_f32 v110, v110
v_mfma_f32_16x16x32_bf16 a[44:47], a[200:203], v[136:139], a[44:47]
ds_read_b64_tr_b16 a[202:203], v10 offset:17408
v_mfma_f32_16x16x32_bf16 a[44:47], a[232:235], v[140:143], a[44:47]
s_cmp_lt_u32 s35, 0x80000
ds_read_b64_tr_b16 a[234:235], v10 offset:19456
v_mfma_f32_16x16x32_bf16 a[60:63], a[236:239], v[140:143], a[60:63]
s_cselect_b32 s8, s40, s36
ds_read_b64_tr_b16 a[232:233], v10 offset:18432
v_mfma_f32_16x16x32_bf16 a[60:63], a[204:207], v[136:139], a[60:63]
s_cselect_b32 s9, s41, s37
ds_read_b64_tr_b16 a[198:199], v9 offset:17408
v_cvt_pk_bf16_f32 v133, v106, v107
v_mfma_f32_16x16x32_bf16 a[76:79], a[208:211], v[136:139], a[76:79]
s_cselect_b32 s3, 0x4000, s48
v_exp_f32 v111, v111
v_mfma_f32_16x16x32_bf16 a[76:79], a[240:243], v[140:143], a[76:79]
s_add_u32 m0, s33, 65536
ds_read_b64_tr_b16 a[226:227], v8 offset:19456
ds_read_b64_tr_b16 a[200:201], v10 offset:16384
v_mfma_f32_16x16x32_bf16 a[92:95], a[244:247], v[140:143], a[92:95]
buffer_load_dwordx4 v2, s[8:11], s35 offen offset:0 sc1 lds
v_mfma_f32_16x16x32_bf16 a[92:95], a[212:215], v[136:139], a[92:95]
ds_read_b64_tr_b16 a[230:231], v9 offset:19456
ds_read_b64_tr_b16 a[196:197], v9 offset:16384
v_mfma_f32_16x16x32_bf16 a[108:111], a[216:219], v[136:139], a[108:111]
v_cvt_pk_bf16_f32 v132, v104, v105
v_cvt_pk_bf16_f32 v135, v110, v111
v_mfma_f32_16x16x32_bf16 a[108:111], a[248:251], v[140:143], a[108:111]
ds_read_b64_tr_b16 a[248:249], v14 offset:18432
ds_read_b64_tr_b16 a[250:251], v14 offset:19456
v_mfma_f32_16x16x32_bf16 a[124:127], a[252:255], v[140:143], a[124:127]
v_mfma_f32_16x16x32_bf16 a[124:127], a[220:223], v[136:139], a[124:127]
ds_read_b64_tr_b16 a[192:193], v8 offset:16384
ds_read_b64_tr_b16 a[208:209], v12 offset:16384
v_mfma_f32_16x16x32_bf16 v[96:99], a[128:131], v[64:67], v[152:155]
v_exp_f32 v112, v112
v_mfma_f32_16x16x32_bf16 v[96:99], a[132:135], v[68:71], v[96:99]
ds_read_b64_tr_b16 a[212:213], v13 offset:16384
ds_read_b64_tr_b16 a[222:223], v15 offset:17408
v_mfma_f32_16x16x32_bf16 v[96:99], a[136:139], v[72:75], v[96:99]
v_exp_f32 v113, v113
v_mfma_f32_16x16x32_bf16 v[96:99], a[140:143], v[76:79], v[96:99]
ds_read_b64_tr_b16 a[246:247], v13 offset:19456
ds_read_b64_tr_b16 a[214:215], v13 offset:17408
v_mfma_f32_16x16x32_bf16 v[100:103], a[156:159], v[76:79], v[152:155]
v_exp_f32 v114, v114
v_mfma_f32_16x16x32_bf16 v[100:103], a[152:155], v[72:75], v[100:103]
ds_read_b64_tr_b16 a[228:229], v9 offset:18432
ds_read_b64_tr_b16 a[236:237], v11 offset:18432
v_mfma_f32_16x16x32_bf16 v[100:103], a[148:151], v[68:71], v[100:103]
buffer_load_dwordx4 v2, s[8:11], s35 offen offset:1024 sc1 lds
v_mfma_f32_16x16x32_bf16 v[100:103], a[144:147], v[64:67], v[100:103]
ds_read_b64_tr_b16 a[216:217], v14 offset:16384
ds_read_b64_tr_b16 a[252:253], v15 offset:18432
v_mfma_f32_16x16x32_bf16 v[104:107], a[160:163], v[64:67], v[152:155]
v_exp_f32 v115, v115
v_mfma_f32_16x16x32_bf16 v[104:107], a[164:167], v[68:71], v[104:107]
v_exp_f32 v116, v116
v_mfma_f32_16x16x32_bf16 v[104:107], a[168:171], v[72:75], v[104:107]
ds_read_b64_tr_b16 a[242:243], v12 offset:19456
ds_read_b64_tr_b16 a[244:245], v13 offset:18432
v_mfma_f32_16x16x32_bf16 v[104:107], a[172:175], v[76:79], v[104:107]
v_exp_f32 v117, v117
v_mfma_f32_16x16x32_bf16 v[108:111], a[188:191], v[76:79], v[152:155]
buffer_load_dwordx4 v2, s[8:11], s35 offen offset:2048 sc1 lds
v_mfma_f32_16x16x32_bf16 v[108:111], a[184:187], v[72:75], v[108:111]
ds_read_b64_tr_b16 a[238:239], v11 offset:19456
ds_read_b64_tr_b16 a[204:205], v11 offset:16384
v_mfma_f32_16x16x32_bf16 v[108:111], a[180:183], v[68:71], v[108:111]
v_exp_f32 v118, v118
v_mfma_f32_16x16x32_bf16 v[108:111], a[176:179], v[64:67], v[108:111]
s_waitcnt lgkmcnt(4)
ds_read_b64_tr_b16 a[206:207], v11 offset:17408
ds_read_b64_tr_b16 a[210:211], v12 offset:17408
v_mfma_f32_16x16x32_bf16 a[0:3], a[192:195], v[128:131], a[0:3]
v_exp_f32 v119, v119
v_mfma_f32_16x16x32_bf16 a[0:3], a[224:227], v[132:135], a[0:3]
ds_read_b64_tr_b16 a[240:241], v12 offset:18432
ds_read_b64_tr_b16 a[218:219], v14 offset:17408
v_mfma_f32_16x16x32_bf16 a[16:19], a[228:231], v[132:135], a[16:19]
v_exp_f32 v120, v120
v_mfma_f32_16x16x32_bf16 a[16:19], a[196:199], v[128:131], a[16:19]
buffer_load_dwordx4 v2, s[8:11], s35 offen offset:3072 sc1 lds
v_mfma_f32_16x16x32_bf16 a[32:35], a[200:203], v[128:131], a[32:35]
ds_read_b64_tr_b16 a[220:221], v15 offset:16384
v_mfma_f32_16x16x32_bf16 a[32:35], a[232:235], v[132:135], a[32:35]
s_waitcnt lgkmcnt(3)
v_exp_f32 v121, v121
v_mfma_f32_16x16x32_bf16 a[48:51], a[236:239], v[132:135], a[48:51]
ds_read_b64_tr_b16 a[254:255], v15 offset:19456
v_mfma_f32_16x16x32_bf16 a[48:51], a[204:207], v[128:131], a[48:51]
s_add_u32 s35, s35, s3
v_exp_f32 v122, v122
v_mfma_f32_16x16x32_bf16 a[64:67], a[208:211], v[128:131], a[64:67]
s_waitcnt lgkmcnt(2)
s_cmp_lt_u32 s34, 0x80000
v_exp_f32 v123, v123
v_mfma_f32_16x16x32_bf16 a[64:67], a[240:243], v[132:135], a[64:67]
s_cselect_b32 s4, s38, s42
v_exp_f32 v124, v124
v_mfma_f32_16x16x32_bf16 a[80:83], a[244:247], v[132:135], a[80:83]
s_cselect_b32 s5, s39, s43
v_exp_f32 v125, v125
v_mfma_f32_16x16x32_bf16 a[80:83], a[212:215], v[128:131], a[80:83]
s_cselect_b32 s3, 0x4000, s48
v_cvt_pk_bf16_f32 v136, v112, v113
v_cvt_pk_bf16_f32 v137, v114, v115
v_mfma_f32_16x16x32_bf16 a[96:99], a[216:219], v[128:131], a[96:99]
s_add_u32 m0, s33, 16384
v_cvt_pk_bf16_f32 v139, v118, v119
v_cvt_pk_bf16_f32 v140, v120, v121
v_mfma_f32_16x16x32_bf16 a[96:99], a[248:251], v[132:135], a[96:99]
s_waitcnt lgkmcnt(0)
buffer_load_dwordx4 v1, s[4:7], s34 offen offset:0 sc1 lds
v_mfma_f32_16x16x32_bf16 a[112:115], a[252:255], v[132:135], a[112:115]
v_cvt_pk_bf16_f32 v138, v116, v117
v_cvt_pk_bf16_f32 v141, v122, v123
v_mfma_f32_16x16x32_bf16 a[112:115], a[220:223], v[128:131], a[112:115]
v_exp_f32 v126, v126
v_mfma_f32_16x16x32_bf16 v[216:219], v[208:211], v[128:131], v[216:219]
v_exp_f32 v127, v127
v_mfma_f32_16x16x32_bf16 v[216:219], v[208:211], v[132:135], v[216:219]
v_cvt_pk_bf16_f32 v142, v124, v125
v_cvt_pk_bf16_f32 v143, v126, v127
v_mfma_f32_16x16x32_bf16 v[112:115], a[128:131], v[80:83], v[156:159]
v_exp_f32 v96, v96
v_mfma_f32_16x16x32_bf16 v[112:115], a[132:135], v[84:87], v[112:115]
v_exp_f32 v97, v97
v_mfma_f32_16x16x32_bf16 v[112:115], a[136:139], v[88:91], v[112:115]
v_exp_f32 v98, v98
v_mfma_f32_16x16x32_bf16 v[112:115], a[140:143], v[92:95], v[112:115]
v_exp_f32 v99, v99
v_mfma_f32_16x16x32_bf16 v[116:119], a[156:159], v[92:95], v[156:159]
ds_read_b128 a[128:131], v4 offset:32768
v_cvt_pk_bf16_f32 v128, v96, v97
v_mfma_f32_16x16x32_bf16 v[116:119], a[152:155], v[88:91], v[116:119]
v_exp_f32 v100, v100
v_mfma_f32_16x16x32_bf16 v[116:119], a[148:151], v[84:87], v[116:119]
ds_read_b128 a[132:135], v5 offset:32768
v_add_f32 v164, v164, v100
v_mfma_f32_16x16x32_bf16 v[116:119], a[144:147], v[80:83], v[116:119]
v_exp_f32 v101, v101
v_mfma_f32_16x16x32_bf16 v[120:123], a[160:163], v[80:83], v[156:159]
ds_read_b128 a[148:151], v5 offset:33792
v_exp_f32 v102, v102
v_mfma_f32_16x16x32_bf16 v[120:123], a[164:167], v[84:87], v[120:123]
v_exp_f32 v103, v103
v_mfma_f32_16x16x32_bf16 v[120:123], a[168:171], v[88:91], v[120:123]
ds_read_b128 a[160:163], v4 offset:34816
v_exp_f32 v104, v104
v_mfma_f32_16x16x32_bf16 v[120:123], a[172:175], v[92:95], v[120:123]
v_exp_f32 v105, v105
v_mfma_f32_16x16x32_bf16 v[124:127], a[188:191], v[92:95], v[156:159]
ds_read_b128 a[152:155], v6 offset:33792
v_add_f32 v164, v164, v104
v_mfma_f32_16x16x32_bf16 v[124:127], a[184:187], v[88:91], v[124:127]
v_exp_f32 v106, v106
v_mfma_f32_16x16x32_bf16 v[124:127], a[180:183], v[84:87], v[124:127]
ds_read_b128 a[168:171], v6 offset:34816
v_cvt_pk_bf16_f32 v131, v102, v103
v_mfma_f32_16x16x32_bf16 v[124:127], a[176:179], v[80:83], v[124:127]
v_exp_f32 v107, v107
v_mfma_f32_16x16x32_bf16 a[4:7], a[192:195], v[136:139], a[4:7]
ds_read_b128 a[144:147], v4 offset:33792
v_add_f32 v165, v165, v105
v_mfma_f32_16x16x32_bf16 a[4:7], a[224:227], v[140:143], a[4:7]
v_exp_f32 v108, v108
v_mfma_f32_16x16x32_bf16 a[20:23], a[228:231], v[140:143], a[20:23]
v_add_f32 v165, v165, v101
v_add_f32 v164, v164, v108
v_mfma_f32_16x16x32_bf16 a[20:23], a[196:199], v[136:139], a[20:23]
ds_read_b128 a[140:143], v7 offset:32768
v_add_f32 v165, v165, v99
v_mfma_f32_16x16x32_bf16 a[36:39], a[200:203], v[136:139], a[36:39]
v_exp_f32 v109, v109
v_mfma_f32_16x16x32_bf16 a[36:39], a[232:235], v[140:143], a[36:39]
v_add_f32 v165, v165, v109
v_cvt_pk_bf16_f32 v134, v108, v109
v_mfma_f32_16x16x32_bf16 a[52:55], a[236:239], v[140:143], a[52:55]
ds_read_b128 a[188:191], v7 offset:35840
v_add_f32 v164, v164, v106
v_mfma_f32_16x16x32_bf16 a[52:55], a[204:207], v[136:139], a[52:55]
v_cvt_pk_bf16_f32 v130, v100, v101
v_cvt_pk_bf16_f32 v132, v104, v105
v_mfma_f32_16x16x32_bf16 a[68:71], a[208:211], v[136:139], a[68:71]
ds_read_b128 a[136:139], v6 offset:32768
v_add_f32 v165, v165, v103
v_mfma_f32_16x16x32_bf16 a[68:71], a[240:243], v[140:143], a[68:71]
v_cvt_pk_bf16_f32 v129, v98, v99
v_add_f32 v165, v165, v107
v_mfma_f32_16x16x32_bf16 a[84:87], a[244:247], v[140:143], a[84:87]
ds_read_b128 a[156:159], v7 offset:33792
v_add_f32 v164, v164, v102
v_mfma_f32_16x16x32_bf16 a[84:87], a[212:215], v[136:139], a[84:87]
v_exp_f32 v110, v110
v_mfma_f32_16x16x32_bf16 a[100:103], a[216:219], v[136:139], a[100:103]
ds_read_b128 a[172:175], v7 offset:34816
v_cvt_pk_bf16_f32 v133, v106, v107
v_mfma_f32_16x16x32_bf16 a[100:103], a[248:251], v[140:143], a[100:103]
v_add_f32 v164, v164, v98
v_add_f32 v164, v164, v110
v_mfma_f32_16x16x32_bf16 a[116:119], a[252:255], v[140:143], a[116:119]
ds_read_b128 a[180:183], v5 offset:35840
v_add_f32 v165, v165, v97
v_mfma_f32_16x16x32_bf16 a[116:119], a[220:223], v[136:139], a[116:119]
v_exp_f32 v111, v111
v_mfma_f32_16x16x32_bf16 v[220:223], v[208:211], v[136:139], v[220:223]
ds_read_b128 a[164:167], v5 offset:34816
v_cvt_pk_bf16_f32 v135, v110, v111
v_mfma_f32_16x16x32_bf16 v[220:223], v[208:211], v[140:143], v[220:223]
s_waitcnt lgkmcnt(3)
v_add_f32 v164, v164, v96
v_add_f32 v165, v165, v111
v_mfma_f32_16x16x32_bf16 v[96:99], a[128:131], v[32:35], v[144:147]
buffer_load_dwordx4 v1, s[4:7], s34 offen offset:1024 sc1 lds
v_mfma_f32_16x16x32_bf16 v[96:99], a[132:135], v[36:39], v[96:99]
v_exp_f32 v112, v112
v_mfma_f32_16x16x32_bf16 v[96:99], a[136:139], v[40:43], v[96:99]
v_exp_f32 v113, v113
v_mfma_f32_16x16x32_bf16 v[96:99], a[140:143], v[44:47], v[96:99]
ds_read_b128 a[184:187], v6 offset:35840
v_add_f32 v166, v166, v112
v_mfma_f32_16x16x32_bf16 v[100:103], a[156:159], v[44:47], v[144:147]
v_exp_f32 v114, v114
v_mfma_f32_16x16x32_bf16 v[100:103], a[152:155], v[40:43], v[100:103]
v_exp_f32 v115, v115
v_mfma_f32_16x16x32_bf16 v[100:103], a[148:151], v[36:39], v[100:103]
v_exp_f32 v116, v116
v_mfma_f32_16x16x32_bf16 v[100:103], a[144:147], v[32:35], v[100:103]
ds_read_b128 a[176:179], v4 offset:35840
v_add_f32 v167, v167, v115
v_mfma_f32_16x16x32_bf16 v[104:107], a[160:163], v[32:35], v[144:147]
s_waitcnt lgkmcnt(2)
v_exp_f32 v117, v117
v_mfma_f32_16x16x32_bf16 v[104:107], a[164:167], v[36:39], v[104:107]
v_exp_f32 v118, v118
v_mfma_f32_16x16x32_bf16 v[104:107], a[168:171], v[40:43], v[104:107]
v_exp_f32 v119, v119
v_mfma_f32_16x16x32_bf16 v[104:107], a[172:175], v[44:47], v[104:107]
v_exp_f32 v120, v120
v_mfma_f32_16x16x32_bf16 v[108:111], a[188:191], v[44:47], v[144:147]
s_waitcnt lgkmcnt(1)
v_exp_f32 v121, v121
v_mfma_f32_16x16x32_bf16 v[108:111], a[184:187], v[40:43], v[108:111]
v_exp_f32 v122, v122
v_mfma_f32_16x16x32_bf16 v[108:111], a[180:183], v[36:39], v[108:111]
s_waitcnt lgkmcnt(0)
v_exp_f32 v123, v123
v_mfma_f32_16x16x32_bf16 v[108:111], a[176:179], v[32:35], v[108:111]
v_exp_f32 v124, v124
v_mfma_f32_16x16x32_bf16 a[8:11], a[192:195], v[128:131], a[8:11]
v_exp_f32 v125, v125
v_mfma_f32_16x16x32_bf16 a[8:11], a[224:227], v[132:135], a[8:11]
v_cvt_pk_bf16_f32 v137, v114, v115
v_cvt_pk_bf16_f32 v140, v120, v121
v_mfma_f32_16x16x32_bf16 a[24:27], a[228:231], v[132:135], a[24:27]
v_exp_f32 v126, v126
v_mfma_f32_16x16x32_bf16 a[24:27], a[196:199], v[128:131], a[24:27]
buffer_load_dwordx4 v1, s[4:7], s34 offen offset:2048 sc1 lds
v_mfma_f32_16x16x32_bf16 a[40:43], a[200:203], v[128:131], a[40:43]
v_exp_f32 v127, v127
v_mfma_f32_16x16x32_bf16 a[40:43], a[232:235], v[132:135], a[40:43]
v_add_f32 v167, v167, v121
v_add_f32 v166, v166, v124
v_mfma_f32_16x16x32_bf16 a[56:59], a[236:239], v[132:135], a[56:59]
v_add_f32 v166, v166, v114
v_add_f32 v166, v166, v122
v_mfma_f32_16x16x32_bf16 a[56:59], a[204:207], v[128:131], a[56:59]
v_cvt_pk_bf16_f32 v138, v116, v117
v_add_f32 v166, v166, v126
v_mfma_f32_16x16x32_bf16 a[72:75], a[208:211], v[128:131], a[72:75]
v_add_f32 v167, v167, v119
v_add_f32 v167, v167, v123
v_mfma_f32_16x16x32_bf16 a[72:75], a[240:243], v[132:135], a[72:75]
v_cvt_pk_bf16_f32 v142, v124, v125
v_cvt_pk_bf16_f32 v143, v126, v127
v_mfma_f32_16x16x32_bf16 a[88:91], a[244:247], v[132:135], a[88:91]
v_add_f32 v166, v166, v116
v_add_f32 v167, v167, v125
v_mfma_f32_16x16x32_bf16 a[88:91], a[212:215], v[128:131], a[88:91]
v_cvt_pk_bf16_f32 v139, v118, v119
v_cvt_pk_bf16_f32 v141, v122, v123
v_mfma_f32_16x16x32_bf16 a[104:107], a[216:219], v[128:131], a[104:107]
v_add_f32 v167, v167, v117
v_add_f32 v166, v166, v120
v_mfma_f32_16x16x32_bf16 a[104:107], a[248:251], v[132:135], a[104:107]
v_cvt_pk_bf16_f32 v136, v112, v113
v_add_f32 v167, v167, v127
v_mfma_f32_16x16x32_bf16 a[120:123], a[252:255], v[132:135], a[120:123]
buffer_load_dwordx4 v1, s[4:7], s34 offen offset:3072 sc1 lds
v_mfma_f32_16x16x32_bf16 a[120:123], a[220:223], v[128:131], a[120:123]
s_add_u32 s34, s34, s3
v_add_f32 v167, v167, v113
v_add_f32 v166, v166, v118
v_mfma_f32_16x16x32_bf16 v[112:115], a[128:131], v[48:51], v[148:151]
v_exp_f32 v96, v96
v_mfma_f32_16x16x32_bf16 v[112:115], a[132:135], v[52:55], v[112:115]
v_exp_f32 v97, v97
v_mfma_f32_16x16x32_bf16 v[112:115], a[136:139], v[56:59], v[112:115]
v_exp_f32 v98, v98
v_mfma_f32_16x16x32_bf16 v[112:115], a[140:143], v[60:63], v[112:115]
v_exp_f32 v99, v99
v_mfma_f32_16x16x32_bf16 v[116:119], a[156:159], v[60:63], v[148:151]
v_exp_f32 v100, v100
v_mfma_f32_16x16x32_bf16 v[116:119], a[152:155], v[56:59], v[116:119]
v_cvt_pk_bf16_f32 v128, v96, v97
v_cvt_pk_bf16_f32 v129, v98, v99
v_mfma_f32_16x16x32_bf16 v[116:119], a[148:151], v[52:55], v[116:119]
v_exp_f32 v101, v101
v_mfma_f32_16x16x32_bf16 v[116:119], a[144:147], v[48:51], v[116:119]
v_exp_f32 v102, v102
v_mfma_f32_16x16x32_bf16 v[120:123], a[160:163], v[48:51], v[148:151]
v_exp_f32 v103, v103
v_mfma_f32_16x16x32_bf16 v[120:123], a[164:167], v[52:55], v[120:123]
v_cvt_pk_bf16_f32 v130, v100, v101
v_cvt_pk_bf16_f32 v131, v102, v103
v_mfma_f32_16x16x32_bf16 v[120:123], a[168:171], v[56:59], v[120:123]
v_exp_f32 v104, v104
v_mfma_f32_16x16x32_bf16 v[120:123], a[172:175], v[60:63], v[120:123]
v_exp_f32 v105, v105
v_mfma_f32_16x16x32_bf16 v[124:127], a[188:191], v[60:63], v[148:151]
v_exp_f32 v106, v106
v_mfma_f32_16x16x32_bf16 v[124:127], a[184:187], v[56:59], v[124:127]
v_exp_f32 v107, v107
v_mfma_f32_16x16x32_bf16 v[124:127], a[180:183], v[52:55], v[124:127]
v_exp_f32 v108, v108
v_mfma_f32_16x16x32_bf16 v[124:127], a[176:179], v[48:51], v[124:127]
s_waitcnt vmcnt(16)
v_exp_f32 v109, v109
v_mfma_f32_16x16x32_bf16 a[12:15], a[192:195], v[136:139], a[12:15]
s_barrier
v_cvt_pk_bf16_f32 v134, v108, v109
v_mfma_f32_16x16x32_bf16 a[12:15], a[224:227], v[140:143], a[12:15]
ds_read_b64_tr_b16 a[224:225], v8 offset:34816
v_mfma_f32_16x16x32_bf16 a[28:31], a[228:231], v[140:143], a[28:31]
ds_read_b64_tr_b16 a[194:195], v8 offset:33792
v_mfma_f32_16x16x32_bf16 a[28:31], a[196:199], v[136:139], a[28:31]
v_exp_f32 v110, v110
v_mfma_f32_16x16x32_bf16 a[44:47], a[200:203], v[136:139], a[44:47]
ds_read_b64_tr_b16 a[202:203], v10 offset:33792
v_mfma_f32_16x16x32_bf16 a[44:47], a[232:235], v[140:143], a[44:47]
s_cmp_lt_u32 s35, 0x80000
ds_read_b64_tr_b16 a[234:235], v10 offset:35840
v_mfma_f32_16x16x32_bf16 a[60:63], a[236:239], v[140:143], a[60:63]
s_cselect_b32 s8, s40, s36
ds_read_b64_tr_b16 a[232:233], v10 offset:34816
v_mfma_f32_16x16x32_bf16 a[60:63], a[204:207], v[136:139], a[60:63]
s_cselect_b32 s9, s41, s37
ds_read_b64_tr_b16 a[198:199], v9 offset:33792
v_cvt_pk_bf16_f32 v133, v106, v107
v_mfma_f32_16x16x32_bf16 a[76:79], a[208:211], v[136:139], a[76:79]
s_cselect_b32 s3, 0x4000, s48
v_exp_f32 v111, v111
v_mfma_f32_16x16x32_bf16 a[76:79], a[240:243], v[140:143], a[76:79]
s_add_u32 m0, s33, 81920
ds_read_b64_tr_b16 a[226:227], v8 offset:35840
ds_read_b64_tr_b16 a[200:201], v10 offset:32768
v_mfma_f32_16x16x32_bf16 a[92:95], a[244:247], v[140:143], a[92:95]
buffer_load_dwordx4 v2, s[8:11], s35 offen offset:0 sc1 lds
v_mfma_f32_16x16x32_bf16 a[92:95], a[212:215], v[136:139], a[92:95]
ds_read_b64_tr_b16 a[230:231], v9 offset:35840
ds_read_b64_tr_b16 a[196:197], v9 offset:32768
v_mfma_f32_16x16x32_bf16 a[108:111], a[216:219], v[136:139], a[108:111]
v_cvt_pk_bf16_f32 v132, v104, v105
v_cvt_pk_bf16_f32 v135, v110, v111
v_mfma_f32_16x16x32_bf16 a[108:111], a[248:251], v[140:143], a[108:111]
ds_read_b64_tr_b16 a[248:249], v14 offset:34816
ds_read_b64_tr_b16 a[250:251], v14 offset:35840
v_mfma_f32_16x16x32_bf16 a[124:127], a[252:255], v[140:143], a[124:127]
v_mfma_f32_16x16x32_bf16 a[124:127], a[220:223], v[136:139], a[124:127]
ds_read_b64_tr_b16 a[192:193], v8 offset:32768
ds_read_b64_tr_b16 a[208:209], v12 offset:32768
v_mfma_f32_16x16x32_bf16 v[96:99], a[128:131], v[64:67], v[152:155]
v_exp_f32 v112, v112
v_mfma_f32_16x16x32_bf16 v[96:99], a[132:135], v[68:71], v[96:99]
ds_read_b64_tr_b16 a[212:213], v13 offset:32768
ds_read_b64_tr_b16 a[222:223], v15 offset:33792
v_mfma_f32_16x16x32_bf16 v[96:99], a[136:139], v[72:75], v[96:99]
v_exp_f32 v113, v113
v_mfma_f32_16x16x32_bf16 v[96:99], a[140:143], v[76:79], v[96:99]
ds_read_b64_tr_b16 a[246:247], v13 offset:35840
ds_read_b64_tr_b16 a[214:215], v13 offset:33792
v_mfma_f32_16x16x32_bf16 v[100:103], a[156:159], v[76:79], v[152:155]
v_exp_f32 v114, v114
v_mfma_f32_16x16x32_bf16 v[100:103], a[152:155], v[72:75], v[100:103]
ds_read_b64_tr_b16 a[228:229], v9 offset:34816
ds_read_b64_tr_b16 a[236:237], v11 offset:34816
v_mfma_f32_16x16x32_bf16 v[100:103], a[148:151], v[68:71], v[100:103]
buffer_load_dwordx4 v2, s[8:11], s35 offen offset:1024 sc1 lds
v_mfma_f32_16x16x32_bf16 v[100:103], a[144:147], v[64:67], v[100:103]
ds_read_b64_tr_b16 a[216:217], v14 offset:32768
ds_read_b64_tr_b16 a[252:253], v15 offset:34816
v_mfma_f32_16x16x32_bf16 v[104:107], a[160:163], v[64:67], v[152:155]
v_exp_f32 v115, v115
v_mfma_f32_16x16x32_bf16 v[104:107], a[164:167], v[68:71], v[104:107]
v_exp_f32 v116, v116
v_mfma_f32_16x16x32_bf16 v[104:107], a[168:171], v[72:75], v[104:107]
ds_read_b64_tr_b16 a[242:243], v12 offset:35840
ds_read_b64_tr_b16 a[244:245], v13 offset:34816
v_mfma_f32_16x16x32_bf16 v[104:107], a[172:175], v[76:79], v[104:107]
v_exp_f32 v117, v117
v_mfma_f32_16x16x32_bf16 v[108:111], a[188:191], v[76:79], v[152:155]
buffer_load_dwordx4 v2, s[8:11], s35 offen offset:2048 sc1 lds
v_mfma_f32_16x16x32_bf16 v[108:111], a[184:187], v[72:75], v[108:111]
ds_read_b64_tr_b16 a[238:239], v11 offset:35840
ds_read_b64_tr_b16 a[204:205], v11 offset:32768
v_mfma_f32_16x16x32_bf16 v[108:111], a[180:183], v[68:71], v[108:111]
v_exp_f32 v118, v118
v_mfma_f32_16x16x32_bf16 v[108:111], a[176:179], v[64:67], v[108:111]
s_waitcnt lgkmcnt(4)
ds_read_b64_tr_b16 a[206:207], v11 offset:33792
ds_read_b64_tr_b16 a[210:211], v12 offset:33792
v_mfma_f32_16x16x32_bf16 a[0:3], a[192:195], v[128:131], a[0:3]
v_exp_f32 v119, v119
v_mfma_f32_16x16x32_bf16 a[0:3], a[224:227], v[132:135], a[0:3]
ds_read_b64_tr_b16 a[240:241], v12 offset:34816
ds_read_b64_tr_b16 a[218:219], v14 offset:33792
v_mfma_f32_16x16x32_bf16 a[16:19], a[228:231], v[132:135], a[16:19]
v_exp_f32 v120, v120
v_mfma_f32_16x16x32_bf16 a[16:19], a[196:199], v[128:131], a[16:19]
buffer_load_dwordx4 v2, s[8:11], s35 offen offset:3072 sc1 lds
v_mfma_f32_16x16x32_bf16 a[32:35], a[200:203], v[128:131], a[32:35]
ds_read_b64_tr_b16 a[220:221], v15 offset:32768
v_mfma_f32_16x16x32_bf16 a[32:35], a[232:235], v[132:135], a[32:35]
s_waitcnt lgkmcnt(3)
v_exp_f32 v121, v121
v_mfma_f32_16x16x32_bf16 a[48:51], a[236:239], v[132:135], a[48:51]
ds_read_b64_tr_b16 a[254:255], v15 offset:35840
v_mfma_f32_16x16x32_bf16 a[48:51], a[204:207], v[128:131], a[48:51]
s_add_u32 s35, s35, s3
v_exp_f32 v122, v122
v_mfma_f32_16x16x32_bf16 a[64:67], a[208:211], v[128:131], a[64:67]
s_waitcnt lgkmcnt(2)
s_cmp_lt_u32 s34, 0x80000
v_exp_f32 v123, v123
v_mfma_f32_16x16x32_bf16 a[64:67], a[240:243], v[132:135], a[64:67]
s_cselect_b32 s4, s38, s42
v_exp_f32 v124, v124
v_mfma_f32_16x16x32_bf16 a[80:83], a[244:247], v[132:135], a[80:83]
s_cselect_b32 s5, s39, s43
v_exp_f32 v125, v125
v_mfma_f32_16x16x32_bf16 a[80:83], a[212:215], v[128:131], a[80:83]
s_cselect_b32 s3, 0x4000, s48
v_cvt_pk_bf16_f32 v136, v112, v113
v_cvt_pk_bf16_f32 v137, v114, v115
v_mfma_f32_16x16x32_bf16 a[96:99], a[216:219], v[128:131], a[96:99]
s_add_u32 m0, s33, 32768
v_cvt_pk_bf16_f32 v139, v118, v119
v_cvt_pk_bf16_f32 v140, v120, v121
v_mfma_f32_16x16x32_bf16 a[96:99], a[248:251], v[132:135], a[96:99]
s_waitcnt lgkmcnt(0)
buffer_load_dwordx4 v1, s[4:7], s34 offen offset:0 sc1 lds
v_mfma_f32_16x16x32_bf16 a[112:115], a[252:255], v[132:135], a[112:115]
v_cvt_pk_bf16_f32 v138, v116, v117
v_cvt_pk_bf16_f32 v141, v122, v123
v_mfma_f32_16x16x32_bf16 a[112:115], a[220:223], v[128:131], a[112:115]
v_exp_f32 v126, v126
v_mfma_f32_16x16x32_bf16 v[216:219], v[208:211], v[128:131], v[216:219]
v_exp_f32 v127, v127
v_mfma_f32_16x16x32_bf16 v[216:219], v[208:211], v[132:135], v[216:219]
v_cvt_pk_bf16_f32 v142, v124, v125
v_cvt_pk_bf16_f32 v143, v126, v127
v_mfma_f32_16x16x32_bf16 v[112:115], a[128:131], v[80:83], v[156:159]
v_exp_f32 v96, v96
v_mfma_f32_16x16x32_bf16 v[112:115], a[132:135], v[84:87], v[112:115]
v_exp_f32 v97, v97
v_mfma_f32_16x16x32_bf16 v[112:115], a[136:139], v[88:91], v[112:115]
v_exp_f32 v98, v98
v_mfma_f32_16x16x32_bf16 v[112:115], a[140:143], v[92:95], v[112:115]
v_exp_f32 v99, v99
v_mfma_f32_16x16x32_bf16 v[116:119], a[156:159], v[92:95], v[156:159]
ds_read_b128 a[128:131], v4 offset:49152
v_cvt_pk_bf16_f32 v128, v96, v97
v_mfma_f32_16x16x32_bf16 v[116:119], a[152:155], v[88:91], v[116:119]
v_exp_f32 v100, v100
v_mfma_f32_16x16x32_bf16 v[116:119], a[148:151], v[84:87], v[116:119]
ds_read_b128 a[132:135], v5 offset:49152
v_add_f32 v164, v164, v100
v_mfma_f32_16x16x32_bf16 v[116:119], a[144:147], v[80:83], v[116:119]
v_exp_f32 v101, v101
v_mfma_f32_16x16x32_bf16 v[120:123], a[160:163], v[80:83], v[156:159]
ds_read_b128 a[148:151], v5 offset:50176
v_exp_f32 v102, v102
v_mfma_f32_16x16x32_bf16 v[120:123], a[164:167], v[84:87], v[120:123]
v_exp_f32 v103, v103
v_mfma_f32_16x16x32_bf16 v[120:123], a[168:171], v[88:91], v[120:123]
ds_read_b128 a[160:163], v4 offset:51200
v_exp_f32 v104, v104
v_mfma_f32_16x16x32_bf16 v[120:123], a[172:175], v[92:95], v[120:123]
v_exp_f32 v105, v105
v_mfma_f32_16x16x32_bf16 v[124:127], a[188:191], v[92:95], v[156:159]
ds_read_b128 a[152:155], v6 offset:50176
v_add_f32 v164, v164, v104
v_mfma_f32_16x16x32_bf16 v[124:127], a[184:187], v[88:91], v[124:127]
v_exp_f32 v106, v106
v_mfma_f32_16x16x32_bf16 v[124:127], a[180:183], v[84:87], v[124:127]
ds_read_b128 a[168:171], v6 offset:51200
v_cvt_pk_bf16_f32 v131, v102, v103
v_mfma_f32_16x16x32_bf16 v[124:127], a[176:179], v[80:83], v[124:127]
v_exp_f32 v107, v107
v_mfma_f32_16x16x32_bf16 a[4:7], a[192:195], v[136:139], a[4:7]
ds_read_b128 a[144:147], v4 offset:50176
v_add_f32 v165, v165, v105
v_mfma_f32_16x16x32_bf16 a[4:7], a[224:227], v[140:143], a[4:7]
v_exp_f32 v108, v108
v_mfma_f32_16x16x32_bf16 a[20:23], a[228:231], v[140:143], a[20:23]
v_add_f32 v165, v165, v101
v_add_f32 v164, v164, v108
v_mfma_f32_16x16x32_bf16 a[20:23], a[196:199], v[136:139], a[20:23]
ds_read_b128 a[140:143], v7 offset:49152
v_add_f32 v165, v165, v99
v_mfma_f32_16x16x32_bf16 a[36:39], a[200:203], v[136:139], a[36:39]
v_exp_f32 v109, v109
v_mfma_f32_16x16x32_bf16 a[36:39], a[232:235], v[140:143], a[36:39]
v_add_f32 v165, v165, v109
v_cvt_pk_bf16_f32 v134, v108, v109
v_mfma_f32_16x16x32_bf16 a[52:55], a[236:239], v[140:143], a[52:55]
ds_read_b128 a[188:191], v7 offset:52224
v_add_f32 v164, v164, v106
v_mfma_f32_16x16x32_bf16 a[52:55], a[204:207], v[136:139], a[52:55]
v_cvt_pk_bf16_f32 v130, v100, v101
v_cvt_pk_bf16_f32 v132, v104, v105
v_mfma_f32_16x16x32_bf16 a[68:71], a[208:211], v[136:139], a[68:71]
ds_read_b128 a[136:139], v6 offset:49152
v_add_f32 v165, v165, v103
v_mfma_f32_16x16x32_bf16 a[68:71], a[240:243], v[140:143], a[68:71]
v_cvt_pk_bf16_f32 v129, v98, v99
v_add_f32 v165, v165, v107
v_mfma_f32_16x16x32_bf16 a[84:87], a[244:247], v[140:143], a[84:87]
ds_read_b128 a[156:159], v7 offset:50176
v_add_f32 v164, v164, v102
v_mfma_f32_16x16x32_bf16 a[84:87], a[212:215], v[136:139], a[84:87]
v_exp_f32 v110, v110
v_mfma_f32_16x16x32_bf16 a[100:103], a[216:219], v[136:139], a[100:103]
ds_read_b128 a[172:175], v7 offset:51200
v_cvt_pk_bf16_f32 v133, v106, v107
v_mfma_f32_16x16x32_bf16 a[100:103], a[248:251], v[140:143], a[100:103]
v_add_f32 v164, v164, v98
v_add_f32 v164, v164, v110
v_mfma_f32_16x16x32_bf16 a[116:119], a[252:255], v[140:143], a[116:119]
ds_read_b128 a[180:183], v5 offset:52224
v_add_f32 v165, v165, v97
v_mfma_f32_16x16x32_bf16 a[116:119], a[220:223], v[136:139], a[116:119]
v_exp_f32 v111, v111
v_mfma_f32_16x16x32_bf16 v[220:223], v[208:211], v[136:139], v[220:223]
ds_read_b128 a[164:167], v5 offset:51200
v_cvt_pk_bf16_f32 v135, v110, v111
v_mfma_f32_16x16x32_bf16 v[220:223], v[208:211], v[140:143], v[220:223]
s_waitcnt lgkmcnt(3)
v_add_f32 v164, v164, v96
v_add_f32 v165, v165, v111
v_mfma_f32_16x16x32_bf16 v[96:99], a[128:131], v[32:35], v[144:147]
buffer_load_dwordx4 v1, s[4:7], s34 offen offset:1024 sc1 lds
v_mfma_f32_16x16x32_bf16 v[96:99], a[132:135], v[36:39], v[96:99]
v_exp_f32 v112, v112
v_mfma_f32_16x16x32_bf16 v[96:99], a[136:139], v[40:43], v[96:99]
v_exp_f32 v113, v113
v_mfma_f32_16x16x32_bf16 v[96:99], a[140:143], v[44:47], v[96:99]
ds_read_b128 a[184:187], v6 offset:52224
v_add_f32 v166, v166, v112
v_mfma_f32_16x16x32_bf16 v[100:103], a[156:159], v[44:47], v[144:147]
v_exp_f32 v114, v114
v_mfma_f32_16x16x32_bf16 v[100:103], a[152:155], v[40:43], v[100:103]
v_exp_f32 v115, v115
v_mfma_f32_16x16x32_bf16 v[100:103], a[148:151], v[36:39], v[100:103]
v_exp_f32 v116, v116
v_mfma_f32_16x16x32_bf16 v[100:103], a[144:147], v[32:35], v[100:103]
ds_read_b128 a[176:179], v4 offset:52224
v_add_f32 v167, v167, v115
v_mfma_f32_16x16x32_bf16 v[104:107], a[160:163], v[32:35], v[144:147]
s_waitcnt lgkmcnt(2)
v_exp_f32 v117, v117
v_mfma_f32_16x16x32_bf16 v[104:107], a[164:167], v[36:39], v[104:107]
v_exp_f32 v118, v118
v_mfma_f32_16x16x32_bf16 v[104:107], a[168:171], v[40:43], v[104:107]
v_exp_f32 v119, v119
v_mfma_f32_16x16x32_bf16 v[104:107], a[172:175], v[44:47], v[104:107]
v_exp_f32 v120, v120
v_mfma_f32_16x16x32_bf16 v[108:111], a[188:191], v[44:47], v[144:147]
s_waitcnt lgkmcnt(1)
v_exp_f32 v121, v121
v_mfma_f32_16x16x32_bf16 v[108:111], a[184:187], v[40:43], v[108:111]
v_exp_f32 v122, v122
v_mfma_f32_16x16x32_bf16 v[108:111], a[180:183], v[36:39], v[108:111]
s_waitcnt lgkmcnt(0)
v_exp_f32 v123, v123
v_mfma_f32_16x16x32_bf16 v[108:111], a[176:179], v[32:35], v[108:111]
v_exp_f32 v124, v124
v_mfma_f32_16x16x32_bf16 a[8:11], a[192:195], v[128:131], a[8:11]
v_exp_f32 v125, v125
v_mfma_f32_16x16x32_bf16 a[8:11], a[224:227], v[132:135], a[8:11]
v_cvt_pk_bf16_f32 v137, v114, v115
v_cvt_pk_bf16_f32 v140, v120, v121
v_mfma_f32_16x16x32_bf16 a[24:27], a[228:231], v[132:135], a[24:27]
v_exp_f32 v126, v126
v_mfma_f32_16x16x32_bf16 a[24:27], a[196:199], v[128:131], a[24:27]
buffer_load_dwordx4 v1, s[4:7], s34 offen offset:2048 sc1 lds
v_mfma_f32_16x16x32_bf16 a[40:43], a[200:203], v[128:131], a[40:43]
v_exp_f32 v127, v127
v_mfma_f32_16x16x32_bf16 a[40:43], a[232:235], v[132:135], a[40:43]
v_add_f32 v167, v167, v121
v_add_f32 v166, v166, v124
v_mfma_f32_16x16x32_bf16 a[56:59], a[236:239], v[132:135], a[56:59]
v_add_f32 v166, v166, v114
v_add_f32 v166, v166, v122
v_mfma_f32_16x16x32_bf16 a[56:59], a[204:207], v[128:131], a[56:59]
v_cvt_pk_bf16_f32 v138, v116, v117
v_add_f32 v166, v166, v126
v_mfma_f32_16x16x32_bf16 a[72:75], a[208:211], v[128:131], a[72:75]
v_add_f32 v167, v167, v119
v_add_f32 v167, v167, v123
v_mfma_f32_16x16x32_bf16 a[72:75], a[240:243], v[132:135], a[72:75]
v_cvt_pk_bf16_f32 v142, v124, v125
v_cvt_pk_bf16_f32 v143, v126, v127
v_mfma_f32_16x16x32_bf16 a[88:91], a[244:247], v[132:135], a[88:91]
v_add_f32 v166, v166, v116
v_add_f32 v167, v167, v125
v_mfma_f32_16x16x32_bf16 a[88:91], a[212:215], v[128:131], a[88:91]
v_cvt_pk_bf16_f32 v139, v118, v119
v_cvt_pk_bf16_f32 v141, v122, v123
v_mfma_f32_16x16x32_bf16 a[104:107], a[216:219], v[128:131], a[104:107]
v_add_f32 v167, v167, v117
v_add_f32 v166, v166, v120
v_mfma_f32_16x16x32_bf16 a[104:107], a[248:251], v[132:135], a[104:107]
v_cvt_pk_bf16_f32 v136, v112, v113
v_add_f32 v167, v167, v127
v_mfma_f32_16x16x32_bf16 a[120:123], a[252:255], v[132:135], a[120:123]
buffer_load_dwordx4 v1, s[4:7], s34 offen offset:3072 sc1 lds
v_mfma_f32_16x16x32_bf16 a[120:123], a[220:223], v[128:131], a[120:123]
s_add_u32 s34, s34, s3
v_add_f32 v167, v167, v113
v_add_f32 v166, v166, v118
v_mfma_f32_16x16x32_bf16 v[112:115], a[128:131], v[48:51], v[148:151]
v_exp_f32 v96, v96
v_mfma_f32_16x16x32_bf16 v[112:115], a[132:135], v[52:55], v[112:115]
v_exp_f32 v97, v97
v_mfma_f32_16x16x32_bf16 v[112:115], a[136:139], v[56:59], v[112:115]
v_exp_f32 v98, v98
v_mfma_f32_16x16x32_bf16 v[112:115], a[140:143], v[60:63], v[112:115]
v_exp_f32 v99, v99
v_mfma_f32_16x16x32_bf16 v[116:119], a[156:159], v[60:63], v[148:151]
v_exp_f32 v100, v100
v_mfma_f32_16x16x32_bf16 v[116:119], a[152:155], v[56:59], v[116:119]
v_cvt_pk_bf16_f32 v128, v96, v97
v_cvt_pk_bf16_f32 v129, v98, v99
v_mfma_f32_16x16x32_bf16 v[116:119], a[148:151], v[52:55], v[116:119]
v_exp_f32 v101, v101
v_mfma_f32_16x16x32_bf16 v[116:119], a[144:147], v[48:51], v[116:119]
v_exp_f32 v102, v102
v_mfma_f32_16x16x32_bf16 v[120:123], a[160:163], v[48:51], v[148:151]
v_exp_f32 v103, v103
v_mfma_f32_16x16x32_bf16 v[120:123], a[164:167], v[52:55], v[120:123]
v_cvt_pk_bf16_f32 v130, v100, v101
v_cvt_pk_bf16_f32 v131, v102, v103
v_mfma_f32_16x16x32_bf16 v[120:123], a[168:171], v[56:59], v[120:123]
v_exp_f32 v104, v104
v_mfma_f32_16x16x32_bf16 v[120:123], a[172:175], v[60:63], v[120:123]
v_exp_f32 v105, v105
v_mfma_f32_16x16x32_bf16 v[124:127], a[188:191], v[60:63], v[148:151]
v_exp_f32 v106, v106
v_mfma_f32_16x16x32_bf16 v[124:127], a[184:187], v[56:59], v[124:127]
v_exp_f32 v107, v107
v_mfma_f32_16x16x32_bf16 v[124:127], a[180:183], v[52:55], v[124:127]
v_exp_f32 v108, v108
v_mfma_f32_16x16x32_bf16 v[124:127], a[176:179], v[48:51], v[124:127]
s_waitcnt vmcnt(16)
v_exp_f32 v109, v109
v_mfma_f32_16x16x32_bf16 a[12:15], a[192:195], v[136:139], a[12:15]
s_barrier
v_cvt_pk_bf16_f32 v134, v108, v109
v_mfma_f32_16x16x32_bf16 a[12:15], a[224:227], v[140:143], a[12:15]
ds_read_b64_tr_b16 a[224:225], v8 offset:51200
v_mfma_f32_16x16x32_bf16 a[28:31], a[228:231], v[140:143], a[28:31]
ds_read_b64_tr_b16 a[194:195], v8 offset:50176
v_mfma_f32_16x16x32_bf16 a[28:31], a[196:199], v[136:139], a[28:31]
v_exp_f32 v110, v110
v_mfma_f32_16x16x32_bf16 a[44:47], a[200:203], v[136:139], a[44:47]
ds_read_b64_tr_b16 a[202:203], v10 offset:50176
v_mfma_f32_16x16x32_bf16 a[44:47], a[232:235], v[140:143], a[44:47]
s_cmp_lt_u32 s35, 0x80000
ds_read_b64_tr_b16 a[234:235], v10 offset:52224
v_mfma_f32_16x16x32_bf16 a[60:63], a[236:239], v[140:143], a[60:63]
s_cselect_b32 s8, s40, s36
ds_read_b64_tr_b16 a[232:233], v10 offset:51200
v_mfma_f32_16x16x32_bf16 a[60:63], a[204:207], v[136:139], a[60:63]
s_cselect_b32 s9, s41, s37
ds_read_b64_tr_b16 a[198:199], v9 offset:50176
v_cvt_pk_bf16_f32 v133, v106, v107
v_mfma_f32_16x16x32_bf16 a[76:79], a[208:211], v[136:139], a[76:79]
s_cselect_b32 s3, 0x4000, s48
v_exp_f32 v111, v111
v_mfma_f32_16x16x32_bf16 a[76:79], a[240:243], v[140:143], a[76:79]
s_add_u32 m0, s33, 98304
ds_read_b64_tr_b16 a[226:227], v8 offset:52224
ds_read_b64_tr_b16 a[200:201], v10 offset:49152
v_mfma_f32_16x16x32_bf16 a[92:95], a[244:247], v[140:143], a[92:95]
buffer_load_dwordx4 v2, s[8:11], s35 offen offset:0 sc1 lds
v_mfma_f32_16x16x32_bf16 a[92:95], a[212:215], v[136:139], a[92:95]
ds_read_b64_tr_b16 a[230:231], v9 offset:52224
ds_read_b64_tr_b16 a[196:197], v9 offset:49152
v_mfma_f32_16x16x32_bf16 a[108:111], a[216:219], v[136:139], a[108:111]
v_cvt_pk_bf16_f32 v132, v104, v105
v_cvt_pk_bf16_f32 v135, v110, v111
v_mfma_f32_16x16x32_bf16 a[108:111], a[248:251], v[140:143], a[108:111]
ds_read_b64_tr_b16 a[248:249], v14 offset:51200
ds_read_b64_tr_b16 a[250:251], v14 offset:52224
v_mfma_f32_16x16x32_bf16 a[124:127], a[252:255], v[140:143], a[124:127]
v_mfma_f32_16x16x32_bf16 a[124:127], a[220:223], v[136:139], a[124:127]
ds_read_b64_tr_b16 a[192:193], v8 offset:49152
ds_read_b64_tr_b16 a[208:209], v12 offset:49152
v_mfma_f32_16x16x32_bf16 v[96:99], a[128:131], v[64:67], v[152:155]
v_exp_f32 v112, v112
v_mfma_f32_16x16x32_bf16 v[96:99], a[132:135], v[68:71], v[96:99]
ds_read_b64_tr_b16 a[212:213], v13 offset:49152
ds_read_b64_tr_b16 a[222:223], v15 offset:50176
v_mfma_f32_16x16x32_bf16 v[96:99], a[136:139], v[72:75], v[96:99]
v_exp_f32 v113, v113
v_mfma_f32_16x16x32_bf16 v[96:99], a[140:143], v[76:79], v[96:99]
ds_read_b64_tr_b16 a[246:247], v13 offset:52224
ds_read_b64_tr_b16 a[214:215], v13 offset:50176
v_mfma_f32_16x16x32_bf16 v[100:103], a[156:159], v[76:79], v[152:155]
v_exp_f32 v114, v114
v_mfma_f32_16x16x32_bf16 v[100:103], a[152:155], v[72:75], v[100:103]
ds_read_b64_tr_b16 a[228:229], v9 offset:51200
ds_read_b64_tr_b16 a[236:237], v11 offset:51200
v_mfma_f32_16x16x32_bf16 v[100:103], a[148:151], v[68:71], v[100:103]
buffer_load_dwordx4 v2, s[8:11], s35 offen offset:1024 sc1 lds
v_mfma_f32_16x16x32_bf16 v[100:103], a[144:147], v[64:67], v[100:103]
ds_read_b64_tr_b16 a[216:217], v14 offset:49152
ds_read_b64_tr_b16 a[252:253], v15 offset:51200
v_mfma_f32_16x16x32_bf16 v[104:107], a[160:163], v[64:67], v[152:155]
v_exp_f32 v115, v115
v_mfma_f32_16x16x32_bf16 v[104:107], a[164:167], v[68:71], v[104:107]
v_exp_f32 v116, v116
v_mfma_f32_16x16x32_bf16 v[104:107], a[168:171], v[72:75], v[104:107]
ds_read_b64_tr_b16 a[242:243], v12 offset:52224
ds_read_b64_tr_b16 a[244:245], v13 offset:51200
v_mfma_f32_16x16x32_bf16 v[104:107], a[172:175], v[76:79], v[104:107]
v_exp_f32 v117, v117
v_mfma_f32_16x16x32_bf16 v[108:111], a[188:191], v[76:79], v[152:155]
buffer_load_dwordx4 v2, s[8:11], s35 offen offset:2048 sc1 lds
v_mfma_f32_16x16x32_bf16 v[108:111], a[184:187], v[72:75], v[108:111]
ds_read_b64_tr_b16 a[238:239], v11 offset:52224
ds_read_b64_tr_b16 a[204:205], v11 offset:49152
v_mfma_f32_16x16x32_bf16 v[108:111], a[180:183], v[68:71], v[108:111]
v_exp_f32 v118, v118
v_mfma_f32_16x16x32_bf16 v[108:111], a[176:179], v[64:67], v[108:111]
s_waitcnt lgkmcnt(4)
ds_read_b64_tr_b16 a[206:207], v11 offset:50176
ds_read_b64_tr_b16 a[210:211], v12 offset:50176
v_mfma_f32_16x16x32_bf16 a[0:3], a[192:195], v[128:131], a[0:3]
v_exp_f32 v119, v119
v_mfma_f32_16x16x32_bf16 a[0:3], a[224:227], v[132:135], a[0:3]
ds_read_b64_tr_b16 a[240:241], v12 offset:51200
ds_read_b64_tr_b16 a[218:219], v14 offset:50176
v_mfma_f32_16x16x32_bf16 a[16:19], a[228:231], v[132:135], a[16:19]
v_exp_f32 v120, v120
v_mfma_f32_16x16x32_bf16 a[16:19], a[196:199], v[128:131], a[16:19]
buffer_load_dwordx4 v2, s[8:11], s35 offen offset:3072 sc1 lds
v_mfma_f32_16x16x32_bf16 a[32:35], a[200:203], v[128:131], a[32:35]
ds_read_b64_tr_b16 a[220:221], v15 offset:49152
v_mfma_f32_16x16x32_bf16 a[32:35], a[232:235], v[132:135], a[32:35]
s_waitcnt lgkmcnt(3)
v_exp_f32 v121, v121
v_mfma_f32_16x16x32_bf16 a[48:51], a[236:239], v[132:135], a[48:51]
ds_read_b64_tr_b16 a[254:255], v15 offset:52224
v_mfma_f32_16x16x32_bf16 a[48:51], a[204:207], v[128:131], a[48:51]
s_add_u32 s35, s35, s3
v_exp_f32 v122, v122
v_mfma_f32_16x16x32_bf16 a[64:67], a[208:211], v[128:131], a[64:67]
s_waitcnt lgkmcnt(2)
s_cmp_lt_u32 s34, 0x80000
v_exp_f32 v123, v123
v_mfma_f32_16x16x32_bf16 a[64:67], a[240:243], v[132:135], a[64:67]
s_cselect_b32 s4, s38, s42
v_exp_f32 v124, v124
v_mfma_f32_16x16x32_bf16 a[80:83], a[244:247], v[132:135], a[80:83]
s_cselect_b32 s5, s39, s43
v_exp_f32 v125, v125
v_mfma_f32_16x16x32_bf16 a[80:83], a[212:215], v[128:131], a[80:83]
s_cselect_b32 s3, 0x4000, s48
v_cvt_pk_bf16_f32 v136, v112, v113
v_cvt_pk_bf16_f32 v137, v114, v115
v_mfma_f32_16x16x32_bf16 a[96:99], a[216:219], v[128:131], a[96:99]
s_add_u32 m0, s33, 49152
v_cvt_pk_bf16_f32 v139, v118, v119
v_cvt_pk_bf16_f32 v140, v120, v121
v_mfma_f32_16x16x32_bf16 a[96:99], a[248:251], v[132:135], a[96:99]
s_waitcnt lgkmcnt(0)
buffer_load_dwordx4 v1, s[4:7], s34 offen offset:0 sc1 lds
v_mfma_f32_16x16x32_bf16 a[112:115], a[252:255], v[132:135], a[112:115]
v_cvt_pk_bf16_f32 v138, v116, v117
v_cvt_pk_bf16_f32 v141, v122, v123
v_mfma_f32_16x16x32_bf16 a[112:115], a[220:223], v[128:131], a[112:115]
v_exp_f32 v126, v126
v_mfma_f32_16x16x32_bf16 v[216:219], v[208:211], v[128:131], v[216:219]
v_exp_f32 v127, v127
v_mfma_f32_16x16x32_bf16 v[216:219], v[208:211], v[132:135], v[216:219]
v_cvt_pk_bf16_f32 v142, v124, v125
v_cvt_pk_bf16_f32 v143, v126, v127
s_cmp_eq_u32 s62, 1
s_cbranch_scc1 LOOPX
v_mfma_f32_16x16x32_bf16 v[112:115], a[128:131], v[80:83], v[156:159]
v_exp_f32 v96, v96
v_mfma_f32_16x16x32_bf16 v[112:115], a[132:135], v[84:87], v[112:115]
v_exp_f32 v97, v97
v_mfma_f32_16x16x32_bf16 v[112:115], a[136:139], v[88:91], v[112:115]
v_exp_f32 v98, v98
v_mfma_f32_16x16x32_bf16 v[112:115], a[140:143], v[92:95], v[112:115]
v_exp_f32 v99, v99
v_mfma_f32_16x16x32_bf16 v[116:119], a[156:159], v[92:95], v[156:159]
ds_read_b128 a[128:131], v4 offset:0
v_cvt_pk_bf16_f32 v128, v96, v97
v_mfma_f32_16x16x32_bf16 v[116:119], a[152:155], v[88:91], v[116:119]
v_exp_f32 v100, v100
v_mfma_f32_16x16x32_bf16 v[116:119], a[148:151], v[84:87], v[116:119]
ds_read_b128 a[132:135], v5 offset:0
v_add_f32 v164, v164, v100
v_mfma_f32_16x16x32_bf16 v[116:119], a[144:147], v[80:83], v[116:119]
v_exp_f32 v101, v101
v_mfma_f32_16x16x32_bf16 v[120:123], a[160:163], v[80:83], v[156:159]
ds_read_b128 a[148:151], v5 offset:1024
v_exp_f32 v102, v102
v_mfma_f32_16x16x32_bf16 v[120:123], a[164:167], v[84:87], v[120:123]
v_exp_f32 v103, v103
v_mfma_f32_16x16x32_bf16 v[120:123], a[168:171], v[88:91], v[120:123]
ds_read_b128 a[160:163], v4 offset:2048
v_exp_f32 v104, v104
v_mfma_f32_16x16x32_bf16 v[120:123], a[172:175], v[92:95], v[120:123]
v_exp_f32 v105, v105
v_mfma_f32_16x16x32_bf16 v[124:127], a[188:191], v[92:95], v[156:159]
ds_read_b128 a[152:155], v6 offset:1024
v_add_f32 v164, v164, v104
v_mfma_f32_16x16x32_bf16 v[124:127], a[184:187], v[88:91], v[124:127]
v_exp_f32 v106, v106
v_mfma_f32_16x16x32_bf16 v[124:127], a[180:183], v[84:87], v[124:127]
ds_read_b128 a[168:171], v6 offset:2048
v_cvt_pk_bf16_f32 v131, v102, v103
v_mfma_f32_16x16x32_bf16 v[124:127], a[176:179], v[80:83], v[124:127]
v_exp_f32 v107, v107
v_mfma_f32_16x16x32_bf16 a[4:7], a[192:195], v[136:139], a[4:7]
ds_read_b128 a[144:147], v4 offset:1024
v_add_f32 v165, v165, v105
v_mfma_f32_16x16x32_bf16 a[4:7], a[224:227], v[140:143], a[4:7]
v_exp_f32 v108, v108
v_mfma_f32_16x16x32_bf16 a[20:23], a[228:231], v[140:143], a[20:23]
v_add_f32 v165, v165, v101
v_add_f32 v164, v164, v108
v_mfma_f32_16x16x32_bf16 a[20:23], a[196:199], v[136:139], a[20:23]
ds_read_b128 a[140:143], v7 offset:0
v_add_f32 v165, v165, v99
v_mfma_f32_16x16x32_bf16 a[36:39], a[200:203], v[136:139], a[36:39]
v_exp_f32 v109, v109
v_mfma_f32_16x16x32_bf16 a[36:39], a[232:235], v[140:143], a[36:39]
v_add_f32 v165, v165, v109
v_cvt_pk_bf16_f32 v134, v108, v109
v_mfma_f32_16x16x32_bf16 a[52:55], a[236:239], v[140:143], a[52:55]
ds_read_b128 a[188:191], v7 offset:3072
v_add_f32 v164, v164, v106
v_mfma_f32_16x16x32_bf16 a[52:55], a[204:207], v[136:139], a[52:55]
v_cvt_pk_bf16_f32 v130, v100, v101
v_cvt_pk_bf16_f32 v132, v104, v105
v_mfma_f32_16x16x32_bf16 a[68:71], a[208:211], v[136:139], a[68:71]
ds_read_b128 a[136:139], v6 offset:0
v_add_f32 v165, v165, v103
v_mfma_f32_16x16x32_bf16 a[68:71], a[240:243], v[140:143], a[68:71]
v_cvt_pk_bf16_f32 v129, v98, v99
v_add_f32 v165, v165, v107
v_mfma_f32_16x16x32_bf16 a[84:87], a[244:247], v[140:143], a[84:87]
ds_read_b128 a[156:159], v7 offset:1024
v_add_f32 v164, v164, v102
v_mfma_f32_16x16x32_bf16 a[84:87], a[212:215], v[136:139], a[84:87]
v_exp_f32 v110, v110
v_mfma_f32_16x16x32_bf16 a[100:103], a[216:219], v[136:139], a[100:103]
ds_read_b128 a[172:175], v7 offset:2048
v_cvt_pk_bf16_f32 v133, v106, v107
v_mfma_f32_16x16x32_bf16 a[100:103], a[248:251], v[140:143], a[100:103]
v_add_f32 v164, v164, v98
v_add_f32 v164, v164, v110
v_mfma_f32_16x16x32_bf16 a[116:119], a[252:255], v[140:143], a[116:119]
ds_read_b128 a[180:183], v5 offset:3072
v_add_f32 v165, v165, v97
v_mfma_f32_16x16x32_bf16 a[116:119], a[220:223], v[136:139], a[116:119]
v_exp_f32 v111, v111
v_mfma_f32_16x16x32_bf16 v[220:223], v[208:211], v[136:139], v[220:223]
ds_read_b128 a[164:167], v5 offset:2048
v_cvt_pk_bf16_f32 v135, v110, v111
v_mfma_f32_16x16x32_bf16 v[220:223], v[208:211], v[140:143], v[220:223]
s_waitcnt lgkmcnt(3)
v_add_f32 v164, v164, v96
v_add_f32 v165, v165, v111
v_mfma_f32_16x16x32_bf16 v[96:99], a[128:131], v[32:35], v[144:147]
buffer_load_dwordx4 v1, s[4:7], s34 offen offset:1024 sc1 lds
v_mfma_f32_16x16x32_bf16 v[96:99], a[132:135], v[36:39], v[96:99]
v_exp_f32 v112, v112
v_mfma_f32_16x16x32_bf16 v[96:99], a[136:139], v[40:43], v[96:99]
v_exp_f32 v113, v113
v_mfma_f32_16x16x32_bf16 v[96:99], a[140:143], v[44:47], v[96:99]
ds_read_b128 a[184:187], v6 offset:3072
v_add_f32 v166, v166, v112
v_mfma_f32_16x16x32_bf16 v[100:103], a[156:159], v[44:47], v[144:147]
v_exp_f32 v114, v114
v_mfma_f32_16x16x32_bf16 v[100:103], a[152:155], v[40:43], v[100:103]
v_exp_f32 v115, v115
v_mfma_f32_16x16x32_bf16 v[100:103], a[148:151], v[36:39], v[100:103]
v_exp_f32 v116, v116
v_mfma_f32_16x16x32_bf16 v[100:103], a[144:147], v[32:35], v[100:103]
ds_read_b128 a[176:179], v4 offset:3072
v_add_f32 v167, v167, v115
v_mfma_f32_16x16x32_bf16 v[104:107], a[160:163], v[32:35], v[144:147]
s_waitcnt lgkmcnt(2)
v_exp_f32 v117, v117
v_mfma_f32_16x16x32_bf16 v[104:107], a[164:167], v[36:39], v[104:107]
v_exp_f32 v118, v118
v_mfma_f32_16x16x32_bf16 v[104:107], a[168:171], v[40:43], v[104:107]
v_exp_f32 v119, v119
v_mfma_f32_16x16x32_bf16 v[104:107], a[172:175], v[44:47], v[104:107]
v_exp_f32 v120, v120
v_mfma_f32_16x16x32_bf16 v[108:111], a[188:191], v[44:47], v[144:147]
s_waitcnt lgkmcnt(1)
v_exp_f32 v121, v121
v_mfma_f32_16x16x32_bf16 v[108:111], a[184:187], v[40:43], v[108:111]
v_exp_f32 v122, v122
v_mfma_f32_16x16x32_bf16 v[108:111], a[180:183], v[36:39], v[108:111]
s_waitcnt lgkmcnt(0)
v_exp_f32 v123, v123
v_mfma_f32_16x16x32_bf16 v[108:111], a[176:179], v[32:35], v[108:111]
v_exp_f32 v124, v124
v_mfma_f32_16x16x32_bf16 a[8:11], a[192:195], v[128:131], a[8:11]
v_exp_f32 v125, v125
v_mfma_f32_16x16x32_bf16 a[8:11], a[224:227], v[132:135], a[8:11]
v_cvt_pk_bf16_f32 v137, v114, v115
v_cvt_pk_bf16_f32 v140, v120, v121
v_mfma_f32_16x16x32_bf16 a[24:27], a[228:231], v[132:135], a[24:27]
v_exp_f32 v126, v126
v_mfma_f32_16x16x32_bf16 a[24:27], a[196:199], v[128:131], a[24:27]
buffer_load_dwordx4 v1, s[4:7], s34 offen offset:2048 sc1 lds
v_mfma_f32_16x16x32_bf16 a[40:43], a[200:203], v[128:131], a[40:43]
v_exp_f32 v127, v127
v_mfma_f32_16x16x32_bf16 a[40:43], a[232:235], v[132:135], a[40:43]
v_add_f32 v167, v167, v121
v_add_f32 v166, v166, v124
v_mfma_f32_16x16x32_bf16 a[56:59], a[236:239], v[132:135], a[56:59]
v_add_f32 v166, v166, v114
v_add_f32 v166, v166, v122
v_mfma_f32_16x16x32_bf16 a[56:59], a[204:207], v[128:131], a[56:59]
v_cvt_pk_bf16_f32 v138, v116, v117
v_add_f32 v166, v166, v126
v_mfma_f32_16x16x32_bf16 a[72:75], a[208:211], v[128:131], a[72:75]
v_add_f32 v167, v167, v119
v_add_f32 v167, v167, v123
v_mfma_f32_16x16x32_bf16 a[72:75], a[240:243], v[132:135], a[72:75]
v_cvt_pk_bf16_f32 v142, v124, v125
v_cvt_pk_bf16_f32 v143, v126, v127
v_mfma_f32_16x16x32_bf16 a[88:91], a[244:247], v[132:135], a[88:91]
v_add_f32 v166, v166, v116
v_add_f32 v167, v167, v125
v_mfma_f32_16x16x32_bf16 a[88:91], a[212:215], v[128:131], a[88:91]
v_cvt_pk_bf16_f32 v139, v118, v119
v_cvt_pk_bf16_f32 v141, v122, v123
v_mfma_f32_16x16x32_bf16 a[104:107], a[216:219], v[128:131], a[104:107]
v_add_f32 v167, v167, v117
v_add_f32 v166, v166, v120
v_mfma_f32_16x16x32_bf16 a[104:107], a[248:251], v[132:135], a[104:107]
v_cvt_pk_bf16_f32 v136, v112, v113
v_add_f32 v167, v167, v127
v_mfma_f32_16x16x32_bf16 a[120:123], a[252:255], v[132:135], a[120:123]
buffer_load_dwordx4 v1, s[4:7], s34 offen offset:3072 sc1 lds
v_mfma_f32_16x16x32_bf16 a[120:123], a[220:223], v[128:131], a[120:123]
s_add_u32 s34, s34, s3
v_add_f32 v167, v167, v113
v_add_f32 v166, v166, v118
s_sub_u32 s62, s62, 1
s_bitcmp1_b32 s49, s62
s_cbranch_scc0 LOOPW
s_branch SIDE
LOOPX:
s_mov_b32 s72, 0x20000
s_mov_b32 s73, 0x40000
v_mov_b32 v248, 1820327936
v_mfma_f32_16x16x32_bf16 v[112:115], a[128:131], v[80:83], v[156:159]
buffer_load_dwordx4 v1, s[4:7], s34 offen offset:1024 sc1 lds
v_mfma_f32_16x16x32_bf16 v[112:115], a[132:135], v[84:87], v[112:115]
buffer_load_dwordx4 v1, s[4:7], s34 offen offset:2048 sc1 lds
v_mfma_f32_16x16x32_bf16 v[112:115], a[136:139], v[88:91], v[112:115]
buffer_load_dwordx4 v1, s[4:7], s34 offen offset:3072 sc1 lds
v_mfma_f32_16x16x32_bf16 v[112:115], a[140:143], v[92:95], v[112:115]
s_mov_b32 s3, 0x60000
v_rcp_f32 v160, v216
v_mfma_f32_16x16x32_bf16 v[116:119], a[156:159], v[92:95], v[156:159]
s_mov_b32 s31, 0
buffer_load_dwordx4 a[128:131], v30, s[12:15], s31 offen offset:0 sc1
v_mfma_f32_16x16x32_bf16 v[116:119], a[152:155], v[88:91], v[116:119]
buffer_load_dwordx4 a[132:135], v30, s[12:15], s31 offen offset:1024 sc1
v_mfma_f32_16x16x32_bf16 v[116:119], a[148:151], v[84:87], v[116:119]
buffer_load_dwordx4 a[136:139], v30, s[12:15], s31 offen offset:2048 sc1
v_mfma_f32_16x16x32_bf16 v[116:119], a[144:147], v[80:83], v[116:119]
buffer_load_dwordx4 a[140:143], v30, s[12:15], s31 offen offset:3072 sc1
v_mfma_f32_16x16x32_bf16 v[120:123], a[160:163], v[80:83], v[156:159]
v_accvgpr_read_b32 v188, a0
v_accvgpr_read_b32 v189, a1
v_mfma_f32_16x16x32_bf16 v[120:123], a[164:167], v[84:87], v[120:123]
v_accvgpr_read_b32 v190, a2
v_accvgpr_read_b32 v191, a3
v_mfma_f32_16x16x32_bf16 v[120:123], a[168:171], v[88:91], v[120:123]
s_mov_b32 s31, 4096
buffer_load_dwordx4 a[144:147], v30, s[12:15], s31 offen offset:0 sc1
v_mfma_f32_16x16x32_bf16 v[120:123], a[172:175], v[92:95], v[120:123]
buffer_load_dwordx4 a[148:151], v30, s[12:15], s31 offen offset:1024 sc1
v_mfma_f32_16x16x32_bf16 v[124:127], a[188:191], v[92:95], v[156:159]
buffer_load_dwordx4 a[152:155], v30, s[12:15], s31 offen offset:2048 sc1
v_mfma_f32_16x16x32_bf16 v[124:127], a[184:187], v[88:91], v[124:127]
buffer_load_dwordx4 a[156:159], v30, s[12:15], s31 offen offset:3072 sc1
v_mfma_f32_16x16x32_bf16 v[124:127], a[180:183], v[84:87], v[124:127]
s_mov_b32 s31, 8192
buffer_load_dwordx4 a[160:163], v30, s[12:15], s31 offen offset:0 sc1
v_mfma_f32_16x16x32_bf16 v[124:127], a[176:179], v[80:83], v[124:127]
buffer_load_dwordx4 a[164:167], v30, s[12:15], s31 offen offset:1024 sc1
v_mfma_f32_16x16x32_bf16 a[4:7], a[192:195], v[136:139], a[4:7]
buffer_load_dwordx4 a[168:171], v30, s[12:15], s31 offen offset:2048 sc1
v_mfma_f32_16x16x32_bf16 a[4:7], a[224:227], v[140:143], a[4:7]
buffer_load_dwordx4 a[172:175], v30, s[12:15], s31 offen offset:3072 sc1
v_mfma_f32_16x16x32_bf16 a[20:23], a[228:231], v[140:143], a[20:23]
v_accvgpr_read_b32 v192, a16
v_accvgpr_read_b32 v193, a17
v_mfma_f32_16x16x32_bf16 a[20:23], a[196:199], v[136:139], a[20:23]
v_accvgpr_read_b32 v194, a18
v_accvgpr_read_b32 v195, a19
v_mfma_f32_16x16x32_bf16 a[36:39], a[200:203], v[136:139], a[36:39]
v_mul_f32 v188, v160, v188
v_mul_f32 v189, v160, v189
v_mfma_f32_16x16x32_bf16 a[36:39], a[232:235], v[140:143], a[36:39]
v_mul_f32 v190, v160, v190
v_mul_f32 v191, v160, v191
v_mfma_f32_16x16x32_bf16 a[52:55], a[236:239], v[140:143], a[52:55]
v_mul_f32 v192, v160, v192
v_mul_f32 v193, v160, v193
v_mfma_f32_16x16x32_bf16 a[52:55], a[204:207], v[136:139], a[52:55]
v_mul_f32 v194, v160, v194
v_mul_f32 v195, v160, v195
v_mfma_f32_16x16x32_bf16 a[68:71], a[208:211], v[136:139], a[68:71]
v_cvt_pk_bf16_f32 v204, v188, v189
v_cvt_pk_bf16_f32 v205, v190, v191
v_mfma_f32_16x16x32_bf16 a[68:71], a[240:243], v[140:143], a[68:71]
v_cvt_pk_bf16_f32 v206, v192, v193
v_cvt_pk_bf16_f32 v207, v194, v195
v_mfma_f32_16x16x32_bf16 a[84:87], a[244:247], v[140:143], a[84:87]
buffer_store_dwordx4 v[204:207], v30, s[20:23], 0 offen offset:0 sc1
v_mfma_f32_16x16x32_bf16 a[84:87], a[212:215], v[136:139], a[84:87]
v_accvgpr_read_b32 v196, a32
v_accvgpr_read_b32 v197, a33
v_mfma_f32_16x16x32_bf16 a[100:103], a[216:219], v[136:139], a[100:103]
v_accvgpr_read_b32 v198, a34
v_accvgpr_read_b32 v199, a35
v_mfma_f32_16x16x32_bf16 a[100:103], a[248:251], v[140:143], a[100:103]
v_accvgpr_read_b32 v200, a48
v_accvgpr_read_b32 v201, a49
v_mfma_f32_16x16x32_bf16 a[116:119], a[252:255], v[140:143], a[116:119]
v_accvgpr_read_b32 v202, a50
v_accvgpr_read_b32 v203, a51
v_mfma_f32_16x16x32_bf16 a[116:119], a[220:223], v[136:139], a[116:119]
v_mul_f32 v196, v160, v196
v_mul_f32 v197, v160, v197
v_mfma_f32_16x16x32_bf16 v[220:223], v[208:211], v[136:139], v[220:223]
v_mul_f32 v198, v160, v198
v_mul_f32 v199, v160, v199
v_mfma_f32_16x16x32_bf16 v[220:223], v[208:211], v[140:143], v[220:223]
v_mul_f32 v200, v160, v200
v_mul_f32 v201, v160, v201
v_mul_f32 v202, v160, v202
v_mul_f32 v203, v160, v203
v_cvt_pk_bf16_f32 v244, v196, v197
v_cvt_pk_bf16_f32 v245, v198, v199
v_cvt_pk_bf16_f32 v246, v200, v201
v_cvt_pk_bf16_f32 v247, v202, v203
v_accvgpr_read_b32 v188, a64
v_accvgpr_read_b32 v189, a65
v_accvgpr_read_b32 v190, a66
v_accvgpr_read_b32 v191, a67
v_accvgpr_read_b32 v192, a80
v_accvgpr_read_b32 v193, a81
v_accvgpr_read_b32 v194, a82
v_accvgpr_read_b32 v195, a83
v_mul_f32 v188, v160, v188
v_mul_f32 v189, v160, v189
v_mul_f32 v190, v160, v190
v_mul_f32 v191, v160, v191
v_mul_f32 v192, v160, v192
v_mul_f32 v193, v160, v193
v_mul_f32 v194, v160, v194
v_mul_f32 v195, v160, v195
v_cvt_pk_bf16_f32 v204, v188, v189
v_cvt_pk_bf16_f32 v205, v190, v191
v_cvt_pk_bf16_f32 v206, v192, v193
v_cvt_pk_bf16_f32 v207, v194, v195
v_accvgpr_read_b32 v196, a96
v_accvgpr_read_b32 v197, a97
v_accvgpr_read_b32 v198, a98
v_accvgpr_read_b32 v199, a99
v_accvgpr_read_b32 v200, a112
v_accvgpr_read_b32 v201, a113
v_accvgpr_read_b32 v202, a114
v_accvgpr_read_b32 v203, a115
v_mul_f32 v196, v160, v196
v_mul_f32 v197, v160, v197
v_mul_f32 v198, v160, v198
v_mul_f32 v199, v160, v199
v_mul_f32 v200, v160, v200
v_mul_f32 v201, v160, v201
v_mul_f32 v202, v160, v202
v_mul_f32 v203, v160, v203
v_exp_f32 v96, v96
v_exp_f32 v97, v97
v_add_f32 v164, v164, v96
v_exp_f32 v98, v98
v_add_f32 v165, v165, v97
v_cvt_pk_bf16_f32 v128, v96, v97
v_exp_f32 v99, v99
v_add_f32 v164, v164, v98
v_exp_f32 v100, v100
v_add_f32 v165, v165, v99
v_cvt_pk_bf16_f32 v129, v98, v99
v_exp_f32 v101, v101
v_add_f32 v164, v164, v100
v_exp_f32 v102, v102
v_add_f32 v165, v165, v101
v_cvt_pk_bf16_f32 v130, v100, v101
v_exp_f32 v103, v103
v_add_f32 v164, v164, v102
v_exp_f32 v104, v104
v_add_f32 v165, v165, v103
v_cvt_pk_bf16_f32 v131, v102, v103
v_exp_f32 v105, v105
v_add_f32 v164, v164, v104
v_mfma_f32_16x16x32_bf16 a[8:11], a[192:195], v[128:131], a[8:11]
buffer_store_dwordx4 v[244:247], v30, s[20:23], s72 offen offset:0 sc1
v_mfma_f32_16x16x32_bf16 a[40:43], a[200:203], v[128:131], a[40:43]
buffer_store_dwordx4 v[204:207], v30, s[20:23], s73 offen offset:0 sc1
v_mfma_f32_16x16x32_bf16 a[72:75], a[208:211], v[128:131], a[72:75]
v_cvt_pk_bf16_f32 v244, v196, v197
v_cvt_pk_bf16_f32 v245, v198, v199
v_mfma_f32_16x16x32_bf16 a[104:107], a[216:219], v[128:131], a[104:107]
v_cvt_pk_bf16_f32 v246, v200, v201
v_cvt_pk_bf16_f32 v247, v202, v203
v_exp_f32 v106, v106
v_add_f32 v165, v165, v105
v_cvt_pk_bf16_f32 v132, v104, v105
v_exp_f32 v107, v107
v_add_f32 v164, v164, v106
v_exp_f32 v108, v108
v_add_f32 v165, v165, v107
v_cvt_pk_bf16_f32 v133, v106, v107
v_exp_f32 v109, v109
v_add_f32 v164, v164, v108
v_exp_f32 v110, v110
v_add_f32 v165, v165, v109
v_cvt_pk_bf16_f32 v134, v108, v109
v_exp_f32 v111, v111
v_add_f32 v164, v164, v110
v_cvt_pk_bf16_f32 v135, v110, v111
v_add_f32 v165, v165, v111
v_rcp_f32 v162, v220
v_mfma_f32_16x16x32_bf16 a[8:11], a[224:227], v[132:135], a[8:11]
buffer_store_dwordx4 v[244:247], v30, s[20:23], s3 offen offset:0 sc1
v_mfma_f32_16x16x32_bf16 a[24:27], a[228:231], v[132:135], a[24:27]
v_accvgpr_read_b32 v188, a4
v_accvgpr_read_b32 v189, a5
v_mfma_f32_16x16x32_bf16 a[24:27], a[196:199], v[128:131], a[24:27]
v_accvgpr_read_b32 v190, a6
v_accvgpr_read_b32 v191, a7
v_mfma_f32_16x16x32_bf16 a[40:43], a[232:235], v[132:135], a[40:43]
v_accvgpr_read_b32 v192, a20
v_accvgpr_read_b32 v193, a21
v_mfma_f32_16x16x32_bf16 a[56:59], a[236:239], v[132:135], a[56:59]
v_accvgpr_read_b32 v194, a22
v_accvgpr_read_b32 v195, a23
v_mfma_f32_16x16x32_bf16 a[56:59], a[204:207], v[128:131], a[56:59]
v_mul_f32 v188, v162, v188
v_mul_f32 v189, v162, v189
v_mfma_f32_16x16x32_bf16 a[72:75], a[240:243], v[132:135], a[72:75]
v_mul_f32 v190, v162, v190
v_mul_f32 v191, v162, v191
v_mfma_f32_16x16x32_bf16 a[88:91], a[244:247], v[132:135], a[88:91]
v_mul_f32 v192, v162, v192
v_mul_f32 v193, v162, v193
v_mfma_f32_16x16x32_bf16 a[88:91], a[212:215], v[128:131], a[88:91]
v_mul_f32 v194, v162, v194
v_mul_f32 v195, v162, v195
v_mfma_f32_16x16x32_bf16 a[104:107], a[248:251], v[132:135], a[104:107]
v_cvt_pk_bf16_f32 v204, v188, v189
v_cvt_pk_bf16_f32 v205, v190, v191
v_mfma_f32_16x16x32_bf16 a[120:123], a[252:255], v[132:135], a[120:123]
v_cvt_pk_bf16_f32 v206, v192, v193
v_cvt_pk_bf16_f32 v207, v194, v195
v_mfma_f32_16x16x32_bf16 a[120:123], a[220:223], v[128:131], a[120:123]
buffer_store_dwordx4 v[204:207], v30, s[20:23], 0 offen offset:1024 sc1
v_accvgpr_read_b32 v196, a36
v_accvgpr_read_b32 v197, a37
v_accvgpr_read_b32 v198, a38
v_accvgpr_read_b32 v199, a39
v_accvgpr_read_b32 v200, a52
v_accvgpr_read_b32 v201, a53
v_accvgpr_read_b32 v202, a54
v_accvgpr_read_b32 v203, a55
v_mul_f32 v196, v162, v196
v_mul_f32 v197, v162, v197
v_mul_f32 v198, v162, v198
v_mul_f32 v199, v162, v199
v_mul_f32 v200, v162, v200
v_mul_f32 v201, v162, v201
v_mul_f32 v202, v162, v202
v_mul_f32 v203, v162, v203
v_cvt_pk_bf16_f32 v244, v196, v197
v_cvt_pk_bf16_f32 v245, v198, v199
v_cvt_pk_bf16_f32 v246, v200, v201
v_cvt_pk_bf16_f32 v247, v202, v203
v_accvgpr_read_b32 v188, a68
v_accvgpr_read_b32 v189, a69
v_accvgpr_read_b32 v190, a70
v_accvgpr_read_b32 v191, a71
v_accvgpr_read_b32 v192, a84
v_accvgpr_read_b32 v193, a85
v_accvgpr_read_b32 v194, a86
v_accvgpr_read_b32 v195, a87
v_mul_f32 v188, v162, v188
v_mul_f32 v189, v162, v189
v_mul_f32 v190, v162, v190
v_mul_f32 v191, v162, v191
v_mul_f32 v192, v162, v192
v_mul_f32 v193, v162, v193
v_mul_f32 v194, v162, v194
v_mul_f32 v195, v162, v195
v_cvt_pk_bf16_f32 v204, v188, v189
v_cvt_pk_bf16_f32 v205, v190, v191
v_cvt_pk_bf16_f32 v206, v192, v193
v_cvt_pk_bf16_f32 v207, v194, v195
v_accvgpr_read_b32 v196, a100
v_accvgpr_read_b32 v197, a101
v_accvgpr_read_b32 v198, a102
v_accvgpr_read_b32 v199, a103
v_accvgpr_read_b32 v200, a116
v_accvgpr_read_b32 v201, a117
v_accvgpr_read_b32 v202, a118
v_accvgpr_read_b32 v203, a119
v_mul_f32 v196, v162, v196
v_mul_f32 v197, v162, v197
v_mul_f32 v198, v162, v198
v_mul_f32 v199, v162, v199
v_mul_f32 v200, v162, v200
v_mul_f32 v201, v162, v201
v_mul_f32 v202, v162, v202
v_mul_f32 v203, v162, v203
v_add_f32 v165, v165, v164
v_mov_b32 v242, v165
v_exp_f32 v112, v112
v_exp_f32 v113, v113
v_permlane16_swap_b32 v165, v242
v_add_f32 v165, v165, v242
v_mov_b32 v242, v165
v_add_f32 v166, v166, v112
v_exp_f32 v114, v114
v_permlane32_swap_b32 v165, v242
v_add_f32 v165, v165, v242
v_rcp_f32 v164, v165
v_add_f32 v167, v167, v113
v_cvt_pk_bf16_f32 v136, v112, v113
v_exp_f32 v115, v115
v_add_f32 v166, v166, v114
v_exp_f32 v116, v116
v_add_f32 v167, v167, v115
v_cvt_pk_bf16_f32 v137, v114, v115
v_exp_f32 v117, v117
v_add_f32 v166, v166, v116
v_exp_f32 v118, v118
v_add_f32 v167, v167, v117
v_cvt_pk_bf16_f32 v138, v116, v117
v_exp_f32 v119, v119
v_add_f32 v166, v166, v118
v_exp_f32 v120, v120
v_add_f32 v167, v167, v119
v_cvt_pk_bf16_f32 v139, v118, v119
v_exp_f32 v121, v121
v_add_f32 v166, v166, v120
v_mfma_f32_16x16x32_bf16 a[12:15], a[192:195], v[136:139], a[12:15]
buffer_store_dwordx4 v[244:247], v30, s[20:23], s72 offen offset:1024 sc1
v_mfma_f32_16x16x32_bf16 a[44:47], a[200:203], v[136:139], a[44:47]
buffer_store_dwordx4 v[204:207], v30, s[20:23], s73 offen offset:1024 sc1
v_mfma_f32_16x16x32_bf16 a[76:79], a[208:211], v[136:139], a[76:79]
v_cvt_pk_bf16_f32 v244, v196, v197
v_cvt_pk_bf16_f32 v245, v198, v199
v_mfma_f32_16x16x32_bf16 a[108:111], a[216:219], v[136:139], a[108:111]
v_cvt_pk_bf16_f32 v246, v200, v201
v_cvt_pk_bf16_f32 v247, v202, v203
v_exp_f32 v122, v122
v_add_f32 v167, v167, v121
v_cvt_pk_bf16_f32 v140, v120, v121
v_exp_f32 v123, v123
v_add_f32 v166, v166, v122
v_exp_f32 v124, v124
v_add_f32 v167, v167, v123
v_cvt_pk_bf16_f32 v141, v122, v123
v_exp_f32 v125, v125
v_add_f32 v166, v166, v124
v_exp_f32 v126, v126
v_add_f32 v167, v167, v125
v_cvt_pk_bf16_f32 v142, v124, v125
v_exp_f32 v127, v127
v_add_f32 v166, v166, v126
v_cvt_pk_bf16_f32 v143, v126, v127
v_add_f32 v167, v167, v127
v_accvgpr_read_b32 v188, a8
v_mfma_f32_16x16x32_bf16 a[12:15], a[224:227], v[140:143], a[12:15]
buffer_store_dwordx4 v[244:247], v30, s[20:23], s3 offen offset:1024 sc1
v_mfma_f32_16x16x32_bf16 a[28:31], a[228:231], v[140:143], a[28:31]
v_accvgpr_read_b32 v189, a9
v_accvgpr_read_b32 v190, a10
v_mfma_f32_16x16x32_bf16 a[28:31], a[196:199], v[136:139], a[28:31]
v_accvgpr_read_b32 v191, a11
v_accvgpr_read_b32 v192, a24
v_mfma_f32_16x16x32_bf16 a[44:47], a[232:235], v[140:143], a[44:47]
v_accvgpr_read_b32 v193, a25
v_accvgpr_read_b32 v194, a26
v_mfma_f32_16x16x32_bf16 a[60:63], a[236:239], v[140:143], a[60:63]
v_accvgpr_read_b32 v195, a27
v_mul_f32 v188, v164, v188
v_mfma_f32_16x16x32_bf16 a[60:63], a[204:207], v[136:139], a[60:63]
v_mul_f32 v189, v164, v189
v_mul_f32 v190, v164, v190
v_mfma_f32_16x16x32_bf16 a[76:79], a[240:243], v[140:143], a[76:79]
v_mul_f32 v191, v164, v191
v_mul_f32 v192, v164, v192
v_mfma_f32_16x16x32_bf16 a[92:95], a[244:247], v[140:143], a[92:95]
v_mul_f32 v193, v164, v193
v_mul_f32 v194, v164, v194
v_mfma_f32_16x16x32_bf16 a[92:95], a[212:215], v[136:139], a[92:95]
v_mul_f32 v195, v164, v195
v_cvt_pk_bf16_f32 v204, v188, v189
v_mfma_f32_16x16x32_bf16 a[108:111], a[248:251], v[140:143], a[108:111]
v_cvt_pk_bf16_f32 v205, v190, v191
v_cvt_pk_bf16_f32 v206, v192, v193
v_mfma_f32_16x16x32_bf16 a[124:127], a[252:255], v[140:143], a[124:127]
v_cvt_pk_bf16_f32 v207, v194, v195
v_accvgpr_read_b32 v196, a40
v_mfma_f32_16x16x32_bf16 a[124:127], a[220:223], v[136:139], a[124:127]
buffer_store_dwordx4 v[204:207], v30, s[20:23], 0 offen offset:2048 sc1
v_accvgpr_read_b32 v197, a41
v_accvgpr_read_b32 v198, a42
v_accvgpr_read_b32 v199, a43
v_accvgpr_read_b32 v200, a56
v_accvgpr_read_b32 v201, a57
v_accvgpr_read_b32 v202, a58
v_accvgpr_read_b32 v203, a59
v_mul_f32 v196, v164, v196
v_mul_f32 v197, v164, v197
v_mul_f32 v198, v164, v198
v_mul_f32 v199, v164, v199
v_mul_f32 v200, v164, v200
v_mul_f32 v201, v164, v201
v_mul_f32 v202, v164, v202
v_mul_f32 v203, v164, v203
v_cvt_pk_bf16_f32 v244, v196, v197
v_cvt_pk_bf16_f32 v245, v198, v199
v_cvt_pk_bf16_f32 v246, v200, v201
v_cvt_pk_bf16_f32 v247, v202, v203
buffer_store_dwordx4 v[244:247], v30, s[20:23], s72 offen offset:2048 sc1
v_accvgpr_read_b32 v188, a72
v_accvgpr_read_b32 v189, a73
v_accvgpr_read_b32 v190, a74
v_accvgpr_read_b32 v191, a75
v_accvgpr_read_b32 v192, a88
v_accvgpr_read_b32 v193, a89
v_accvgpr_read_b32 v194, a90
v_accvgpr_read_b32 v195, a91
v_mul_f32 v188, v164, v188
v_mul_f32 v189, v164, v189
v_mul_f32 v190, v164, v190
v_mul_f32 v191, v164, v191
v_mul_f32 v192, v164, v192
v_mul_f32 v193, v164, v193
v_mul_f32 v194, v164, v194
v_mul_f32 v195, v164, v195
v_cvt_pk_bf16_f32 v204, v188, v189
v_cvt_pk_bf16_f32 v205, v190, v191
v_cvt_pk_bf16_f32 v206, v192, v193
v_cvt_pk_bf16_f32 v207, v194, v195
buffer_store_dwordx4 v[204:207], v30, s[20:23], s73 offen offset:2048 sc1
v_accvgpr_read_b32 v196, a104
v_accvgpr_read_b32 v197, a105
v_accvgpr_read_b32 v198, a106
v_accvgpr_read_b32 v199, a107
v_accvgpr_read_b32 v200, a120
v_accvgpr_read_b32 v201, a121
v_accvgpr_read_b32 v202, a122
v_accvgpr_read_b32 v203, a123
v_mul_f32 v196, v164, v196
v_mul_f32 v197, v164, v197
v_mul_f32 v198, v164, v198
v_mul_f32 v199, v164, v199
v_mul_f32 v200, v164, v200
v_mul_f32 v201, v164, v201
v_mul_f32 v202, v164, v202
v_mul_f32 v203, v164, v203
v_cvt_pk_bf16_f32 v244, v196, v197
v_cvt_pk_bf16_f32 v245, v198, v199
v_cvt_pk_bf16_f32 v246, v200, v201
v_cvt_pk_bf16_f32 v247, v202, v203
buffer_store_dwordx4 v[244:247], v30, s[20:23], s3 offen offset:2048 sc1
v_add_f32 v167, v167, v166
v_mov_b32 v243, v167
v_add_f32 v241, v216, v220
v_mov_b32 v242, 155136
v_permlane16_swap_b32 v167, v243
v_add_f32 v167, v167, v243
v_mov_b32 v243, v167
v_accvgpr_read_b32 v188, a12
v_accvgpr_read_b32 v189, a13
v_permlane32_swap_b32 v167, v243
v_add_f32 v167, v167, v243
v_rcp_f32 v166, v167
v_add_f32 v240, v165, v167
v_add_f32 v241, v241, v240
v_mov_b32 v243, 1
v_cmp_nle_f32 vcc, v241, v248
v_accvgpr_read_b32 v190, a14
s_and_saveexec_b64 s[34:35], vcc
ds_write_b32 v242, v243
s_mov_b64 exec, s[34:35]
s_waitcnt lgkmcnt(0)
s_barrier
ds_read_b32 v243, v242
v_accvgpr_read_b32 v191, a15
v_accvgpr_read_b32 v192, a28
v_accvgpr_read_b32 v193, a29
v_accvgpr_read_b32 v194, a30
v_accvgpr_read_b32 v195, a31
v_mul_f32 v188, v166, v188
v_mul_f32 v189, v166, v189
v_mul_f32 v190, v166, v190
v_mul_f32 v191, v166, v191
v_mul_f32 v192, v166, v192
v_mul_f32 v193, v166, v193
v_mul_f32 v194, v166, v194
v_mul_f32 v195, v166, v195
v_cvt_pk_bf16_f32 v204, v188, v189
v_cvt_pk_bf16_f32 v205, v190, v191
v_cvt_pk_bf16_f32 v206, v192, v193
v_cvt_pk_bf16_f32 v207, v194, v195
buffer_store_dwordx4 v[204:207], v30, s[20:23], 0 offen offset:3072 sc1
v_accvgpr_read_b32 v196, a44
v_accvgpr_read_b32 v197, a45
v_accvgpr_read_b32 v198, a46
v_accvgpr_read_b32 v199, a47
v_accvgpr_read_b32 v200, a60
v_accvgpr_read_b32 v201, a61
v_accvgpr_read_b32 v202, a62
v_accvgpr_read_b32 v203, a63
v_mul_f32 v196, v166, v196
v_mul_f32 v197, v166, v197
v_mul_f32 v198, v166, v198
v_mul_f32 v199, v166, v199
v_mul_f32 v200, v166, v200
v_mul_f32 v201, v166, v201
v_mul_f32 v202, v166, v202
v_mul_f32 v203, v166, v203
v_cvt_pk_bf16_f32 v244, v196, v197
v_cvt_pk_bf16_f32 v245, v198, v199
v_cvt_pk_bf16_f32 v246, v200, v201
v_cvt_pk_bf16_f32 v247, v202, v203
buffer_store_dwordx4 v[244:247], v30, s[20:23], s72 offen offset:3072 sc1
v_accvgpr_read_b32 v188, a76
v_accvgpr_read_b32 v189, a77
v_accvgpr_read_b32 v190, a78
v_accvgpr_read_b32 v191, a79
v_accvgpr_read_b32 v192, a92
v_accvgpr_read_b32 v193, a93
v_accvgpr_read_b32 v194, a94
v_accvgpr_read_b32 v195, a95
v_mul_f32 v188, v166, v188
v_mul_f32 v189, v166, v189
v_mul_f32 v190, v166, v190
v_mul_f32 v191, v166, v191
v_mul_f32 v192, v166, v192
v_mul_f32 v193, v166, v193
v_mul_f32 v194, v166, v194
v_mul_f32 v195, v166, v195
v_cvt_pk_bf16_f32 v204, v188, v189
v_cvt_pk_bf16_f32 v205, v190, v191
v_cvt_pk_bf16_f32 v206, v192, v193
v_cvt_pk_bf16_f32 v207, v194, v195
buffer_store_dwordx4 v[204:207], v30, s[20:23], s73 offen offset:3072 sc1
v_accvgpr_read_b32 v196, a108
v_accvgpr_read_b32 v197, a109
v_accvgpr_read_b32 v198, a110
v_accvgpr_read_b32 v199, a111
v_accvgpr_read_b32 v200, a124
v_accvgpr_read_b32 v201, a125
v_accvgpr_read_b32 v202, a126
v_accvgpr_read_b32 v203, a127
v_mul_f32 v196, v166, v196
v_mul_f32 v197, v166, v197
v_mul_f32 v198, v166, v198
v_mul_f32 v199, v166, v199
v_mul_f32 v200, v166, v200
v_mul_f32 v201, v166, v201
v_mul_f32 v202, v166, v202
v_mul_f32 v203, v166, v203
v_cvt_pk_bf16_f32 v244, v196, v197
v_cvt_pk_bf16_f32 v245, v198, v199
v_cvt_pk_bf16_f32 v246, v200, v201
v_cvt_pk_bf16_f32 v247, v202, v203
buffer_store_dwordx4 v[244:247], v30, s[20:23], s3 offen offset:3072 sc1
s_waitcnt lgkmcnt(0)
v_readfirstlane_b32 s72, v243
v_mov_b32 v248, 1
v_mov_b32 v249, s74
s_andn2_b32 s72, s72, s63
s_cmp_lg_u32 s72, 0
s_cbranch_scc1 REDO
s_mov_b32 s31, 12288
buffer_load_dwordx4 a[176:179], v30, s[12:15], s31 offen offset:0 sc1
v_lshrrev_b32 v240, 4, v0
v_bfe_u32 v241, v0, 2, 2
v_lshl_add_u32 v240, v240, 3, v241
v_and_b32 v241, 3, v0
v_lshlrev_b32 v241, 3, v241
v_lshl_add_u32 v240, v240, 5, v241
buffer_load_dwordx4 a[180:183], v30, s[12:15], s31 offen offset:1024 sc1
v_add_u32 v240, s75, v240
ds_read_b64_tr_b16 v[188:189], v240 offset:0
ds_read_b64_tr_b16 v[190:191], v240 offset:128
ds_read_b64_tr_b16 v[192:193], v240 offset:1024
ds_read_b64_tr_b16 v[194:195], v240 offset:1152
ds_read_b64_tr_b16 v[196:197], v240 offset:2048
buffer_load_dwordx4 a[184:187], v30, s[12:15], s31 offen offset:2048 sc1
ds_read_b64_tr_b16 v[198:199], v240 offset:2176
ds_read_b64_tr_b16 v[200:201], v240 offset:3072
ds_read_b64_tr_b16 v[202:203], v240 offset:3200
ds_read_b64_tr_b16 v[204:205], v240 offset:4096
ds_read_b64_tr_b16 v[206:207], v240 offset:4224
v_and_b32 v243, 15, v0
buffer_load_dwordx4 a[188:191], v30, s[12:15], s31 offen offset:3072 sc1
v_lshlrev_b32 v241, 4, v243
s_lshl_b32 s72, s28, 2
s_add_u32 s72, s72, 138752
v_add_u32 v241, s72, v241
s_mul_i32 s72, s28, 320
s_add_u32 s72, s72, 131072
s_mov_b32 s31, 16384
buffer_load_dwordx4 a[192:195], v30, s[12:15], s31 offen offset:0 sc1
s_movk_i32 s73, 1280
s_waitcnt lgkmcnt(0)
v_mfma_f32_16x16x32_bf16 v[208:211], v[168:171], v[188:191], 0
v_mfma_f32_16x16x32_bf16 v[208:211], v[172:175], v[192:195], v[208:211]
v_mfma_f32_16x16x32_bf16 v[208:211], v[176:179], v[196:199], v[208:211]
v_mfma_f32_16x16x32_bf16 v[208:211], v[180:183], v[200:203], v[208:211]
buffer_load_dwordx4 a[196:199], v30, s[12:15], s31 offen offset:1024 sc1
v_mfma_f32_16x16x32_bf16 v[208:211], v[184:187], v[204:207], v[208:211]
v_bfe_u32 v240, v0, 3, 2
v_lshlrev_b32 v240, 13, v240
v_bfe_u32 v242, v0, 2, 1
v_mad_u32_u24 v240, v242, s73, v240
v_and_b32 v242, 3, v0
buffer_load_dwordx4 a[200:203], v30, s[12:15], s31 offen offset:2048 sc1
v_lshl_add_u32 v240, v242, 3, v240
v_add_u32 v240, s72, v240
s_nop 0
ds_write_b32 v241, v208
ds_read_b64_tr_b16 v[188:189], v240 offset:5120
ds_read_b64_tr_b16 v[190:191], v240 offset:5152
s_waitcnt vmcnt(56)
buffer_load_dwordx4 a[204:207], v30, s[12:15], s31 offen offset:3072 sc1
ds_read_b64_tr_b16 v[192:193], v240 offset:5184
ds_read_b64_tr_b16 v[194:195], v240 offset:5216
ds_read_b64_tr_b16 v[196:197], v240 offset:5248
ds_read_b64_tr_b16 v[198:199], v240 offset:5280
ds_read_b64_tr_b16 v[200:201], v240 offset:5312
ds_read_b64_tr_b16 v[202:203], v240 offset:5344
ds_read_b64_tr_b16 v[204:205], v240 offset:5376
ds_read_b64_tr_b16 v[206:207], v240 offset:5408
s_waitcnt lgkmcnt(0)
s_waitcnt vmcnt(8)
s_mov_b64 exec, 1
buffer_store_dword v248, v249, s[24:27], 0 offen sc1
s_mov_b64 exec, -1
s_mov_b32 s31, 20480
buffer_load_dwordx4 a[208:211], v30, s[12:15], s31 offen offset:0 sc1
buffer_load_dwordx4 a[212:215], v30, s[12:15], s31 offen offset:1024 sc1
buffer_load_dwordx4 a[216:219], v30, s[12:15], s31 offen offset:2048 sc1
buffer_load_dwordx4 a[220:223], v30, s[12:15], s31 offen offset:3072 sc1
s_barrier
s_mov_b32 s31, 24576
buffer_load_dwordx4 a[224:227], v30, s[12:15], s31 offen offset:0 sc1
v_and_b32 v240, 7, v0
v_lshlrev_b32 v241, 4, v240
v_add_u32 v241, 138752, v241
ds_read_b128 v[208:211], v241
ds_read_b128 v[212:215], v241 offset:128
s_lshl_b32 s72, s28, 5
s_add_u32 s72, s72, 146944
v_lshl_add_u32 v241, v240, 1, s72
v_bfe_u32 v240, v0, 4, 1
v_lshl_add_u32 v240, v240, 3, s72
buffer_load_dwordx4 a[228:231], v30, s[12:15], s31 offen offset:1024 sc1
s_waitcnt lgkmcnt(0)
v_add_f32 v208, v208, v209
v_add_f32 v210, v210, v211
v_add_f32 v208, v208, v210
v_add_f32 v212, v212, v213
v_add_f32 v214, v214, v215
v_add_f32 v212, v212, v214
v_cvt_pk_bf16_f32 v208, v208, v212
v_and_b32 v212, 0xffff0000, v208
v_lshlrev_b32 v208, 16, v208
buffer_load_dwordx4 a[232:235], v30, s[12:15], s31 offen offset:2048 sc1
v_mul_f32 v209, 3216550459, v208
v_exp_f32 v209, v209
s_nop 0
v_add_f32 v209, 1.0, v209
v_rcp_f32 v209, v209
s_nop 0
v_mul_f32 v208, v208, v209
v_cvt_pk_bf16_f32 v208, v208, v208
v_lshlrev_b32 v208, 16, v208
v_mul_f32 v208, v208, v212
buffer_load_dwordx4 a[236:239], v30, s[12:15], s31 offen offset:3072 sc1
v_cvt_pk_bf16_f32 v208, v208, v208
ds_write_b16 v241, v208
s_waitcnt lgkmcnt(0)
ds_read_b64 v[208:209], v240
v_cmp_gt_u32 vcc, 32, v0
s_lshr_b32 s73, s2, 3
s_cmp_lt_u32 s73, 27
s_mov_b32 s73, 4194304
s_cselect_b32 s73, 3276800, s73
s_mul_i32 s72, s28, 640
s_add_u32 s72, s72, s73
s_and_b32 s73, s2, 15
s_mov_b32 s31, 28672
buffer_load_dwordx4 a[240:243], v30, s[12:15], s31 offen offset:0 sc1
s_mul_i32 s73, s73, 2560
s_add_u32 s72, s72, s73
v_lshl_add_u32 v243, v243, 2, s72
s_waitcnt lgkmcnt(0)
v_cndmask_b32 v208, 0, v208, vcc
v_cndmask_b32 v209, 0, v209, vcc
s_nop 1
v_mfma_f32_16x16x16_bf16 v[168:171], v[208:209], v[188:189], 0
v_mfma_f32_16x16x16_bf16 v[172:175], v[208:209], v[190:191], 0
v_mfma_f32_16x16x16_bf16 v[176:179], v[208:209], v[192:193], 0
buffer_load_dwordx4 a[244:247], v30, s[12:15], s31 offen offset:1024 sc1
v_mfma_f32_16x16x16_bf16 v[180:183], v[208:209], v[194:195], 0
v_mfma_f32_16x16x16_bf16 v[184:187], v[208:209], v[196:197], 0
v_mfma_f32_16x16x16_bf16 v[212:215], v[208:209], v[198:199], 0
v_mfma_f32_16x16x16_bf16 v[216:219], v[208:209], v[200:201], 0
v_mfma_f32_16x16x16_bf16 v[220:223], v[208:209], v[202:203], 0
v_mfma_f32_16x16x16_bf16 v[224:227], v[208:209], v[204:205], 0
v_mfma_f32_16x16x16_bf16 v[228:231], v[208:209], v[206:207], 0
s_mov_b64 exec, 0xffff
buffer_atomic_add_f32 v168, v243, s[24:27], 0 offen offset:0
buffer_atomic_add_f32 v172, v243, s[24:27], 0 offen offset:64
buffer_atomic_add_f32 v176, v243, s[24:27], 0 offen offset:128
buffer_atomic_add_f32 v180, v243, s[24:27], 0 offen offset:192
buffer_atomic_add_f32 v184, v243, s[24:27], 0 offen offset:256
buffer_atomic_add_f32 v212, v243, s[24:27], 0 offen offset:320
buffer_atomic_add_f32 v216, v243, s[24:27], 0 offen offset:384
buffer_atomic_add_f32 v220, v243, s[24:27], 0 offen offset:448
s_nop 1
buffer_atomic_add_f32 v224, v243, s[24:27], 0 offen offset:512
s_nop 1
buffer_atomic_add_f32 v228, v243, s[24:27], 0 offen offset:576
s_mov_b64 exec, -1
buffer_load_dwordx4 a[248:251], v30, s[12:15], s31 offen offset:2048 sc1
buffer_load_dwordx4 a[252:255], v30, s[12:15], s31 offen offset:3072 sc1
s_lshr_b32 s72, s2, 7
s_lshl_b32 s72, s72, 2
s_add_u32 s72, s72, s28
s_lshl_b32 s72, s72, 21
s_lshl_b32 s73, s78, 13
s_add_u32 s72, s72, s73
s_add_u32 s72, s72, 4194304
s_add_u32 s20, s60, s72
s_addc_u32 s21, s61, 0
s_mov_b32 s22, 1974272
s_mov_b32 s23, 0x20000
s_add_u32 s4, s56, 0
s_addc_u32 s5, s57, 0
s_mov_b32 s6, 2621440
s_mov_b32 s7, 0x20000
s_add_u32 s68, s60, 26214400
s_addc_u32 s69, s61, 0
s_mov_b32 s70, 5242880
s_mov_b32 s71, 0x20000
s_lshr_b32 s76, s2, 7
s_lshl_b32 s72, s78, 3
s_lshl_b32 s73, s76, 2
s_add_u32 s72, s72, s73
s_add_u32 s72, s72, s28
s_lshl_b32 s72, s72, 7
s_add_u32 s72, s72, 3317760
v_and_b32 v14, 7, v0
v_lshl_add_u32 v14, v14, 2, s72
s_add_u32 s72, s28, 0
s_and_b32 s72, s72, 3
s_xor_b32 s73, s76, 1
s_lshl1_add_u32 s72, s72, s73
s_lshl_b32 s72, s72, 10
v_add_u32 v3, s72, v30
s_add_u32 s72, s28, 1
s_and_b32 s72, s72, 3
s_xor_b32 s73, s76, 1
s_lshl1_add_u32 s72, s72, s73
s_lshl_b32 s72, s72, 10
v_add_u32 v4, s72, v30
s_add_u32 s72, s28, 2
s_and_b32 s72, s72, 3
s_xor_b32 s73, s76, 1
s_lshl1_add_u32 s72, s72, s73
s_lshl_b32 s72, s72, 10
v_add_u32 v5, s72, v30
s_add_u32 s72, s28, 3
s_and_b32 s72, s72, 3
s_xor_b32 s73, s76, 1
s_lshl1_add_u32 s72, s72, s73
s_lshl_b32 s72, s72, 10
v_add_u32 v6, s72, v30
s_add_u32 s72, s28, 0
s_and_b32 s72, s72, 3
s_xor_b32 s73, s76, 0
s_lshl1_add_u32 s72, s72, s73
s_lshl_b32 s72, s72, 10
v_add_u32 v7, s72, v30
s_add_u32 s72, s28, 1
s_and_b32 s72, s72, 3
s_xor_b32 s73, s76, 0
s_lshl1_add_u32 s72, s72, s73
s_lshl_b32 s72, s72, 10
v_add_u32 v8, s72, v30
s_add_u32 s72, s28, 2
s_and_b32 s72, s72, 3
s_xor_b32 s73, s76, 0
s_lshl1_add_u32 s72, s72, s73
s_lshl_b32 s72, s72, 10
v_add_u32 v9, s72, v30
s_add_u32 s72, s28, 3
s_and_b32 s72, s72, 3
s_xor_b32 s73, s76, 0
s_lshl1_add_u32 s72, s72, s73
s_lshl_b32 s72, s72, 10
v_add_u32 v10, s72, v30
v_add_u32 v2, 65536, v2
v_and_b32 v240, 15, v0
v_lshrrev_b32 v241, 4, v0
s_lshl_b32 s74, s78, 7
s_lshl_b32 s72, s30, 4
s_add_u32 s74, s74, s72
v_add_u32 v11, s74, v240
s_mul_i32 s72, s79, 320
s_add_u32 s72, s72, 3276800
v_mul_u32_u24 v242, 2560, v240
v_add_u32 v242, s72, v242
v_lshl_add_u32 v13, v241, 5, v242
v_lshl_add_u32 v15, v241, 4, v242
v_add_u32 v12, s33, v30
v_add_u32 v17, 98304, v12
v_add_u32 v21, s75, v30
s_sub_u32 s75, s46, s74
v_mov_b32 v246, 36
s_mov_b32 s100, 3216550459
s_mov_b32 s101, 0xffff0000
s_lshr_b32 s72, s2, 1
s_lshl_b32 s72, s72, 5
s_and_b32 s73, s2, 1
s_lshl2_add_u32 s72, s73, s72
s_add_u32 s72, s72, s28
s_lshl_b32 s72, s72, 2
s_add_u32 s48, s72, 3338240
s_xor_b32 s72, s72, 8192
s_add_u32 s72, s72, 3338240
v_mov_b32 v247, s72
s_lshl_b32 s76, s2, 2
s_add_u32 s76, s76, s28
s_xor_b32 s77, s76, 512
s_mul_i32 s76, s76, 5120
s_mul_i32 s77, s77, 5120
buffer_load_dword v238, v14, s[24:27], 0 offen sc1
s_mov_b32 s31, 32768
buffer_load_dwordx4 a[0:3], v30, s[12:15], s31 offen offset:0 sc1
buffer_load_dwordx4 a[4:7], v30, s[12:15], s31 offen offset:1024 sc1
buffer_load_dwordx4 a[8:11], v30, s[12:15], s31 offen offset:2048 sc1
buffer_load_dwordx4 a[12:15], v30, s[12:15], s31 offen offset:3072 sc1
s_mov_b32 s31, 61440
buffer_load_dwordx4 a[16:19], v30, s[12:15], s31 offen offset:0 sc1
buffer_load_dwordx4 a[20:23], v30, s[12:15], s31 offen offset:1024 sc1
buffer_load_dwordx4 a[24:27], v30, s[12:15], s31 offen offset:2048 sc1
buffer_load_dwordx4 a[28:31], v30, s[12:15], s31 offen offset:3072 sc1
s_mov_b32 s31, 65536
buffer_load_dwordx4 a[32:35], v30, s[12:15], s31 offen offset:0 sc1
buffer_load_dwordx4 a[36:39], v30, s[12:15], s31 offen offset:1024 sc1
buffer_load_dwordx4 a[40:43], v30, s[12:15], s31 offen offset:2048 sc1
buffer_load_dwordx4 a[44:47], v30, s[12:15], s31 offen offset:3072 sc1
s_waitcnt vmcnt(12)
s_barrier
s_cmp_lg_u32 s28, 0
s_cbranch_scc1 OCSIG
s_mov_b32 s72, 1
s_atomic_add s72, s[58:59], 36
OCSIG:
s_mov_b32 s32, 0x100000
OFLAG:
v_cmp_gt_u32 vcc, 1, v238
s_sub_u32 s32, s32, 1
s_cbranch_scc1 OFLAG_OK
s_cbranch_vccz OFLAG_OK
s_sleep 1
buffer_load_dword v238, v14, s[24:27], 0 offen sc1
s_waitcnt vmcnt(0)
s_branch OFLAG
OFLAG_OK:
s_mov_b32 s34, 0
buffer_load_dwordx4 v[112:115], v3, s[20:23], s34 offen sc1
buffer_load_dwordx4 v[116:119], v4, s[20:23], s34 offen sc1
buffer_load_dwordx4 v[120:123], v5, s[20:23], s34 offen sc1
buffer_load_dwordx4 v[124:127], v6, s[20:23], s34 offen sc1
s_mov_b32 s34, 131072
buffer_load_dwordx4 v[128:131], v3, s[20:23], s34 offen sc1
buffer_load_dwordx4 v[132:135], v4, s[20:23], s34 offen sc1
buffer_load_dwordx4 v[136:139], v5, s[20:23], s34 offen sc1
buffer_load_dwordx4 v[140:143], v6, s[20:23], s34 offen sc1
s_mov_b32 s34, 262144
buffer_load_dwordx4 v[144:147], v3, s[20:23], s34 offen sc1
buffer_load_dwordx4 v[148:151], v4, s[20:23], s34 offen sc1
buffer_load_dwordx4 v[152:155], v5, s[20:23], s34 offen sc1
buffer_load_dwordx4 v[156:159], v6, s[20:23], s34 offen sc1
s_mov_b32 s34, 393216
buffer_load_dwordx4 v[160:163], v3, s[20:23], s34 offen sc1
buffer_load_dwordx4 v[164:167], v4, s[20:23], s34 offen sc1
buffer_load_dwordx4 v[168:171], v5, s[20:23], s34 offen sc1
buffer_load_dwordx4 v[172:175], v6, s[20:23], s34 offen sc1
s_waitcnt vmcnt(15)
v_mfma_f32_16x16x32_bf16 a[96:99], a[128:131], v[112:115], 0
v_mfma_f32_16x16x32_bf16 a[100:103], a[132:135], v[112:115], 0
s_mov_b32 s31, 69632
v_mfma_f32_16x16x32_bf16 a[104:107], a[136:139], v[112:115], 0
s_mov_b32 s34, 524288
buffer_load_dwordx4 a[48:51], v30, s[12:15], s31 offen offset:0 sc1
v_mfma_f32_16x16x32_bf16 a[108:111], a[140:143], v[112:115], 0
v_mfma_f32_16x16x32_bf16 a[112:115], a[144:147], v[112:115], 0
s_waitcnt vmcnt(15)
buffer_load_dwordx4 v[112:115], v3, s[20:23], s34 offen sc1
v_mfma_f32_16x16x32_bf16 v[52:55], a[128:131], v[116:119], 0
v_mfma_f32_16x16x32_bf16 v[56:59], a[132:135], v[116:119], 0
v_mfma_f32_16x16x32_bf16 v[60:63], a[136:139], v[116:119], 0
s_mov_b32 s34, 524288
v_mfma_f32_16x16x32_bf16 v[64:67], a[140:143], v[116:119], 0
v_mfma_f32_16x16x32_bf16 v[68:71], a[144:147], v[116:119], 0
s_waitcnt vmcnt(15)
buffer_load_dwordx4 v[116:119], v4, s[20:23], s34 offen sc1
v_mfma_f32_16x16x32_bf16 v[72:75], a[128:131], v[120:123], 0
buffer_load_dwordx4 a[52:55], v30, s[12:15], s31 offen offset:1024 sc1
v_mfma_f32_16x16x32_bf16 v[76:79], a[132:135], v[120:123], 0
v_mfma_f32_16x16x32_bf16 v[80:83], a[136:139], v[120:123], 0
s_mov_b32 s34, 524288
v_mfma_f32_16x16x32_bf16 v[84:87], a[140:143], v[120:123], 0
v_mfma_f32_16x16x32_bf16 v[88:91], a[144:147], v[120:123], 0
s_waitcnt vmcnt(16)
buffer_load_dwordx4 v[120:123], v5, s[20:23], s34 offen sc1
v_mfma_f32_16x16x32_bf16 v[92:95], a[128:131], v[124:127], 0
v_mfma_f32_16x16x32_bf16 v[96:99], a[132:135], v[124:127], 0
v_mfma_f32_16x16x32_bf16 v[100:103], a[136:139], v[124:127], 0
s_mov_b32 s34, 524288
buffer_load_dwordx4 a[56:59], v30, s[12:15], s31 offen offset:2048 sc1
v_mfma_f32_16x16x32_bf16 v[104:107], a[140:143], v[124:127], 0
v_mfma_f32_16x16x32_bf16 v[108:111], a[144:147], v[124:127], 0
s_waitcnt vmcnt(17)
buffer_load_dwordx4 v[124:127], v6, s[20:23], s34 offen sc1
v_mfma_f32_16x16x32_bf16 a[96:99], a[148:151], v[128:131], a[96:99]
v_mfma_f32_16x16x32_bf16 a[100:103], a[152:155], v[128:131], a[100:103]
v_mfma_f32_16x16x32_bf16 a[104:107], a[156:159], v[128:131], a[104:107]
s_mov_b32 s34, 655360
v_mfma_f32_16x16x32_bf16 a[108:111], a[160:163], v[128:131], a[108:111]
v_mfma_f32_16x16x32_bf16 a[112:115], a[164:167], v[128:131], a[112:115]
s_waitcnt vmcnt(17)
buffer_load_dwordx4 v[128:131], v3, s[20:23], s34 offen sc1
v_mfma_f32_16x16x32_bf16 v[52:55], a[148:151], v[132:135], v[52:55]
buffer_load_dwordx4 a[60:63], v30, s[12:15], s31 offen offset:3072 sc1
v_mfma_f32_16x16x32_bf16 v[56:59], a[152:155], v[132:135], v[56:59]
v_mfma_f32_16x16x32_bf16 v[60:63], a[156:159], v[132:135], v[60:63]
s_mov_b32 s34, 655360
v_mfma_f32_16x16x32_bf16 v[64:67], a[160:163], v[132:135], v[64:67]
v_mfma_f32_16x16x32_bf16 v[68:71], a[164:167], v[132:135], v[68:71]
s_waitcnt vmcnt(18)
buffer_load_dwordx4 v[132:135], v4, s[20:23], s34 offen sc1
v_mfma_f32_16x16x32_bf16 v[72:75], a[148:151], v[136:139], v[72:75]
v_mfma_f32_16x16x32_bf16 v[76:79], a[152:155], v[136:139], v[76:79]
s_mov_b32 s31, 73728
v_mfma_f32_16x16x32_bf16 v[80:83], a[156:159], v[136:139], v[80:83]
s_mov_b32 s34, 655360
buffer_load_dwordx4 a[64:67], v30, s[12:15], s31 offen offset:0 sc1
v_mfma_f32_16x16x32_bf16 v[84:87], a[160:163], v[136:139], v[84:87]
v_mfma_f32_16x16x32_bf16 v[88:91], a[164:167], v[136:139], v[88:91]
s_waitcnt vmcnt(19)
buffer_load_dwordx4 v[136:139], v5, s[20:23], s34 offen sc1
v_mfma_f32_16x16x32_bf16 v[92:95], a[148:151], v[140:143], v[92:95]
v_mfma_f32_16x16x32_bf16 v[96:99], a[152:155], v[140:143], v[96:99]
v_mfma_f32_16x16x32_bf16 v[100:103], a[156:159], v[140:143], v[100:103]
s_mov_b32 s34, 655360
v_mfma_f32_16x16x32_bf16 v[104:107], a[160:163], v[140:143], v[104:107]
v_mfma_f32_16x16x32_bf16 v[108:111], a[164:167], v[140:143], v[108:111]
s_waitcnt vmcnt(19)
buffer_load_dwordx4 v[140:143], v6, s[20:23], s34 offen sc1
v_mfma_f32_16x16x32_bf16 a[96:99], a[168:171], v[144:147], a[96:99]
buffer_load_dwordx4 a[68:71], v30, s[12:15], s31 offen offset:1024 sc1
v_mfma_f32_16x16x32_bf16 a[100:103], a[172:175], v[144:147], a[100:103]
v_mfma_f32_16x16x32_bf16 a[104:107], a[176:179], v[144:147], a[104:107]
s_mov_b32 s34, 786432
v_mfma_f32_16x16x32_bf16 a[108:111], a[180:183], v[144:147], a[108:111]
v_mfma_f32_16x16x32_bf16 a[112:115], a[184:187], v[144:147], a[112:115]
s_waitcnt vmcnt(20)
buffer_load_dwordx4 v[144:147], v3, s[20:23], s34 offen sc1
v_mfma_f32_16x16x32_bf16 v[52:55], a[168:171], v[148:151], v[52:55]
v_mfma_f32_16x16x32_bf16 v[56:59], a[172:175], v[148:151], v[56:59]
v_mfma_f32_16x16x32_bf16 v[60:63], a[176:179], v[148:151], v[60:63]
s_mov_b32 s34, 786432
buffer_load_dwordx4 a[72:75], v30, s[12:15], s31 offen offset:2048 sc1
v_mfma_f32_16x16x32_bf16 v[64:67], a[180:183], v[148:151], v[64:67]
v_mfma_f32_16x16x32_bf16 v[68:71], a[184:187], v[148:151], v[68:71]
s_waitcnt vmcnt(21)
buffer_load_dwordx4 v[148:151], v4, s[20:23], s34 offen sc1
v_mfma_f32_16x16x32_bf16 v[72:75], a[168:171], v[152:155], v[72:75]
v_mfma_f32_16x16x32_bf16 v[76:79], a[172:175], v[152:155], v[76:79]
v_mfma_f32_16x16x32_bf16 v[80:83], a[176:179], v[152:155], v[80:83]
s_mov_b32 s34, 786432
v_mfma_f32_16x16x32_bf16 v[84:87], a[180:183], v[152:155], v[84:87]
v_mfma_f32_16x16x32_bf16 v[88:91], a[184:187], v[152:155], v[88:91]
s_waitcnt vmcnt(21)
buffer_load_dwordx4 v[152:155], v5, s[20:23], s34 offen sc1
v_mfma_f32_16x16x32_bf16 v[92:95], a[168:171], v[156:159], v[92:95]
buffer_load_dwordx4 a[76:79], v30, s[12:15], s31 offen offset:3072 sc1
v_mfma_f32_16x16x32_bf16 v[96:99], a[172:175], v[156:159], v[96:99]
v_mfma_f32_16x16x32_bf16 v[100:103], a[176:179], v[156:159], v[100:103]
s_mov_b32 s34, 786432
v_mfma_f32_16x16x32_bf16 v[104:107], a[180:183], v[156:159], v[104:107]
v_mfma_f32_16x16x32_bf16 v[108:111], a[184:187], v[156:159], v[108:111]
s_waitcnt vmcnt(22)
buffer_load_dwordx4 v[156:159], v6, s[20:23], s34 offen sc1
v_mfma_f32_16x16x32_bf16 a[96:99], a[188:191], v[160:163], a[96:99]
v_mfma_f32_16x16x32_bf16 a[100:103], a[192:195], v[160:163], a[100:103]
s_mov_b32 s31, 77824
v_mfma_f32_16x16x32_bf16 a[104:107], a[196:199], v[160:163], a[104:107]
s_mov_b32 s34, 917504
buffer_load_dwordx4 a[80:83], v30, s[12:15], s31 offen offset:0 sc1
v_mfma_f32_16x16x32_bf16 a[108:111], a[200:203], v[160:163], a[108:111]
v_mfma_f32_16x16x32_bf16 a[112:115], a[204:207], v[160:163], a[112:115]
s_waitcnt vmcnt(23)
buffer_load_dwordx4 v[160:163], v3, s[20:23], s34 offen sc1
v_mfma_f32_16x16x32_bf16 v[52:55], a[188:191], v[164:167], v[52:55]
v_mfma_f32_16x16x32_bf16 v[56:59], a[192:195], v[164:167], v[56:59]
v_mfma_f32_16x16x32_bf16 v[60:63], a[196:199], v[164:167], v[60:63]
s_mov_b32 s34, 917504
v_mfma_f32_16x16x32_bf16 v[64:67], a[200:203], v[164:167], v[64:67]
v_mfma_f32_16x16x32_bf16 v[68:71], a[204:207], v[164:167], v[68:71]
s_waitcnt vmcnt(23)
buffer_load_dwordx4 v[164:167], v4, s[20:23], s34 offen sc1
v_mfma_f32_16x16x32_bf16 v[72:75], a[188:191], v[168:171], v[72:75]
buffer_load_dwordx4 a[84:87], v30, s[12:15], s31 offen offset:1024 sc1
v_mfma_f32_16x16x32_bf16 v[76:79], a[192:195], v[168:171], v[76:79]
v_mfma_f32_16x16x32_bf16 v[80:83], a[196:199], v[168:171], v[80:83]
s_mov_b32 s34, 917504
v_mfma_f32_16x16x32_bf16 v[84:87], a[200:203], v[168:171], v[84:87]
v_mfma_f32_16x16x32_bf16 v[88:91], a[204:207], v[168:171], v[88:91]
s_waitcnt vmcnt(24)
buffer_load_dwordx4 v[168:171], v5, s[20:23], s34 offen sc1
v_mfma_f32_16x16x32_bf16 v[92:95], a[188:191], v[172:175], v[92:95]
v_mfma_f32_16x16x32_bf16 v[96:99], a[192:195], v[172:175], v[96:99]
v_mfma_f32_16x16x32_bf16 v[100:103], a[196:199], v[172:175], v[100:103]
s_mov_b32 s34, 917504
buffer_load_dwordx4 a[88:91], v30, s[12:15], s31 offen offset:2048 sc1
v_mfma_f32_16x16x32_bf16 v[104:107], a[200:203], v[172:175], v[104:107]
v_mfma_f32_16x16x32_bf16 v[108:111], a[204:207], v[172:175], v[108:111]
s_waitcnt vmcnt(24)
buffer_load_dwordx4 v[172:175], v6, s[20:23], s34 offen sc1
v_mfma_f32_16x16x32_bf16 a[96:99], a[208:211], v[112:115], a[96:99]
v_mfma_f32_16x16x32_bf16 a[100:103], a[212:215], v[112:115], a[100:103]
v_mfma_f32_16x16x32_bf16 a[104:107], a[216:219], v[112:115], a[104:107]
s_mov_b32 s34, 1048576
v_mfma_f32_16x16x32_bf16 a[108:111], a[220:223], v[112:115], a[108:111]
v_mfma_f32_16x16x32_bf16 a[112:115], a[224:227], v[112:115], a[112:115]
s_waitcnt vmcnt(24)
buffer_load_dwordx4 v[112:115], v3, s[20:23], s34 offen sc1
v_mfma_f32_16x16x32_bf16 v[52:55], a[208:211], v[116:119], v[52:55]
buffer_load_dwordx4 a[92:95], v30, s[12:15], s31 offen offset:3072 sc1
v_mfma_f32_16x16x32_bf16 v[56:59], a[212:215], v[116:119], v[56:59]
v_mfma_f32_16x16x32_bf16 v[60:63], a[216:219], v[116:119], v[60:63]
s_mov_b32 s34, 1048576
v_mfma_f32_16x16x32_bf16 v[64:67], a[220:223], v[116:119], v[64:67]
v_mfma_f32_16x16x32_bf16 v[68:71], a[224:227], v[116:119], v[68:71]
s_waitcnt vmcnt(24)
buffer_load_dwordx4 v[116:119], v4, s[20:23], s34 offen sc1
v_mfma_f32_16x16x32_bf16 v[72:75], a[208:211], v[120:123], v[72:75]
v_mfma_f32_16x16x32_bf16 v[76:79], a[212:215], v[120:123], v[76:79]
v_mfma_f32_16x16x32_bf16 v[80:83], a[216:219], v[120:123], v[80:83]
s_mov_b32 s34, 1048576
v_mfma_f32_16x16x32_bf16 v[84:87], a[220:223], v[120:123], v[84:87]
v_mfma_f32_16x16x32_bf16 v[88:91], a[224:227], v[120:123], v[88:91]
s_waitcnt vmcnt(23)
buffer_load_dwordx4 v[120:123], v5, s[20:23], s34 offen sc1
v_mfma_f32_16x16x32_bf16 v[92:95], a[208:211], v[124:127], v[92:95]
v_mfma_f32_16x16x32_bf16 v[96:99], a[212:215], v[124:127], v[96:99]
v_mfma_f32_16x16x32_bf16 v[100:103], a[216:219], v[124:127], v[100:103]
s_mov_b32 s34, 1048576
v_mfma_f32_16x16x32_bf16 v[104:107], a[220:223], v[124:127], v[104:107]
v_mfma_f32_16x16x32_bf16 v[108:111], a[224:227], v[124:127], v[108:111]
s_waitcnt vmcnt(23)
buffer_load_dwordx4 v[124:127], v6, s[20:23], s34 offen sc1
v_mfma_f32_16x16x32_bf16 a[96:99], a[228:231], v[128:131], a[96:99]
v_mfma_f32_16x16x32_bf16 a[100:103], a[232:235], v[128:131], a[100:103]
v_mfma_f32_16x16x32_bf16 a[104:107], a[236:239], v[128:131], a[104:107]
s_mov_b32 s34, 1179648
v_mfma_f32_16x16x32_bf16 a[108:111], a[240:243], v[128:131], a[108:111]
v_mfma_f32_16x16x32_bf16 a[112:115], a[244:247], v[128:131], a[112:115]
s_waitcnt vmcnt(22)
buffer_load_dwordx4 v[128:131], v3, s[20:23], s34 offen sc1
v_mfma_f32_16x16x32_bf16 v[52:55], a[228:231], v[132:135], v[52:55]
v_mfma_f32_16x16x32_bf16 v[56:59], a[232:235], v[132:135], v[56:59]
v_mfma_f32_16x16x32_bf16 v[60:63], a[236:239], v[132:135], v[60:63]
s_mov_b32 s34, 1179648
v_mfma_f32_16x16x32_bf16 v[64:67], a[240:243], v[132:135], v[64:67]
v_mfma_f32_16x16x32_bf16 v[68:71], a[244:247], v[132:135], v[68:71]
s_waitcnt vmcnt(21)
buffer_load_dwordx4 v[132:135], v4, s[20:23], s34 offen sc1
v_mfma_f32_16x16x32_bf16 v[72:75], a[228:231], v[136:139], v[72:75]
v_mfma_f32_16x16x32_bf16 v[76:79], a[232:235], v[136:139], v[76:79]
v_mfma_f32_16x16x32_bf16 v[80:83], a[236:239], v[136:139], v[80:83]
s_mov_b32 s34, 1179648
v_mfma_f32_16x16x32_bf16 v[84:87], a[240:243], v[136:139], v[84:87]
v_mfma_f32_16x16x32_bf16 v[88:91], a[244:247], v[136:139], v[88:91]
s_waitcnt vmcnt(21)
buffer_load_dwordx4 v[136:139], v5, s[20:23], s34 offen sc1
v_mfma_f32_16x16x32_bf16 v[92:95], a[228:231], v[140:143], v[92:95]
v_mfma_f32_16x16x32_bf16 v[96:99], a[232:235], v[140:143], v[96:99]
v_mfma_f32_16x16x32_bf16 v[100:103], a[236:239], v[140:143], v[100:103]
s_mov_b32 s34, 1179648
v_mfma_f32_16x16x32_bf16 v[104:107], a[240:243], v[140:143], v[104:107]
v_mfma_f32_16x16x32_bf16 v[108:111], a[244:247], v[140:143], v[108:111]
s_waitcnt vmcnt(20)
buffer_load_dwordx4 v[140:143], v6, s[20:23], s34 offen sc1
v_mfma_f32_16x16x32_bf16 a[96:99], a[248:251], v[144:147], a[96:99]
v_mfma_f32_16x16x32_bf16 a[100:103], a[252:255], v[144:147], a[100:103]
v_mfma_f32_16x16x32_bf16 a[104:107], a[0:3], v[144:147], a[104:107]
s_mov_b32 s34, 1310720
v_mfma_f32_16x16x32_bf16 a[108:111], a[4:7], v[144:147], a[108:111]
v_mfma_f32_16x16x32_bf16 a[112:115], a[8:11], v[144:147], a[112:115]
s_waitcnt vmcnt(19)
buffer_load_dwordx4 v[144:147], v3, s[20:23], s34 offen sc1
v_mfma_f32_16x16x32_bf16 v[52:55], a[248:251], v[148:151], v[52:55]
ds_read_b128 v[216:219], v1 offset:0
v_mfma_f32_16x16x32_bf16 v[56:59], a[252:255], v[148:151], v[56:59]
v_mfma_f32_16x16x32_bf16 v[60:63], a[0:3], v[148:151], v[60:63]
s_mov_b32 s34, 1310720
ds_read_b128 v[220:223], v1 offset:1024
v_mfma_f32_16x16x32_bf16 v[64:67], a[4:7], v[148:151], v[64:67]
v_mfma_f32_16x16x32_bf16 v[68:71], a[8:11], v[148:151], v[68:71]
s_waitcnt vmcnt(19)
buffer_load_dwordx4 v[148:151], v4, s[20:23], s34 offen sc1
v_mfma_f32_16x16x32_bf16 v[72:75], a[248:251], v[152:155], v[72:75]
ds_read_b128 v[224:227], v1 offset:2048
v_mfma_f32_16x16x32_bf16 v[76:79], a[252:255], v[152:155], v[76:79]
v_mfma_f32_16x16x32_bf16 v[80:83], a[0:3], v[152:155], v[80:83]
s_mov_b32 s34, 1310720
v_mfma_f32_16x16x32_bf16 v[84:87], a[4:7], v[152:155], v[84:87]
ds_read_b128 v[228:231], v1 offset:3072
v_mfma_f32_16x16x32_bf16 v[88:91], a[8:11], v[152:155], v[88:91]
s_waitcnt vmcnt(18)
buffer_load_dwordx4 v[152:155], v5, s[20:23], s34 offen sc1
v_mfma_f32_16x16x32_bf16 v[92:95], a[248:251], v[156:159], v[92:95]
v_mfma_f32_16x16x32_bf16 v[96:99], a[252:255], v[156:159], v[96:99]
v_mfma_f32_16x16x32_bf16 v[100:103], a[0:3], v[156:159], v[100:103]
s_mov_b32 s34, 1310720
v_mfma_f32_16x16x32_bf16 v[104:107], a[4:7], v[156:159], v[104:107]
v_mfma_f32_16x16x32_bf16 v[108:111], a[8:11], v[156:159], v[108:111]
s_waitcnt vmcnt(17)
buffer_load_dwordx4 v[156:159], v6, s[20:23], s34 offen sc1
v_mfma_f32_16x16x32_bf16 a[96:99], a[12:15], v[160:163], a[96:99]
s_waitcnt lgkmcnt(0)
v_mfma_f32_16x16x32_bf16 a[100:103], v[216:219], v[160:163], a[100:103]
ds_read_b128 v[192:195], v1 offset:16384
v_mfma_f32_16x16x32_bf16 a[104:107], v[220:223], v[160:163], a[104:107]
s_mov_b32 s34, 1441792
v_mfma_f32_16x16x32_bf16 a[108:111], v[224:227], v[160:163], a[108:111]
v_mfma_f32_16x16x32_bf16 a[112:115], v[228:231], v[160:163], a[112:115]
s_waitcnt vmcnt(17)
buffer_load_dwordx4 v[160:163], v3, s[20:23], s34 offen sc1
v_mfma_f32_16x16x32_bf16 v[52:55], a[12:15], v[164:167], v[52:55]
ds_read_b128 v[196:199], v1 offset:17408
v_mfma_f32_16x16x32_bf16 v[56:59], v[216:219], v[164:167], v[56:59]
v_mfma_f32_16x16x32_bf16 v[60:63], v[220:223], v[164:167], v[60:63]
s_mov_b32 s34, 1441792
ds_read_b128 v[200:203], v1 offset:18432
v_mfma_f32_16x16x32_bf16 v[64:67], v[224:227], v[164:167], v[64:67]
v_mfma_f32_16x16x32_bf16 v[68:71], v[228:231], v[164:167], v[68:71]
s_waitcnt vmcnt(16)
buffer_load_dwordx4 v[164:167], v4, s[20:23], s34 offen sc1
v_mfma_f32_16x16x32_bf16 v[72:75], a[12:15], v[168:171], v[72:75]
ds_read_b128 v[204:207], v1 offset:19456
v_mfma_f32_16x16x32_bf16 v[76:79], v[216:219], v[168:171], v[76:79]
v_mfma_f32_16x16x32_bf16 v[80:83], v[220:223], v[168:171], v[80:83]
s_mov_b32 s34, 1441792
v_mfma_f32_16x16x32_bf16 v[84:87], v[224:227], v[168:171], v[84:87]
ds_read_b128 v[208:211], v1 offset:32768
v_mfma_f32_16x16x32_bf16 v[88:91], v[228:231], v[168:171], v[88:91]
s_waitcnt vmcnt(15)
buffer_load_dwordx4 v[168:171], v5, s[20:23], s34 offen sc1
v_mfma_f32_16x16x32_bf16 v[92:95], a[12:15], v[172:175], v[92:95]
v_mfma_f32_16x16x32_bf16 v[96:99], v[216:219], v[172:175], v[96:99]
v_mfma_f32_16x16x32_bf16 v[100:103], v[220:223], v[172:175], v[100:103]
s_mov_b32 s34, 1441792
v_mfma_f32_16x16x32_bf16 v[104:107], v[224:227], v[172:175], v[104:107]
v_mfma_f32_16x16x32_bf16 v[108:111], v[228:231], v[172:175], v[108:111]
s_waitcnt lgkmcnt(0)
s_waitcnt vmcnt(15)
buffer_load_dwordx4 v[172:175], v6, s[20:23], s34 offen sc1
s_cmp_lt_u32 s75, 16
s_cbranch_scc0 OC1
buffer_load_dword v245, v246, s[64:67], 0 offen sc1
OC1:
v_mfma_f32_16x16x32_bf16 a[96:99], v[192:195], v[112:115], a[96:99]
v_mfma_f32_16x16x32_bf16 a[100:103], v[196:199], v[112:115], a[100:103]
ds_read_b128 v[212:215], v1 offset:33792
v_mfma_f32_16x16x32_bf16 a[104:107], v[200:203], v[112:115], a[104:107]
s_mov_b32 s34, 1572864
v_mfma_f32_16x16x32_bf16 a[108:111], v[204:207], v[112:115], a[108:111]
v_mfma_f32_16x16x32_bf16 a[112:115], v[208:211], v[112:115], a[112:115]
s_waitcnt vmcnt(14)
buffer_load_dwordx4 v[112:115], v3, s[20:23], s34 offen sc1
v_mfma_f32_16x16x32_bf16 v[52:55], v[192:195], v[116:119], v[52:55]
ds_read_b128 v[216:219], v1 offset:34816
v_mfma_f32_16x16x32_bf16 v[56:59], v[196:199], v[116:119], v[56:59]
v_mfma_f32_16x16x32_bf16 v[60:63], v[200:203], v[116:119], v[60:63]
s_mov_b32 s34, 1572864
ds_read_b128 v[220:223], v1 offset:35840
v_mfma_f32_16x16x32_bf16 v[64:67], v[204:207], v[116:119], v[64:67]
v_mfma_f32_16x16x32_bf16 v[68:71], v[208:211], v[116:119], v[68:71]
s_waitcnt vmcnt(14)
buffer_load_dwordx4 v[116:119], v4, s[20:23], s34 offen sc1
v_mfma_f32_16x16x32_bf16 v[72:75], v[192:195], v[120:123], v[72:75]
ds_read_b128 v[224:227], v1 offset:49152
v_mfma_f32_16x16x32_bf16 v[76:79], v[196:199], v[120:123], v[76:79]
v_mfma_f32_16x16x32_bf16 v[80:83], v[200:203], v[120:123], v[80:83]
s_mov_b32 s34, 1572864
v_mfma_f32_16x16x32_bf16 v[84:87], v[204:207], v[120:123], v[84:87]
ds_read_b128 v[228:231], v1 offset:50176
v_mfma_f32_16x16x32_bf16 v[88:91], v[208:211], v[120:123], v[88:91]
s_waitcnt vmcnt(14)
buffer_load_dwordx4 v[120:123], v5, s[20:23], s34 offen sc1
v_mfma_f32_16x16x32_bf16 v[92:95], v[192:195], v[124:127], v[92:95]
v_mfma_f32_16x16x32_bf16 v[96:99], v[196:199], v[124:127], v[96:99]
v_mfma_f32_16x16x32_bf16 v[100:103], v[200:203], v[124:127], v[100:103]
s_mov_b32 s34, 1572864
v_mfma_f32_16x16x32_bf16 v[104:107], v[204:207], v[124:127], v[104:107]
v_mfma_f32_16x16x32_bf16 v[108:111], v[208:211], v[124:127], v[108:111]
s_waitcnt lgkmcnt(0)
s_waitcnt vmcnt(14)
buffer_load_dwordx4 v[124:127], v6, s[20:23], s34 offen sc1
v_mfma_f32_16x16x32_bf16 a[96:99], v[212:215], v[128:131], a[96:99]
v_mfma_f32_16x16x32_bf16 a[100:103], v[216:219], v[128:131], a[100:103]
ds_read_b128 v[192:195], v1 offset:51200
v_mfma_f32_16x16x32_bf16 a[104:107], v[220:223], v[128:131], a[104:107]
s_mov_b32 s34, 1703936
v_mfma_f32_16x16x32_bf16 a[108:111], v[224:227], v[128:131], a[108:111]
v_mfma_f32_16x16x32_bf16 a[112:115], v[228:231], v[128:131], a[112:115]
s_waitcnt vmcnt(14)
buffer_load_dwordx4 v[128:131], v3, s[20:23], s34 offen sc1
v_mfma_f32_16x16x32_bf16 v[52:55], v[212:215], v[132:135], v[52:55]
ds_read_b128 v[196:199], v1 offset:52224
v_mfma_f32_16x16x32_bf16 v[56:59], v[216:219], v[132:135], v[56:59]
v_mfma_f32_16x16x32_bf16 v[60:63], v[220:223], v[132:135], v[60:63]
s_mov_b32 s34, 1703936
ds_read_b128 v[200:203], v2 offset:0
v_mfma_f32_16x16x32_bf16 v[64:67], v[224:227], v[132:135], v[64:67]
v_mfma_f32_16x16x32_bf16 v[68:71], v[228:231], v[132:135], v[68:71]
s_waitcnt vmcnt(14)
buffer_load_dwordx4 v[132:135], v4, s[20:23], s34 offen sc1
v_mfma_f32_16x16x32_bf16 v[72:75], v[212:215], v[136:139], v[72:75]
ds_read_b128 v[204:207], v2 offset:1024
v_mfma_f32_16x16x32_bf16 v[76:79], v[216:219], v[136:139], v[76:79]
v_mfma_f32_16x16x32_bf16 v[80:83], v[220:223], v[136:139], v[80:83]
s_mov_b32 s34, 1703936
v_mfma_f32_16x16x32_bf16 v[84:87], v[224:227], v[136:139], v[84:87]
ds_read_b128 v[208:211], v2 offset:2048
v_mfma_f32_16x16x32_bf16 v[88:91], v[228:231], v[136:139], v[88:91]
s_waitcnt vmcnt(14)
buffer_load_dwordx4 v[136:139], v5, s[20:23], s34 offen sc1
v_mfma_f32_16x16x32_bf16 v[92:95], v[212:215], v[140:143], v[92:95]
v_mfma_f32_16x16x32_bf16 v[96:99], v[216:219], v[140:143], v[96:99]
v_mfma_f32_16x16x32_bf16 v[100:103], v[220:223], v[140:143], v[100:103]
s_mov_b32 s34, 1703936
v_mfma_f32_16x16x32_bf16 v[104:107], v[224:227], v[140:143], v[104:107]
v_mfma_f32_16x16x32_bf16 v[108:111], v[228:231], v[140:143], v[108:111]
s_waitcnt lgkmcnt(0)
s_waitcnt vmcnt(14)
buffer_load_dwordx4 v[140:143], v6, s[20:23], s34 offen sc1
v_mfma_f32_16x16x32_bf16 a[96:99], v[192:195], v[144:147], a[96:99]
v_mov_b32 v176, 0
v_mov_b32 v177, 0
v_mfma_f32_16x16x32_bf16 a[100:103], v[196:199], v[144:147], a[100:103]
ds_read_b128 v[212:215], v2 offset:3072
v_mov_b32 v178, 0
v_mov_b32 v179, 0
v_mfma_f32_16x16x32_bf16 a[104:107], v[200:203], v[144:147], a[104:107]
s_mov_b32 s34, 1835008
v_mov_b32 v180, 0
v_mov_b32 v181, 0
v_mfma_f32_16x16x32_bf16 a[108:111], v[204:207], v[144:147], a[108:111]
v_mfma_f32_16x16x32_bf16 a[112:115], v[208:211], v[144:147], a[112:115]
s_waitcnt vmcnt(14)
buffer_load_dwordx4 v[144:147], v3, s[20:23], s34 offen sc1
v_mfma_f32_16x16x32_bf16 v[52:55], v[192:195], v[148:151], v[52:55]
ds_read_b128 v[216:219], v2 offset:16384
v_mov_b32 v182, 0
v_mov_b32 v183, 0
v_mfma_f32_16x16x32_bf16 v[56:59], v[196:199], v[148:151], v[56:59]
v_mov_b32 v184, 0
v_mov_b32 v185, 0
v_mfma_f32_16x16x32_bf16 v[60:63], v[200:203], v[148:151], v[60:63]
s_mov_b32 s34, 1835008
ds_read_b128 v[220:223], v2 offset:17408
v_mov_b32 v186, 0
v_mov_b32 v187, 0
v_mfma_f32_16x16x32_bf16 v[64:67], v[204:207], v[148:151], v[64:67]
v_mfma_f32_16x16x32_bf16 v[68:71], v[208:211], v[148:151], v[68:71]
s_waitcnt vmcnt(14)
buffer_load_dwordx4 v[148:151], v4, s[20:23], s34 offen sc1
v_mfma_f32_16x16x32_bf16 v[72:75], v[192:195], v[152:155], v[72:75]
ds_read_b128 v[224:227], v2 offset:18432
v_mov_b32 v188, 0
v_mov_b32 v189, 0
v_mfma_f32_16x16x32_bf16 v[76:79], v[196:199], v[152:155], v[76:79]
v_mov_b32 v190, 0
v_mov_b32 v191, 0
v_mfma_f32_16x16x32_bf16 v[80:83], v[200:203], v[152:155], v[80:83]
s_mov_b32 s34, 1835008
v_mov_b32 v248, 0
v_mov_b32 v249, 0
v_mfma_f32_16x16x32_bf16 v[84:87], v[204:207], v[152:155], v[84:87]
ds_read_b128 v[228:231], v2 offset:19456
v_mfma_f32_16x16x32_bf16 v[88:91], v[208:211], v[152:155], v[88:91]
s_waitcnt vmcnt(14)
buffer_load_dwordx4 v[152:155], v5, s[20:23], s34 offen sc1
v_mfma_f32_16x16x32_bf16 v[92:95], v[192:195], v[156:159], v[92:95]
v_mov_b32 v250, 0
v_mov_b32 v251, 0
v_mfma_f32_16x16x32_bf16 v[96:99], v[196:199], v[156:159], v[96:99]
v_mfma_f32_16x16x32_bf16 v[100:103], v[200:203], v[156:159], v[100:103]
s_mov_b32 s34, 1835008
v_mfma_f32_16x16x32_bf16 v[104:107], v[204:207], v[156:159], v[104:107]
v_mfma_f32_16x16x32_bf16 v[108:111], v[208:211], v[156:159], v[108:111]
s_waitcnt lgkmcnt(0)
s_waitcnt vmcnt(14)
buffer_load_dwordx4 v[156:159], v6, s[20:23], s34 offen sc1
v_mfma_f32_16x16x32_bf16 a[96:99], v[212:215], v[160:163], a[96:99]
v_mfma_f32_16x16x32_bf16 a[100:103], v[216:219], v[160:163], a[100:103]
v_mfma_f32_16x16x32_bf16 a[104:107], v[220:223], v[160:163], a[104:107]
s_mov_b32 s34, 1966080
v_mfma_f32_16x16x32_bf16 a[108:111], v[224:227], v[160:163], a[108:111]
v_mfma_f32_16x16x32_bf16 a[112:115], v[228:231], v[160:163], a[112:115]
s_waitcnt vmcnt(14)
buffer_load_dwordx4 v[160:163], v3, s[20:23], s34 offen sc1
v_mfma_f32_16x16x32_bf16 v[52:55], v[212:215], v[164:167], v[52:55]
v_mfma_f32_16x16x32_bf16 v[56:59], v[216:219], v[164:167], v[56:59]
v_mfma_f32_16x16x32_bf16 v[60:63], v[220:223], v[164:167], v[60:63]
s_mov_b32 s34, 1966080
v_mfma_f32_16x16x32_bf16 v[64:67], v[224:227], v[164:167], v[64:67]
v_mfma_f32_16x16x32_bf16 v[68:71], v[228:231], v[164:167], v[68:71]
s_waitcnt vmcnt(14)
buffer_load_dwordx4 v[164:167], v4, s[20:23], s34 offen sc1
v_mfma_f32_16x16x32_bf16 v[72:75], v[212:215], v[168:171], v[72:75]
v_mfma_f32_16x16x32_bf16 v[76:79], v[216:219], v[168:171], v[76:79]
v_mfma_f32_16x16x32_bf16 v[80:83], v[220:223], v[168:171], v[80:83]
s_mov_b32 s34, 1966080
v_mfma_f32_16x16x32_bf16 v[84:87], v[224:227], v[168:171], v[84:87]
v_mfma_f32_16x16x32_bf16 v[88:91], v[228:231], v[168:171], v[88:91]
s_waitcnt vmcnt(14)
buffer_load_dwordx4 v[168:171], v5, s[20:23], s34 offen sc1
v_mfma_f32_16x16x32_bf16 v[92:95], v[212:215], v[172:175], v[92:95]
v_mfma_f32_16x16x32_bf16 v[96:99], v[216:219], v[172:175], v[96:99]
v_mfma_f32_16x16x32_bf16 v[100:103], v[220:223], v[172:175], v[100:103]
s_mov_b32 s34, 1966080
v_mfma_f32_16x16x32_bf16 v[104:107], v[224:227], v[172:175], v[104:107]
v_mfma_f32_16x16x32_bf16 v[108:111], v[228:231], v[172:175], v[108:111]
s_waitcnt vmcnt(14)
buffer_load_dwordx4 v[172:175], v6, s[20:23], s34 offen sc1
s_cmp_lt_u32 s75, 16
s_cbranch_scc0 OC2
s_waitcnt vmcnt(16)
s_movk_i32 s72, 256
s_mov_b32 s32, 0x100000
OCS:
v_cmp_gt_u32 vcc, s72, v245
s_sub_u32 s32, s32, 1
s_cbranch_scc1 OCS_OK
s_cbranch_vccz OCS_OK
s_sleep 1
buffer_load_dword v245, v246, s[64:67], 0 offen sc1
s_waitcnt vmcnt(0)
s_branch OCS
OCS_OK:
buffer_load_dwordx4 v[176:179], v13, s[24:27], 0 offen offset:0 sc1
buffer_load_dwordx4 v[180:183], v13, s[24:27], 0 offen offset:16 sc1
buffer_load_dwordx4 v[184:187], v13, s[24:27], 0 offen offset:128 sc1
buffer_load_dwordx4 v[188:191], v13, s[24:27], 0 offen offset:144 sc1
buffer_load_dwordx4 v[248:251], v15, s[24:27], 0 offen offset:256 sc1
OC2:
v_mfma_f32_16x16x32_bf16 a[96:99], a[16:19], v[112:115], a[96:99]
s_sub_u32 s72, s28, 1
s_and_b32 s72, s72, 3
s_lshl_b32 s72, s72, 12
s_add_u32 s72, s72, 98304
v_add_u32 v231, s72, v30
v_mfma_f32_16x16x32_bf16 a[100:103], a[20:23], v[112:115], a[100:103]
v_mfma_f32_16x16x32_bf16 a[104:107], a[24:27], v[112:115], a[104:107]
s_mov_b32 s34, 0
v_mfma_f32_16x16x32_bf16 a[108:111], a[28:31], v[112:115], a[108:111]
v_mfma_f32_16x16x32_bf16 a[112:115], a[32:35], v[112:115], a[112:115]
s_waitcnt vmcnt(14)
buffer_load_dwordx4 v[112:115], v7, s[20:23], s34 offen sc1
v_mfma_f32_16x16x32_bf16 v[52:55], a[16:19], v[116:119], v[52:55]
s_sub_u32 s72, s28, 2
s_and_b32 s72, s72, 3
s_lshl_b32 s72, s72, 12
s_add_u32 s72, s72, 98304
v_add_u32 v228, s72, v30
v_mfma_f32_16x16x32_bf16 v[56:59], a[20:23], v[116:119], v[56:59]
v_mfma_f32_16x16x32_bf16 v[60:63], a[24:27], v[116:119], v[60:63]
s_mov_b32 s34, 0
v_mfma_f32_16x16x32_bf16 v[64:67], a[28:31], v[116:119], v[64:67]
v_mfma_f32_16x16x32_bf16 v[68:71], a[32:35], v[116:119], v[68:71]
s_waitcnt vmcnt(14)
buffer_load_dwordx4 v[116:119], v8, s[20:23], s34 offen sc1
v_mfma_f32_16x16x32_bf16 v[72:75], a[16:19], v[120:123], v[72:75]
s_sub_u32 s72, s28, 2
s_and_b32 s72, s72, 3
s_lshl_b32 s72, s72, 13
s_add_u32 s72, s72, 131072
v_add_u32 v229, s72, v30
v_mfma_f32_16x16x32_bf16 v[76:79], a[20:23], v[120:123], v[76:79]
v_mfma_f32_16x16x32_bf16 v[80:83], a[24:27], v[120:123], v[80:83]
s_mov_b32 s34, 0
v_mfma_f32_16x16x32_bf16 v[84:87], a[28:31], v[120:123], v[84:87]
v_mfma_f32_16x16x32_bf16 v[88:91], a[32:35], v[120:123], v[88:91]
s_waitcnt vmcnt(14)
buffer_load_dwordx4 v[120:123], v9, s[20:23], s34 offen sc1
v_mfma_f32_16x16x32_bf16 v[92:95], a[16:19], v[124:127], v[92:95]
s_sub_u32 s72, s28, 3
s_and_b32 s72, s72, 3
s_lshl_b32 s72, s72, 13
s_add_u32 s72, s72, 131072
v_add_u32 v230, s72, v30
v_mfma_f32_16x16x32_bf16 v[96:99], a[20:23], v[124:127], v[96:99]
v_mfma_f32_16x16x32_bf16 v[100:103], a[24:27], v[124:127], v[100:103]
s_mov_b32 s34, 0
v_mfma_f32_16x16x32_bf16 v[104:107], a[28:31], v[124:127], v[104:107]
v_mfma_f32_16x16x32_bf16 v[108:111], a[32:35], v[124:127], v[108:111]
s_waitcnt vmcnt(13)
buffer_load_dwordx4 v[124:127], v10, s[20:23], s34 offen sc1
v_mfma_f32_16x16x32_bf16 v[52:55], a[36:39], v[132:135], v[52:55]
v_mfma_f32_16x16x32_bf16 v[56:59], a[40:43], v[132:135], v[56:59]
v_mfma_f32_16x16x32_bf16 v[60:63], a[44:47], v[132:135], v[60:63]
s_mov_b32 s34, 131072
v_mfma_f32_16x16x32_bf16 v[64:67], a[48:51], v[132:135], v[64:67]
v_mfma_f32_16x16x32_bf16 v[68:71], a[52:55], v[132:135], v[68:71]
s_waitcnt vmcnt(13)
buffer_load_dwordx4 v[132:135], v8, s[20:23], s34 offen sc1
v_mfma_f32_16x16x32_bf16 v[72:75], a[36:39], v[136:139], v[72:75]
v_mfma_f32_16x16x32_bf16 v[76:79], a[40:43], v[136:139], v[76:79]
v_mfma_f32_16x16x32_bf16 v[80:83], a[44:47], v[136:139], v[80:83]
s_mov_b32 s34, 131072
v_mfma_f32_16x16x32_bf16 v[84:87], a[48:51], v[136:139], v[84:87]
v_mfma_f32_16x16x32_bf16 v[88:91], a[52:55], v[136:139], v[88:91]
s_waitcnt vmcnt(11)
buffer_load_dwordx4 v[136:139], v9, s[20:23], s34 offen sc1
v_mfma_f32_16x16x32_bf16 v[52:55], a[56:59], v[148:151], v[52:55]
v_mfma_f32_16x16x32_bf16 v[56:59], a[60:63], v[148:151], v[56:59]
v_mfma_f32_16x16x32_bf16 v[60:63], a[64:67], v[148:151], v[60:63]
s_mov_b32 s34, 262144
v_mfma_f32_16x16x32_bf16 v[64:67], a[68:71], v[148:151], v[64:67]
v_mfma_f32_16x16x32_bf16 v[68:71], a[72:75], v[148:151], v[68:71]
buffer_load_dwordx4 v[148:151], v8, s[20:23], s34 offen sc1
v_mfma_f32_16x16x32_bf16 v[92:95], a[36:39], v[140:143], v[92:95]
v_mfma_f32_16x16x32_bf16 v[96:99], a[40:43], v[140:143], v[96:99]
v_mfma_f32_16x16x32_bf16 v[100:103], a[44:47], v[140:143], v[100:103]
s_mov_b32 s34, 131072
v_mfma_f32_16x16x32_bf16 v[104:107], a[48:51], v[140:143], v[104:107]
v_mfma_f32_16x16x32_bf16 v[108:111], a[52:55], v[140:143], v[108:111]
s_waitcnt vmcnt(9)
buffer_load_dwordx4 v[140:143], v10, s[20:23], s34 offen sc1
v_mfma_f32_16x16x32_bf16 v[52:55], a[76:79], v[164:167], v[52:55]
v_mfma_f32_16x16x32_bf16 v[56:59], a[80:83], v[164:167], v[56:59]
v_mfma_f32_16x16x32_bf16 v[60:63], a[84:87], v[164:167], v[60:63]
s_mov_b32 s34, 393216
v_mfma_f32_16x16x32_bf16 v[64:67], a[88:91], v[164:167], v[64:67]
v_mfma_f32_16x16x32_bf16 v[68:71], a[92:95], v[164:167], v[68:71]
buffer_load_dwordx4 v[164:167], v8, s[20:23], s34 offen sc1
v_mfma_f32_16x16x32_bf16 v[72:75], a[56:59], v[152:155], v[72:75]
v_mfma_f32_16x16x32_bf16 v[76:79], a[60:63], v[152:155], v[76:79]
v_mfma_f32_16x16x32_bf16 v[80:83], a[64:67], v[152:155], v[80:83]
s_mov_b32 s34, 262144
v_mfma_f32_16x16x32_bf16 v[84:87], a[68:71], v[152:155], v[84:87]
v_mfma_f32_16x16x32_bf16 v[88:91], a[72:75], v[152:155], v[88:91]
buffer_load_dwordx4 v[152:155], v9, s[20:23], s34 offen sc1
v_mfma_f32_16x16x32_bf16 a[96:99], a[36:39], v[128:131], a[96:99]
ds_write_b128 v17, v[52:55] offset:0
v_mfma_f32_16x16x32_bf16 a[100:103], a[40:43], v[128:131], a[100:103]
v_mfma_f32_16x16x32_bf16 a[104:107], a[44:47], v[128:131], a[104:107]
s_mov_b32 s34, 131072
v_mfma_f32_16x16x32_bf16 a[108:111], a[48:51], v[128:131], a[108:111]
ds_write_b128 v17, v[56:59] offset:1024
v_mfma_f32_16x16x32_bf16 a[112:115], a[52:55], v[128:131], a[112:115]
s_waitcnt vmcnt(11)
buffer_load_dwordx4 v[128:131], v7, s[20:23], s34 offen sc1
v_mfma_f32_16x16x32_bf16 v[72:75], a[76:79], v[168:171], v[72:75]
v_mfma_f32_16x16x32_bf16 v[76:79], a[80:83], v[168:171], v[76:79]
ds_write_b128 v17, v[60:63] offset:2048
v_mfma_f32_16x16x32_bf16 v[80:83], a[84:87], v[168:171], v[80:83]
s_mov_b32 s34, 393216
v_mfma_f32_16x16x32_bf16 v[84:87], a[88:91], v[168:171], v[84:87]
v_mfma_f32_16x16x32_bf16 v[88:91], a[92:95], v[168:171], v[88:91]
buffer_load_dwordx4 v[168:171], v9, s[20:23], s34 offen sc1
v_mfma_f32_16x16x32_bf16 v[92:95], a[56:59], v[156:159], v[92:95]
ds_write_b128 v17, v[64:67] offset:3072
v_mfma_f32_16x16x32_bf16 v[96:99], a[60:63], v[156:159], v[96:99]
v_mfma_f32_16x16x32_bf16 v[100:103], a[64:67], v[156:159], v[100:103]
s_mov_b32 s34, 262144
v_mfma_f32_16x16x32_bf16 v[104:107], a[68:71], v[156:159], v[104:107]
ds_write_b128 v17, v[68:71] offset:16384
v_mfma_f32_16x16x32_bf16 v[108:111], a[72:75], v[156:159], v[108:111]
s_waitcnt vmcnt(12)
buffer_load_dwordx4 v[156:159], v10, s[20:23], s34 offen sc1
v_mfma_f32_16x16x32_bf16 v[92:95], a[76:79], v[172:175], v[92:95]
v_mfma_f32_16x16x32_bf16 v[96:99], a[80:83], v[172:175], v[96:99]
ds_write_b128 v17, v[72:75] offset:17408
v_mfma_f32_16x16x32_bf16 v[100:103], a[84:87], v[172:175], v[100:103]
s_mov_b32 s34, 393216
v_mfma_f32_16x16x32_bf16 v[104:107], a[88:91], v[172:175], v[104:107]
v_mfma_f32_16x16x32_bf16 v[108:111], a[92:95], v[172:175], v[108:111]
buffer_load_dwordx4 v[172:175], v10, s[20:23], s34 offen sc1
v_mfma_f32_16x16x32_bf16 a[96:99], a[56:59], v[144:147], a[96:99]
ds_write_b128 v17, v[76:79] offset:18432
v_mfma_f32_16x16x32_bf16 a[100:103], a[60:63], v[144:147], a[100:103]
v_mfma_f32_16x16x32_bf16 a[104:107], a[64:67], v[144:147], a[104:107]
s_mov_b32 s34, 262144
v_mfma_f32_16x16x32_bf16 a[108:111], a[68:71], v[144:147], a[108:111]
ds_write_b128 v17, v[80:83] offset:19456
v_mfma_f32_16x16x32_bf16 a[112:115], a[72:75], v[144:147], a[112:115]
buffer_load_dwordx4 v[144:147], v7, s[20:23], s34 offen sc1
v_mfma_f32_16x16x32_bf16 a[96:99], a[76:79], v[160:163], a[96:99]
v_mfma_f32_16x16x32_bf16 a[100:103], a[80:83], v[160:163], a[100:103]
ds_write_b128 v21, v[84:87] offset:0
v_mfma_f32_16x16x32_bf16 a[104:107], a[84:87], v[160:163], a[104:107]
s_mov_b32 s34, 393216
v_mfma_f32_16x16x32_bf16 a[108:111], a[88:91], v[160:163], a[108:111]
v_mfma_f32_16x16x32_bf16 a[112:115], a[92:95], v[160:163], a[112:115]
s_waitcnt vmcnt(14)
buffer_load_dwordx4 v[160:163], v7, s[20:23], s34 offen sc1
v_mfma_f32_16x16x32_bf16 v[32:35], a[128:131], v[112:115], 0
ds_write_b128 v21, v[88:91] offset:1024
v_mfma_f32_16x16x32_bf16 v[36:39], a[132:135], v[112:115], 0
v_mfma_f32_16x16x32_bf16 v[40:43], a[136:139], v[112:115], 0
s_mov_b32 s34, 524288
v_mfma_f32_16x16x32_bf16 v[44:47], a[140:143], v[112:115], 0
ds_write_b128 v21, v[92:95] offset:2048
v_mfma_f32_16x16x32_bf16 v[48:51], a[144:147], v[112:115], 0
s_waitcnt vmcnt(14)
buffer_load_dwordx4 v[112:115], v7, s[20:23], s34 offen sc1
v_mfma_f32_16x16x32_bf16 v[52:55], a[128:131], v[116:119], 0
v_mfma_f32_16x16x32_bf16 v[56:59], a[132:135], v[116:119], 0
ds_write_b128 v21, v[96:99] offset:3072
v_mfma_f32_16x16x32_bf16 v[60:63], a[136:139], v[116:119], 0
s_mov_b32 s34, 524288
v_mfma_f32_16x16x32_bf16 v[64:67], a[140:143], v[116:119], 0
v_mfma_f32_16x16x32_bf16 v[68:71], a[144:147], v[116:119], 0
s_waitcnt vmcnt(14)
buffer_load_dwordx4 v[116:119], v8, s[20:23], s34 offen sc1
v_mfma_f32_16x16x32_bf16 v[72:75], a[128:131], v[120:123], 0
ds_write_b128 v21, v[100:103] offset:4096
v_mfma_f32_16x16x32_bf16 v[76:79], a[132:135], v[120:123], 0
v_mfma_f32_16x16x32_bf16 v[80:83], a[136:139], v[120:123], 0
s_mov_b32 s34, 524288
v_mfma_f32_16x16x32_bf16 v[84:87], a[140:143], v[120:123], 0
ds_write_b128 v21, v[104:107] offset:5120
v_mfma_f32_16x16x32_bf16 v[88:91], a[144:147], v[120:123], 0
s_waitcnt vmcnt(14)
buffer_load_dwordx4 v[120:123], v9, s[20:23], s34 offen sc1
v_mfma_f32_16x16x32_bf16 v[92:95], a[128:131], v[124:127], 0
v_mfma_f32_16x16x32_bf16 v[96:99], a[132:135], v[124:127], 0
ds_write_b128 v21, v[108:111] offset:6144
v_mfma_f32_16x16x32_bf16 v[100:103], a[136:139], v[124:127], 0
s_mov_b32 s34, 524288
v_mfma_f32_16x16x32_bf16 v[104:107], a[140:143], v[124:127], 0
v_mfma_f32_16x16x32_bf16 v[108:111], a[144:147], v[124:127], 0
s_waitcnt vmcnt(8)
buffer_load_dwordx4 v[124:127], v10, s[20:23], s34 offen sc1
v_mfma_f32_16x16x32_bf16 v[32:35], a[148:151], v[128:131], v[32:35]
v_mfma_f32_16x16x32_bf16 v[36:39], a[152:155], v[128:131], v[36:39]
s_add_u32 s31, s76, 4096
s_waitcnt lgkmcnt(0)
s_barrier
v_mfma_f32_16x16x32_bf16 v[40:43], a[156:159], v[128:131], v[40:43]
s_mov_b32 s34, 655360
ds_read_b128 v[192:195], v231 offset:0
v_mfma_f32_16x16x32_bf16 v[44:47], a[160:163], v[128:131], v[44:47]
ds_read_b128 v[196:199], v228 offset:17408
v_mfma_f32_16x16x32_bf16 v[48:51], a[164:167], v[128:131], v[48:51]
buffer_load_dwordx4 v[128:131], v7, s[20:23], s34 offen sc1
v_mfma_f32_16x16x32_bf16 v[52:55], a[148:151], v[132:135], v[52:55]
ds_read_b128 v[200:203], v230 offset:2048
v_mfma_f32_16x16x32_bf16 v[56:59], a[152:155], v[132:135], v[56:59]
ds_read_b128 v[204:207], v231 offset:1024
v_mfma_f32_16x16x32_bf16 v[60:63], a[156:159], v[132:135], v[60:63]
s_mov_b32 s34, 655360
ds_read_b128 v[208:211], v228 offset:18432
v_mfma_f32_16x16x32_bf16 v[64:67], a[160:163], v[132:135], v[64:67]
ds_read_b128 v[212:215], v230 offset:3072
v_mfma_f32_16x16x32_bf16 v[68:71], a[164:167], v[132:135], v[68:71]
buffer_load_dwordx4 v[132:135], v8, s[20:23], s34 offen sc1
v_mfma_f32_16x16x32_bf16 v[72:75], a[148:151], v[136:139], v[72:75]
ds_read_b128 v[216:219], v231 offset:2048
v_mfma_f32_16x16x32_bf16 v[76:79], a[152:155], v[136:139], v[76:79]
ds_read_b128 v[220:223], v228 offset:19456
v_mfma_f32_16x16x32_bf16 v[80:83], a[156:159], v[136:139], v[80:83]
s_mov_b32 s34, 655360
ds_read_b128 v[224:227], v230 offset:4096
v_mfma_f32_16x16x32_bf16 v[84:87], a[160:163], v[136:139], v[84:87]
v_accvgpr_read_b32 v240, a96
v_accvgpr_read_b32 v241, a97
v_mfma_f32_16x16x32_bf16 v[88:91], a[164:167], v[136:139], v[88:91]
buffer_load_dwordx4 v[136:139], v9, s[20:23], s34 offen sc1
v_mfma_f32_16x16x32_bf16 v[92:95], a[148:151], v[140:143], v[92:95]
v_accvgpr_read_b32 v242, a98
v_accvgpr_read_b32 v243, a99
v_mfma_f32_16x16x32_bf16 v[96:99], a[152:155], v[140:143], v[96:99]
s_waitcnt lgkmcnt(2)
v_add_f32 v192, v192, v196
v_add_f32 v193, v193, v197
v_mfma_f32_16x16x32_bf16 v[100:103], a[156:159], v[140:143], v[100:103]
s_mov_b32 s34, 655360
v_add_f32 v194, v194, v198
v_add_f32 v195, v195, v199
v_mfma_f32_16x16x32_bf16 v[104:107], a[160:163], v[140:143], v[104:107]
v_add_f32 v240, v240, v200
v_add_f32 v241, v241, v201
v_mfma_f32_16x16x32_bf16 v[108:111], a[164:167], v[140:143], v[108:111]
s_waitcnt vmcnt(8)
buffer_load_dwordx4 v[140:143], v10, s[20:23], s34 offen sc1
v_mfma_f32_16x16x32_bf16 v[32:35], a[168:171], v[144:147], v[32:35]
v_add_f32 v242, v242, v202
v_add_f32 v243, v243, v203
v_mfma_f32_16x16x32_bf16 v[36:39], a[172:175], v[144:147], v[36:39]
v_add_f32 v192, v192, v240
v_add_f32 v193, v193, v241
v_mfma_f32_16x16x32_bf16 v[40:43], a[176:179], v[144:147], v[40:43]
s_mov_b32 s34, 786432
v_add_f32 v194, v194, v242
v_add_f32 v195, v195, v243
v_mfma_f32_16x16x32_bf16 v[44:47], a[180:183], v[144:147], v[44:47]
buffer_store_dwordx4 v[192:195], v30, s[68:71], s76 offen offset:0 sc1
v_mfma_f32_16x16x32_bf16 v[48:51], a[184:187], v[144:147], v[48:51]
buffer_load_dwordx4 v[144:147], v7, s[20:23], s34 offen sc1
v_mfma_f32_16x16x32_bf16 v[52:55], a[168:171], v[148:151], v[52:55]
ds_read_b128 v[192:195], v231 offset:3072
v_mfma_f32_16x16x32_bf16 v[56:59], a[172:175], v[148:151], v[56:59]
ds_read_b128 v[196:199], v229 offset:0
v_mfma_f32_16x16x32_bf16 v[60:63], a[176:179], v[148:151], v[60:63]
s_mov_b32 s34, 786432
ds_read_b128 v[200:203], v230 offset:5120
v_mfma_f32_16x16x32_bf16 v[64:67], a[180:183], v[148:151], v[64:67]
v_accvgpr_read_b32 v240, a100
v_accvgpr_read_b32 v241, a101
v_mfma_f32_16x16x32_bf16 v[68:71], a[184:187], v[148:151], v[68:71]
buffer_load_dwordx4 v[148:151], v8, s[20:23], s34 offen sc1
v_mfma_f32_16x16x32_bf16 v[72:75], a[168:171], v[152:155], v[72:75]
v_accvgpr_read_b32 v242, a102
v_accvgpr_read_b32 v243, a103
v_mfma_f32_16x16x32_bf16 v[76:79], a[172:175], v[152:155], v[76:79]
v_add_f32 v204, v204, v208
v_add_f32 v205, v205, v209
v_mfma_f32_16x16x32_bf16 v[80:83], a[176:179], v[152:155], v[80:83]
s_mov_b32 s34, 786432
v_add_f32 v206, v206, v210
v_add_f32 v207, v207, v211
v_mfma_f32_16x16x32_bf16 v[84:87], a[180:183], v[152:155], v[84:87]
v_add_f32 v240, v240, v212
v_add_f32 v241, v241, v213
v_mfma_f32_16x16x32_bf16 v[88:91], a[184:187], v[152:155], v[88:91]
buffer_load_dwordx4 v[152:155], v9, s[20:23], s34 offen sc1
v_mfma_f32_16x16x32_bf16 v[92:95], a[168:171], v[156:159], v[92:95]
v_add_f32 v242, v242, v214
v_add_f32 v243, v243, v215
v_mfma_f32_16x16x32_bf16 v[96:99], a[172:175], v[156:159], v[96:99]
v_add_f32 v204, v204, v240
v_add_f32 v205, v205, v241
v_mfma_f32_16x16x32_bf16 v[100:103], a[176:179], v[156:159], v[100:103]
s_mov_b32 s34, 786432
v_add_f32 v206, v206, v242
v_add_f32 v207, v207, v243
v_mfma_f32_16x16x32_bf16 v[104:107], a[180:183], v[156:159], v[104:107]
buffer_store_dwordx4 v[204:207], v30, s[68:71], s76 offen offset:1024 sc1
v_mfma_f32_16x16x32_bf16 v[108:111], a[184:187], v[156:159], v[108:111]
s_waitcnt vmcnt(13)
buffer_load_dwordx4 v[156:159], v10, s[20:23], s34 offen sc1
v_mfma_f32_16x16x32_bf16 v[32:35], a[188:191], v[160:163], v[32:35]
ds_read_b128 v[204:207], v231 offset:16384
v_mfma_f32_16x16x32_bf16 v[36:39], a[192:195], v[160:163], v[36:39]
ds_read_b128 v[208:211], v229 offset:1024
v_mfma_f32_16x16x32_bf16 v[40:43], a[196:199], v[160:163], v[40:43]
s_mov_b32 s34, 917504
ds_read_b128 v[212:215], v230 offset:6144
v_mfma_f32_16x16x32_bf16 v[44:47], a[200:203], v[160:163], v[44:47]
v_accvgpr_read_b32 v240, a104
v_accvgpr_read_b32 v241, a105
v_mfma_f32_16x16x32_bf16 v[48:51], a[204:207], v[160:163], v[48:51]
buffer_load_dwordx4 v[160:163], v7, s[20:23], s34 offen sc1
v_mfma_f32_16x16x32_bf16 v[52:55], a[188:191], v[164:167], v[52:55]
v_accvgpr_read_b32 v242, a106
v_accvgpr_read_b32 v243, a107
v_mfma_f32_16x16x32_bf16 v[56:59], a[192:195], v[164:167], v[56:59]
s_waitcnt lgkmcnt(2)
v_add_f32 v216, v216, v220
v_add_f32 v217, v217, v221
v_mfma_f32_16x16x32_bf16 v[60:63], a[196:199], v[164:167], v[60:63]
s_mov_b32 s34, 917504
v_add_f32 v218, v218, v222
v_add_f32 v219, v219, v223
v_mfma_f32_16x16x32_bf16 v[64:67], a[200:203], v[164:167], v[64:67]
v_add_f32 v240, v240, v224
v_add_f32 v241, v241, v225
v_mfma_f32_16x16x32_bf16 v[68:71], a[204:207], v[164:167], v[68:71]
buffer_load_dwordx4 v[164:167], v8, s[20:23], s34 offen sc1
v_mfma_f32_16x16x32_bf16 v[72:75], a[188:191], v[168:171], v[72:75]
v_add_f32 v242, v242, v226
v_add_f32 v243, v243, v227
v_mfma_f32_16x16x32_bf16 v[76:79], a[192:195], v[168:171], v[76:79]
v_add_f32 v216, v216, v240
v_add_f32 v217, v217, v241
v_mfma_f32_16x16x32_bf16 v[80:83], a[196:199], v[168:171], v[80:83]
s_mov_b32 s34, 917504
v_add_f32 v218, v218, v242
v_add_f32 v219, v219, v243
v_mfma_f32_16x16x32_bf16 v[84:87], a[200:203], v[168:171], v[84:87]
buffer_store_dwordx4 v[216:219], v30, s[68:71], s76 offen offset:2048 sc1
v_mfma_f32_16x16x32_bf16 v[88:91], a[204:207], v[168:171], v[88:91]
buffer_load_dwordx4 v[168:171], v9, s[20:23], s34 offen sc1
v_mfma_f32_16x16x32_bf16 v[92:95], a[188:191], v[172:175], v[92:95]
v_accvgpr_read_b32 v240, a108
v_accvgpr_read_b32 v241, a109
v_mfma_f32_16x16x32_bf16 v[96:99], a[192:195], v[172:175], v[96:99]
v_accvgpr_read_b32 v242, a110
v_accvgpr_read_b32 v243, a111
v_mfma_f32_16x16x32_bf16 v[100:103], a[196:199], v[172:175], v[100:103]
s_mov_b32 s34, 917504
v_add_f32 v192, v192, v196
v_add_f32 v193, v193, v197
v_mfma_f32_16x16x32_bf16 v[104:107], a[200:203], v[172:175], v[104:107]
v_add_f32 v194, v194, v198
v_add_f32 v195, v195, v199
v_mfma_f32_16x16x32_bf16 v[108:111], a[204:207], v[172:175], v[108:111]
s_waitcnt vmcnt(17)
buffer_load_dwordx4 v[172:175], v10, s[20:23], s34 offen sc1
v_mfma_f32_16x16x32_bf16 v[32:35], a[208:211], v[112:115], v[32:35]
v_add_f32 v240, v240, v200
v_add_f32 v241, v241, v201
v_mfma_f32_16x16x32_bf16 v[36:39], a[212:215], v[112:115], v[36:39]
v_add_f32 v242, v242, v202
v_add_f32 v243, v243, v203
v_mfma_f32_16x16x32_bf16 v[40:43], a[216:219], v[112:115], v[40:43]
s_mov_b32 s34, 1048576
v_add_f32 v192, v192, v240
v_add_f32 v193, v193, v241
v_mfma_f32_16x16x32_bf16 v[44:47], a[220:223], v[112:115], v[44:47]
v_add_f32 v194, v194, v242
v_add_f32 v195, v195, v243
v_mfma_f32_16x16x32_bf16 v[48:51], a[224:227], v[112:115], v[48:51]
s_waitcnt vmcnt(17)
buffer_load_dwordx4 v[112:115], v7, s[20:23], s34 offen sc1
v_mfma_f32_16x16x32_bf16 v[52:55], a[208:211], v[116:119], v[52:55]
buffer_store_dwordx4 v[192:195], v30, s[68:71], s76 offen offset:3072 sc1
v_mfma_f32_16x16x32_bf16 v[56:59], a[212:215], v[116:119], v[56:59]
v_accvgpr_read_b32 v240, a112
v_accvgpr_read_b32 v241, a113
v_mfma_f32_16x16x32_bf16 v[60:63], a[216:219], v[116:119], v[60:63]
s_mov_b32 s34, 1048576
v_accvgpr_read_b32 v242, a114
v_accvgpr_read_b32 v243, a115
v_mfma_f32_16x16x32_bf16 v[64:67], a[220:223], v[116:119], v[64:67]
s_waitcnt lgkmcnt(0)
v_add_f32 v204, v204, v208
v_add_f32 v205, v205, v209
v_mfma_f32_16x16x32_bf16 v[68:71], a[224:227], v[116:119], v[68:71]
s_waitcnt vmcnt(18)
buffer_load_dwordx4 v[116:119], v8, s[20:23], s34 offen sc1
v_mfma_f32_16x16x32_bf16 v[72:75], a[208:211], v[120:123], v[72:75]
v_add_f32 v206, v206, v210
v_add_f32 v207, v207, v211
v_mfma_f32_16x16x32_bf16 v[76:79], a[212:215], v[120:123], v[76:79]
v_add_f32 v240, v240, v212
v_add_f32 v241, v241, v213
v_mfma_f32_16x16x32_bf16 v[80:83], a[216:219], v[120:123], v[80:83]
s_mov_b32 s34, 1048576
v_add_f32 v242, v242, v214
v_add_f32 v243, v243, v215
v_mfma_f32_16x16x32_bf16 v[84:87], a[220:223], v[120:123], v[84:87]
v_add_f32 v204, v204, v240
v_add_f32 v205, v205, v241
v_mfma_f32_16x16x32_bf16 v[88:91], a[224:227], v[120:123], v[88:91]
s_waitcnt vmcnt(18)
buffer_load_dwordx4 v[120:123], v9, s[20:23], s34 offen sc1
v_mfma_f32_16x16x32_bf16 v[92:95], a[208:211], v[124:127], v[92:95]
v_add_f32 v206, v206, v242
v_add_f32 v207, v207, v243
v_mfma_f32_16x16x32_bf16 v[96:99], a[212:215], v[124:127], v[96:99]
buffer_store_dwordx4 v[204:207], v30, s[68:71], s31 offen offset:0 sc1
v_mfma_f32_16x16x32_bf16 v[100:103], a[216:219], v[124:127], v[100:103]
s_mov_b32 s34, 1048576
v_mfma_f32_16x16x32_bf16 v[104:107], a[220:223], v[124:127], v[104:107]
v_mfma_f32_16x16x32_bf16 v[108:111], a[224:227], v[124:127], v[108:111]
s_waitcnt vmcnt(19)
buffer_load_dwordx4 v[124:127], v10, s[20:23], s34 offen sc1
s_cmp_lt_u32 s75, 16
s_cbranch_scc0 OC3
s_waitcnt vmcnt(41)
v_mov_b32 v244, s47
v_mul_f32 v244, s100, v244
v_exp_f32 v244, v244
v_cmp_eq_u32 vcc, s46, v11
v_add_f32 v244, 1.0, v244
v_rcp_f32 v244, v244
s_nop 0
v_cvt_pk_bf16_f32 v244, v244, v244
v_lshlrev_b32 v244, 16, v244
v_add_f32_dpp v176, v176, v176 row_ror:8 row_mask:0xf bank_mask:0xf
v_add_f32_dpp v177, v177, v177 row_ror:8 row_mask:0xf bank_mask:0xf
v_add_f32_dpp v178, v178, v178 row_ror:8 row_mask:0xf bank_mask:0xf
v_add_f32_dpp v179, v179, v179 row_ror:8 row_mask:0xf bank_mask:0xf
v_add_f32_dpp v180, v180, v180 row_ror:8 row_mask:0xf bank_mask:0xf
v_add_f32_dpp v181, v181, v181 row_ror:8 row_mask:0xf bank_mask:0xf
v_add_f32_dpp v182, v182, v182 row_ror:8 row_mask:0xf bank_mask:0xf
v_add_f32_dpp v183, v183, v183 row_ror:8 row_mask:0xf bank_mask:0xf
v_add_f32_dpp v184, v184, v184 row_ror:8 row_mask:0xf bank_mask:0xf
v_add_f32_dpp v185, v185, v185 row_ror:8 row_mask:0xf bank_mask:0xf
v_add_f32_dpp v186, v186, v186 row_ror:8 row_mask:0xf bank_mask:0xf
v_add_f32_dpp v187, v187, v187 row_ror:8 row_mask:0xf bank_mask:0xf
v_add_f32_dpp v188, v188, v188 row_ror:8 row_mask:0xf bank_mask:0xf
v_add_f32_dpp v189, v189, v189 row_ror:8 row_mask:0xf bank_mask:0xf
v_add_f32_dpp v190, v190, v190 row_ror:8 row_mask:0xf bank_mask:0xf
v_add_f32_dpp v191, v191, v191 row_ror:8 row_mask:0xf bank_mask:0xf
v_add_f32_dpp v248, v248, v248 row_ror:8 row_mask:0xf bank_mask:0xf
v_add_f32_dpp v249, v249, v249 row_ror:8 row_mask:0xf bank_mask:0xf
v_add_f32_dpp v250, v250, v250 row_ror:8 row_mask:0xf bank_mask:0xf
v_add_f32_dpp v251, v251, v251 row_ror:8 row_mask:0xf bank_mask:0xf
v_add_f32_dpp v176, v176, v176 row_ror:4 row_mask:0xf bank_mask:0xf
v_add_f32_dpp v177, v177, v177 row_ror:4 row_mask:0xf bank_mask:0xf
v_add_f32_dpp v178, v178, v178 row_ror:4 row_mask:0xf bank_mask:0xf
v_add_f32_dpp v179, v179, v179 row_ror:4 row_mask:0xf bank_mask:0xf
v_add_f32_dpp v180, v180, v180 row_ror:4 row_mask:0xf bank_mask:0xf
v_add_f32_dpp v181, v181, v181 row_ror:4 row_mask:0xf bank_mask:0xf
v_add_f32_dpp v182, v182, v182 row_ror:4 row_mask:0xf bank_mask:0xf
v_add_f32_dpp v183, v183, v183 row_ror:4 row_mask:0xf bank_mask:0xf
v_add_f32_dpp v184, v184, v184 row_ror:4 row_mask:0xf bank_mask:0xf
v_add_f32_dpp v185, v185, v185 row_ror:4 row_mask:0xf bank_mask:0xf
v_add_f32_dpp v186, v186, v186 row_ror:4 row_mask:0xf bank_mask:0xf
v_add_f32_dpp v187, v187, v187 row_ror:4 row_mask:0xf bank_mask:0xf
v_add_f32_dpp v188, v188, v188 row_ror:4 row_mask:0xf bank_mask:0xf
v_add_f32_dpp v189, v189, v189 row_ror:4 row_mask:0xf bank_mask:0xf
v_add_f32_dpp v190, v190, v190 row_ror:4 row_mask:0xf bank_mask:0xf
v_add_f32_dpp v191, v191, v191 row_ror:4 row_mask:0xf bank_mask:0xf
v_add_f32_dpp v248, v248, v248 row_ror:4 row_mask:0xf bank_mask:0xf
v_add_f32_dpp v249, v249, v249 row_ror:4 row_mask:0xf bank_mask:0xf
v_add_f32_dpp v250, v250, v250 row_ror:4 row_mask:0xf bank_mask:0xf
v_add_f32_dpp v251, v251, v251 row_ror:4 row_mask:0xf bank_mask:0xf
v_add_f32_dpp v176, v176, v176 row_ror:2 row_mask:0xf bank_mask:0xf
v_add_f32_dpp v177, v177, v177 row_ror:2 row_mask:0xf bank_mask:0xf
v_add_f32_dpp v178, v178, v178 row_ror:2 row_mask:0xf bank_mask:0xf
v_add_f32_dpp v179, v179, v179 row_ror:2 row_mask:0xf bank_mask:0xf
v_add_f32_dpp v180, v180, v180 row_ror:2 row_mask:0xf bank_mask:0xf
v_add_f32_dpp v181, v181, v181 row_ror:2 row_mask:0xf bank_mask:0xf
v_add_f32_dpp v182, v182, v182 row_ror:2 row_mask:0xf bank_mask:0xf
v_add_f32_dpp v183, v183, v183 row_ror:2 row_mask:0xf bank_mask:0xf
v_add_f32_dpp v184, v184, v184 row_ror:2 row_mask:0xf bank_mask:0xf
v_add_f32_dpp v185, v185, v185 row_ror:2 row_mask:0xf bank_mask:0xf
v_add_f32_dpp v186, v186, v186 row_ror:2 row_mask:0xf bank_mask:0xf
v_add_f32_dpp v187, v187, v187 row_ror:2 row_mask:0xf bank_mask:0xf
v_add_f32_dpp v188, v188, v188 row_ror:2 row_mask:0xf bank_mask:0xf
v_add_f32_dpp v189, v189, v189 row_ror:2 row_mask:0xf bank_mask:0xf
v_add_f32_dpp v190, v190, v190 row_ror:2 row_mask:0xf bank_mask:0xf
v_add_f32_dpp v191, v191, v191 row_ror:2 row_mask:0xf bank_mask:0xf
v_add_f32_dpp v248, v248, v248 row_ror:2 row_mask:0xf bank_mask:0xf
v_add_f32_dpp v249, v249, v249 row_ror:2 row_mask:0xf bank_mask:0xf
v_add_f32_dpp v250, v250, v250 row_ror:2 row_mask:0xf bank_mask:0xf
v_add_f32_dpp v251, v251, v251 row_ror:2 row_mask:0xf bank_mask:0xf
v_add_f32_dpp v176, v176, v176 row_ror:1 row_mask:0xf bank_mask:0xf
v_add_f32_dpp v177, v177, v177 row_ror:1 row_mask:0xf bank_mask:0xf
v_add_f32_dpp v178, v178, v178 row_ror:1 row_mask:0xf bank_mask:0xf
v_add_f32_dpp v179, v179, v179 row_ror:1 row_mask:0xf bank_mask:0xf
v_add_f32_dpp v180, v180, v180 row_ror:1 row_mask:0xf bank_mask:0xf
v_add_f32_dpp v181, v181, v181 row_ror:1 row_mask:0xf bank_mask:0xf
v_add_f32_dpp v182, v182, v182 row_ror:1 row_mask:0xf bank_mask:0xf
v_add_f32_dpp v183, v183, v183 row_ror:1 row_mask:0xf bank_mask:0xf
v_add_f32_dpp v184, v184, v184 row_ror:1 row_mask:0xf bank_mask:0xf
v_add_f32_dpp v185, v185, v185 row_ror:1 row_mask:0xf bank_mask:0xf
v_add_f32_dpp v186, v186, v186 row_ror:1 row_mask:0xf bank_mask:0xf
v_add_f32_dpp v187, v187, v187 row_ror:1 row_mask:0xf bank_mask:0xf
v_add_f32_dpp v188, v188, v188 row_ror:1 row_mask:0xf bank_mask:0xf
v_add_f32_dpp v189, v189, v189 row_ror:1 row_mask:0xf bank_mask:0xf
v_add_f32_dpp v190, v190, v190 row_ror:1 row_mask:0xf bank_mask:0xf
v_add_f32_dpp v191, v191, v191 row_ror:1 row_mask:0xf bank_mask:0xf
v_add_f32_dpp v248, v248, v248 row_ror:1 row_mask:0xf bank_mask:0xf
v_add_f32_dpp v249, v249, v249 row_ror:1 row_mask:0xf bank_mask:0xf
v_add_f32_dpp v250, v250, v250 row_ror:1 row_mask:0xf bank_mask:0xf
v_add_f32_dpp v251, v251, v251 row_ror:1 row_mask:0xf bank_mask:0xf
v_cvt_pk_bf16_f32 v176, v176, v177
v_and_b32 v177, s101, v176
v_lshlrev_b32 v176, 16, v176
v_cvt_pk_bf16_f32 v178, v178, v179
v_and_b32 v179, s101, v178
v_lshlrev_b32 v178, 16, v178
v_cvt_pk_bf16_f32 v180, v180, v181
v_and_b32 v181, s101, v180
v_lshlrev_b32 v180, 16, v180
v_cvt_pk_bf16_f32 v182, v182, v183
v_and_b32 v183, s101, v182
v_lshlrev_b32 v182, 16, v182
v_cvt_pk_bf16_f32 v184, v184, v185
v_and_b32 v185, s101, v184
v_lshlrev_b32 v184, 16, v184
v_cvt_pk_bf16_f32 v186, v186, v187
v_and_b32 v187, s101, v186
v_lshlrev_b32 v186, 16, v186
v_cvt_pk_bf16_f32 v188, v188, v189
v_and_b32 v189, s101, v188
v_lshlrev_b32 v188, 16, v188
v_cvt_pk_bf16_f32 v190, v190, v191
v_and_b32 v191, s101, v190
v_lshlrev_b32 v190, 16, v190
v_cvt_pk_bf16_f32 v248, v248, v249
v_and_b32 v249, s101, v248
v_lshlrev_b32 v248, 16, v248
v_cvt_pk_bf16_f32 v250, v250, v251
v_and_b32 v251, s101, v250
v_lshlrev_b32 v250, 16, v250
v_mul_f32 v176, v176, v244
v_mul_f32 v177, v177, v244
v_mul_f32 v178, v178, v244
v_mul_f32 v179, v179, v244
v_mul_f32 v180, v180, v244
v_mul_f32 v181, v181, v244
v_mul_f32 v182, v182, v244
v_mul_f32 v183, v183, v244
v_mul_f32 v184, v184, v244
v_mul_f32 v185, v185, v244
v_mul_f32 v186, v186, v244
v_mul_f32 v187, v187, v244
v_mul_f32 v188, v188, v244
v_mul_f32 v189, v189, v244
v_mul_f32 v190, v190, v244
v_mul_f32 v191, v191, v244
v_mul_f32 v248, v248, v244
v_mul_f32 v249, v249, v244
v_mul_f32 v250, v250, v244
v_mul_f32 v251, v251, v244
v_cvt_pk_bf16_f32 v176, v176, v177
v_and_b32 v177, s101, v176
v_lshlrev_b32 v176, 16, v176
v_cvt_pk_bf16_f32 v178, v178, v179
v_and_b32 v179, s101, v178
v_lshlrev_b32 v178, 16, v178
v_cvt_pk_bf16_f32 v180, v180, v181
v_and_b32 v181, s101, v180
v_lshlrev_b32 v180, 16, v180
v_cvt_pk_bf16_f32 v182, v182, v183
v_and_b32 v183, s101, v182
v_lshlrev_b32 v182, 16, v182
v_cvt_pk_bf16_f32 v184, v184, v185
v_and_b32 v185, s101, v184
v_lshlrev_b32 v184, 16, v184
v_cvt_pk_bf16_f32 v186, v186, v187
v_and_b32 v187, s101, v186
v_lshlrev_b32 v186, 16, v186
v_cvt_pk_bf16_f32 v188, v188, v189
v_and_b32 v189, s101, v188
v_lshlrev_b32 v188, 16, v188
v_cvt_pk_bf16_f32 v190, v190, v191
v_and_b32 v191, s101, v190
v_lshlrev_b32 v190, 16, v190
v_cvt_pk_bf16_f32 v248, v248, v249
v_and_b32 v249, s101, v248
v_lshlrev_b32 v248, 16, v248
v_cvt_pk_bf16_f32 v250, v250, v251
v_and_b32 v251, s101, v250
v_lshlrev_b32 v250, 16, v250
v_cndmask_b32 v176, 0, v176, vcc
v_cndmask_b32 v177, 0, v177, vcc
v_cndmask_b32 v178, 0, v178, vcc
v_cndmask_b32 v179, 0, v179, vcc
v_cndmask_b32 v180, 0, v180, vcc
v_cndmask_b32 v181, 0, v181, vcc
v_cndmask_b32 v182, 0, v182, vcc
v_cndmask_b32 v183, 0, v183, vcc
v_cndmask_b32 v184, 0, v184, vcc
v_cndmask_b32 v185, 0, v185, vcc
v_cndmask_b32 v186, 0, v186, vcc
v_cndmask_b32 v187, 0, v187, vcc
v_cndmask_b32 v188, 0, v188, vcc
v_cndmask_b32 v189, 0, v189, vcc
v_cndmask_b32 v190, 0, v190, vcc
v_cndmask_b32 v191, 0, v191, vcc
v_cndmask_b32 v248, 0, v248, vcc
v_cndmask_b32 v249, 0, v249, vcc
v_cndmask_b32 v250, 0, v250, vcc
v_cndmask_b32 v251, 0, v251, vcc
OC3:
v_mfma_f32_16x16x32_bf16 v[32:35], a[228:231], v[128:131], v[32:35]
v_lshlrev_b32 v240, 16, v232
v_and_b32 v241, s101, v232
v_mfma_f32_16x16x32_bf16 v[36:39], a[232:235], v[128:131], v[36:39]
v_add_f32 v176, v176, v240
v_add_f32 v177, v177, v241
v_mfma_f32_16x16x32_bf16 v[40:43], a[236:239], v[128:131], v[40:43]
s_mov_b32 s34, 1179648
v_lshlrev_b32 v240, 16, v233
v_and_b32 v241, s101, v233
v_mfma_f32_16x16x32_bf16 v[44:47], a[240:243], v[128:131], v[44:47]
v_add_f32 v178, v178, v240
v_add_f32 v179, v179, v241
v_mfma_f32_16x16x32_bf16 v[48:51], a[244:247], v[128:131], v[48:51]
s_waitcnt vmcnt(19)
buffer_load_dwordx4 v[128:131], v7, s[20:23], s34 offen sc1
v_mfma_f32_16x16x32_bf16 v[52:55], a[228:231], v[132:135], v[52:55]
v_lshlrev_b32 v240, 16, v234
v_and_b32 v241, s101, v234
v_mfma_f32_16x16x32_bf16 v[56:59], a[232:235], v[132:135], v[56:59]
v_add_f32 v180, v180, v240
v_add_f32 v181, v181, v241
v_mfma_f32_16x16x32_bf16 v[60:63], a[236:239], v[132:135], v[60:63]
s_mov_b32 s34, 1179648
v_lshlrev_b32 v240, 16, v235
v_and_b32 v241, s101, v235
v_mfma_f32_16x16x32_bf16 v[64:67], a[240:243], v[132:135], v[64:67]
v_add_f32 v182, v182, v240
v_add_f32 v183, v183, v241
v_mfma_f32_16x16x32_bf16 v[68:71], a[244:247], v[132:135], v[68:71]
s_waitcnt vmcnt(19)
buffer_load_dwordx4 v[132:135], v8, s[20:23], s34 offen sc1
v_mfma_f32_16x16x32_bf16 v[72:75], a[228:231], v[136:139], v[72:75]
v_lshlrev_b32 v240, 16, v252
v_and_b32 v241, s101, v252
v_mfma_f32_16x16x32_bf16 v[76:79], a[232:235], v[136:139], v[76:79]
v_add_f32 v184, v184, v240
v_add_f32 v185, v185, v241
v_mfma_f32_16x16x32_bf16 v[80:83], a[236:239], v[136:139], v[80:83]
s_mov_b32 s34, 1179648
v_lshlrev_b32 v240, 16, v253
v_and_b32 v241, s101, v253
v_mfma_f32_16x16x32_bf16 v[84:87], a[240:243], v[136:139], v[84:87]
v_add_f32 v186, v186, v240
v_add_f32 v187, v187, v241
v_mfma_f32_16x16x32_bf16 v[88:91], a[244:247], v[136:139], v[88:91]
s_waitcnt vmcnt(19)
buffer_load_dwordx4 v[136:139], v9, s[20:23], s34 offen sc1
v_mfma_f32_16x16x32_bf16 v[92:95], a[228:231], v[140:143], v[92:95]
v_lshlrev_b32 v240, 16, v254
v_and_b32 v241, s101, v254
v_mfma_f32_16x16x32_bf16 v[96:99], a[232:235], v[140:143], v[96:99]
v_add_f32 v188, v188, v240
v_add_f32 v189, v189, v241
v_mfma_f32_16x16x32_bf16 v[100:103], a[236:239], v[140:143], v[100:103]
s_mov_b32 s34, 1179648
v_lshlrev_b32 v240, 16, v255
v_and_b32 v241, s101, v255
v_mfma_f32_16x16x32_bf16 v[104:107], a[240:243], v[140:143], v[104:107]
v_add_f32 v190, v190, v240
v_add_f32 v191, v191, v241
v_mfma_f32_16x16x32_bf16 v[108:111], a[244:247], v[140:143], v[108:111]
s_waitcnt vmcnt(18)
buffer_load_dwordx4 v[140:143], v10, s[20:23], s34 offen sc1
v_mfma_f32_16x16x32_bf16 v[32:35], a[248:251], v[144:147], v[32:35]
v_lshlrev_b32 v240, 16, v236
v_and_b32 v241, s101, v236
v_mfma_f32_16x16x32_bf16 v[36:39], a[252:255], v[144:147], v[36:39]
v_add_f32 v248, v248, v240
v_add_f32 v249, v249, v241
v_mfma_f32_16x16x32_bf16 v[40:43], a[0:3], v[144:147], v[40:43]
s_mov_b32 s34, 1310720
v_lshlrev_b32 v240, 16, v237
v_and_b32 v241, s101, v237
v_mfma_f32_16x16x32_bf16 v[44:47], a[4:7], v[144:147], v[44:47]
v_add_f32 v250, v250, v240
v_add_f32 v251, v251, v241
v_mfma_f32_16x16x32_bf16 v[48:51], a[8:11], v[144:147], v[48:51]
s_waitcnt vmcnt(18)
buffer_load_dwordx4 v[144:147], v7, s[20:23], s34 offen sc1
v_mfma_f32_16x16x32_bf16 v[52:55], a[248:251], v[148:151], v[52:55]
ds_read_b128 v[216:219], v1 offset:0
v_cvt_pk_bf16_f32 v176, v176, v177
v_mfma_f32_16x16x32_bf16 v[56:59], a[252:255], v[148:151], v[56:59]
v_and_b32 v177, s101, v176
v_lshlrev_b32 v176, 16, v176
v_mfma_f32_16x16x32_bf16 v[60:63], a[0:3], v[148:151], v[60:63]
s_mov_b32 s34, 1310720
ds_read_b128 v[220:223], v1 offset:1024
v_cvt_pk_bf16_f32 v178, v178, v179
v_mfma_f32_16x16x32_bf16 v[64:67], a[4:7], v[148:151], v[64:67]
v_and_b32 v179, s101, v178
v_lshlrev_b32 v178, 16, v178
v_mfma_f32_16x16x32_bf16 v[68:71], a[8:11], v[148:151], v[68:71]
s_waitcnt vmcnt(18)
buffer_load_dwordx4 v[148:151], v8, s[20:23], s34 offen sc1
v_mfma_f32_16x16x32_bf16 v[72:75], a[248:251], v[152:155], v[72:75]
ds_read_b128 v[224:227], v1 offset:2048
v_cvt_pk_bf16_f32 v180, v180, v181
v_mfma_f32_16x16x32_bf16 v[76:79], a[252:255], v[152:155], v[76:79]
v_and_b32 v181, s101, v180
v_lshlrev_b32 v180, 16, v180
v_mfma_f32_16x16x32_bf16 v[80:83], a[0:3], v[152:155], v[80:83]
s_mov_b32 s34, 1310720
v_cvt_pk_bf16_f32 v182, v182, v183
v_and_b32 v183, s101, v182
v_mfma_f32_16x16x32_bf16 v[84:87], a[4:7], v[152:155], v[84:87]
ds_read_b128 v[228:231], v1 offset:3072
v_lshlrev_b32 v182, 16, v182
v_mfma_f32_16x16x32_bf16 v[88:91], a[8:11], v[152:155], v[88:91]
s_waitcnt vmcnt(17)
buffer_load_dwordx4 v[152:155], v9, s[20:23], s34 offen sc1
v_mfma_f32_16x16x32_bf16 v[92:95], a[248:251], v[156:159], v[92:95]
v_cvt_pk_bf16_f32 v184, v184, v185
v_and_b32 v185, s101, v184
v_mfma_f32_16x16x32_bf16 v[96:99], a[252:255], v[156:159], v[96:99]
v_lshlrev_b32 v184, 16, v184
v_cvt_pk_bf16_f32 v186, v186, v187
v_mfma_f32_16x16x32_bf16 v[100:103], a[0:3], v[156:159], v[100:103]
s_mov_b32 s34, 1310720
v_and_b32 v187, s101, v186
v_lshlrev_b32 v186, 16, v186
v_mfma_f32_16x16x32_bf16 v[104:107], a[4:7], v[156:159], v[104:107]
v_cvt_pk_bf16_f32 v188, v188, v189
v_and_b32 v189, s101, v188
v_mfma_f32_16x16x32_bf16 v[108:111], a[8:11], v[156:159], v[108:111]
s_waitcnt vmcnt(17)
buffer_load_dwordx4 v[156:159], v10, s[20:23], s34 offen sc1
v_mfma_f32_16x16x32_bf16 v[32:35], a[12:15], v[160:163], v[32:35]
s_waitcnt lgkmcnt(0)
s_waitcnt vmcnt(9)
v_mov_b32 v246, s48
v_mov_b32 v245, 1
buffer_store_dword v245, v246, s[24:27], 0 offen sc1
v_mfma_f32_16x16x32_bf16 v[36:39], v[216:219], v[160:163], v[36:39]
ds_read_b128 v[192:195], v1 offset:16384
v_lshlrev_b32 v188, 16, v188
v_mfma_f32_16x16x32_bf16 v[40:43], v[220:223], v[160:163], v[40:43]
s_mov_b32 s34, 1441792
v_cvt_pk_bf16_f32 v190, v190, v191
v_and_b32 v191, s101, v190
v_mfma_f32_16x16x32_bf16 v[44:47], v[224:227], v[160:163], v[44:47]
v_lshlrev_b32 v190, 16, v190
v_cvt_pk_bf16_f32 v248, v248, v249
v_mfma_f32_16x16x32_bf16 v[48:51], v[228:231], v[160:163], v[48:51]
buffer_load_dwordx4 v[160:163], v7, s[20:23], s34 offen sc1
v_mfma_f32_16x16x32_bf16 v[52:55], a[12:15], v[164:167], v[52:55]
ds_read_b128 v[196:199], v1 offset:17408
v_and_b32 v249, s101, v248
v_mfma_f32_16x16x32_bf16 v[56:59], v[216:219], v[164:167], v[56:59]
v_lshlrev_b32 v248, 16, v248
v_cvt_pk_bf16_f32 v250, v250, v251
v_mfma_f32_16x16x32_bf16 v[60:63], v[220:223], v[164:167], v[60:63]
s_mov_b32 s34, 1441792
ds_read_b128 v[200:203], v1 offset:18432
v_and_b32 v251, s101, v250
v_mfma_f32_16x16x32_bf16 v[64:67], v[224:227], v[164:167], v[64:67]
v_lshlrev_b32 v250, 16, v250
v_mul_f32 v240, s100, v176
v_mfma_f32_16x16x32_bf16 v[68:71], v[228:231], v[164:167], v[68:71]
buffer_load_dwordx4 v[164:167], v8, s[20:23], s34 offen sc1
v_mfma_f32_16x16x32_bf16 v[72:75], a[12:15], v[168:171], v[72:75]
ds_read_b128 v[204:207], v1 offset:19456
v_mul_f32 v241, s100, v177
v_mfma_f32_16x16x32_bf16 v[76:79], v[216:219], v[168:171], v[76:79]
v_mul_f32 v242, s100, v178
v_mul_f32 v243, s100, v179
v_mfma_f32_16x16x32_bf16 v[80:83], v[220:223], v[168:171], v[80:83]
s_mov_b32 s34, 1441792
v_mul_f32 v244, s100, v180
v_exp_f32 v240, v240
v_mfma_f32_16x16x32_bf16 v[84:87], v[224:227], v[168:171], v[84:87]
ds_read_b128 v[208:211], v1 offset:32768
v_exp_f32 v241, v241
v_mfma_f32_16x16x32_bf16 v[88:91], v[228:231], v[168:171], v[88:91]
buffer_load_dwordx4 v[168:171], v9, s[20:23], s34 offen sc1
v_mfma_f32_16x16x32_bf16 v[92:95], a[12:15], v[172:175], v[92:95]
v_exp_f32 v242, v242
v_mfma_f32_16x16x32_bf16 v[96:99], v[216:219], v[172:175], v[96:99]
v_exp_f32 v243, v243
v_mfma_f32_16x16x32_bf16 v[100:103], v[220:223], v[172:175], v[100:103]
s_mov_b32 s34, 1441792
v_exp_f32 v244, v244
v_mfma_f32_16x16x32_bf16 v[104:107], v[224:227], v[172:175], v[104:107]
v_add_f32 v240, 1.0, v240
v_add_f32 v241, 1.0, v241
v_mfma_f32_16x16x32_bf16 v[108:111], v[228:231], v[172:175], v[108:111]
s_waitcnt lgkmcnt(0)
buffer_load_dwordx4 v[172:175], v10, s[20:23], s34 offen sc1
v_mfma_f32_16x16x32_bf16 v[32:35], v[192:195], v[112:115], v[32:35]
v_add_f32 v242, 1.0, v242
v_add_f32 v243, 1.0, v243
v_mfma_f32_16x16x32_bf16 v[36:39], v[196:199], v[112:115], v[36:39]
ds_read_b128 v[212:215], v1 offset:33792
v_add_f32 v244, 1.0, v244
v_mfma_f32_16x16x32_bf16 v[40:43], v[200:203], v[112:115], v[40:43]
s_mov_b32 s34, 1572864
v_rcp_f32 v240, v240
v_mfma_f32_16x16x32_bf16 v[44:47], v[204:207], v[112:115], v[44:47]
v_rcp_f32 v241, v241
v_mfma_f32_16x16x32_bf16 v[48:51], v[208:211], v[112:115], v[48:51]
buffer_load_dwordx4 v[112:115], v7, s[20:23], s34 offen sc1
v_mfma_f32_16x16x32_bf16 v[52:55], v[192:195], v[116:119], v[52:55]
ds_read_b128 v[216:219], v1 offset:34816
v_rcp_f32 v242, v242
v_mfma_f32_16x16x32_bf16 v[56:59], v[196:199], v[116:119], v[56:59]
v_rcp_f32 v243, v243
v_mfma_f32_16x16x32_bf16 v[60:63], v[200:203], v[116:119], v[60:63]
s_mov_b32 s34, 1572864
ds_read_b128 v[220:223], v1 offset:35840
v_rcp_f32 v244, v244
v_mfma_f32_16x16x32_bf16 v[64:67], v[204:207], v[116:119], v[64:67]
v_mul_f32 v176, v176, v240
v_mul_f32 v177, v177, v241
v_mfma_f32_16x16x32_bf16 v[68:71], v[208:211], v[116:119], v[68:71]
buffer_load_dwordx4 v[116:119], v8, s[20:23], s34 offen sc1
v_mfma_f32_16x16x32_bf16 v[72:75], v[192:195], v[120:123], v[72:75]
ds_read_b128 v[224:227], v1 offset:49152
v_mul_f32 v178, v178, v242
v_mfma_f32_16x16x32_bf16 v[76:79], v[196:199], v[120:123], v[76:79]
v_mul_f32 v179, v179, v243
v_mul_f32 v180, v180, v244
v_mfma_f32_16x16x32_bf16 v[80:83], v[200:203], v[120:123], v[80:83]
s_mov_b32 s34, 1572864
v_mul_f32 v240, s100, v181
v_mul_f32 v241, s100, v182
v_mfma_f32_16x16x32_bf16 v[84:87], v[204:207], v[120:123], v[84:87]
ds_read_b128 v[228:231], v1 offset:50176
v_mul_f32 v242, s100, v183
v_mfma_f32_16x16x32_bf16 v[88:91], v[208:211], v[120:123], v[88:91]
s_waitcnt vmcnt(15)
buffer_load_dwordx4 v[120:123], v9, s[20:23], s34 offen sc1
v_mfma_f32_16x16x32_bf16 v[92:95], v[192:195], v[124:127], v[92:95]
v_mul_f32 v243, s100, v184
v_mul_f32 v244, s100, v185
v_mfma_f32_16x16x32_bf16 v[96:99], v[196:199], v[124:127], v[96:99]
v_exp_f32 v240, v240
v_mfma_f32_16x16x32_bf16 v[100:103], v[200:203], v[124:127], v[100:103]
s_mov_b32 s34, 1572864
v_exp_f32 v241, v241
v_mfma_f32_16x16x32_bf16 v[104:107], v[204:207], v[124:127], v[104:107]
v_exp_f32 v242, v242
v_mfma_f32_16x16x32_bf16 v[108:111], v[208:211], v[124:127], v[108:111]
s_waitcnt lgkmcnt(0)
s_waitcnt vmcnt(15)
buffer_load_dwordx4 v[124:127], v10, s[20:23], s34 offen sc1
v_mfma_f32_16x16x32_bf16 v[32:35], v[212:215], v[128:131], v[32:35]
v_exp_f32 v243, v243
v_mfma_f32_16x16x32_bf16 v[36:39], v[216:219], v[128:131], v[36:39]
ds_read_b128 v[192:195], v1 offset:51200
v_exp_f32 v244, v244
v_mfma_f32_16x16x32_bf16 v[40:43], v[220:223], v[128:131], v[40:43]
s_mov_b32 s34, 1703936
v_add_f32 v240, 1.0, v240
v_add_f32 v241, 1.0, v241
v_mfma_f32_16x16x32_bf16 v[44:47], v[224:227], v[128:131], v[44:47]
v_add_f32 v242, 1.0, v242
v_add_f32 v243, 1.0, v243
v_mfma_f32_16x16x32_bf16 v[48:51], v[228:231], v[128:131], v[48:51]
s_waitcnt vmcnt(15)
buffer_load_dwordx4 v[128:131], v7, s[20:23], s34 offen sc1
v_mfma_f32_16x16x32_bf16 v[52:55], v[212:215], v[132:135], v[52:55]
ds_read_b128 v[196:199], v1 offset:52224
v_add_f32 v244, 1.0, v244
v_mfma_f32_16x16x32_bf16 v[56:59], v[216:219], v[132:135], v[56:59]
v_rcp_f32 v240, v240
v_mfma_f32_16x16x32_bf16 v[60:63], v[220:223], v[132:135], v[60:63]
s_mov_b32 s34, 1703936
ds_read_b128 v[200:203], v2 offset:0
v_rcp_f32 v241, v241
v_mfma_f32_16x16x32_bf16 v[64:67], v[224:227], v[132:135], v[64:67]
v_rcp_f32 v242, v242
v_mfma_f32_16x16x32_bf16 v[68:71], v[228:231], v[132:135], v[68:71]
s_waitcnt vmcnt(15)
buffer_load_dwordx4 v[132:135], v8, s[20:23], s34 offen sc1
v_mfma_f32_16x16x32_bf16 v[72:75], v[212:215], v[136:139], v[72:75]
ds_read_b128 v[204:207], v2 offset:1024
v_rcp_f32 v243, v243
v_mfma_f32_16x16x32_bf16 v[76:79], v[216:219], v[136:139], v[76:79]
v_rcp_f32 v244, v244
v_mfma_f32_16x16x32_bf16 v[80:83], v[220:223], v[136:139], v[80:83]
s_mov_b32 s34, 1703936
v_mul_f32 v181, v181, v240
v_mul_f32 v182, v182, v241
v_mfma_f32_16x16x32_bf16 v[84:87], v[224:227], v[136:139], v[84:87]
ds_read_b128 v[208:211], v2 offset:2048
v_mul_f32 v183, v183, v242
v_mfma_f32_16x16x32_bf16 v[88:91], v[228:231], v[136:139], v[88:91]
s_waitcnt vmcnt(15)
buffer_load_dwordx4 v[136:139], v9, s[20:23], s34 offen sc1
v_mfma_f32_16x16x32_bf16 v[92:95], v[212:215], v[140:143], v[92:95]
v_mul_f32 v184, v184, v243
v_mul_f32 v185, v185, v244
v_mfma_f32_16x16x32_bf16 v[96:99], v[216:219], v[140:143], v[96:99]
v_mul_f32 v240, s100, v186
v_mul_f32 v241, s100, v187
v_mfma_f32_16x16x32_bf16 v[100:103], v[220:223], v[140:143], v[100:103]
s_mov_b32 s34, 1703936
v_mul_f32 v242, s100, v188
v_mul_f32 v243, s100, v189
v_mfma_f32_16x16x32_bf16 v[104:107], v[224:227], v[140:143], v[104:107]
v_mul_f32 v244, s100, v190
v_exp_f32 v240, v240
v_mfma_f32_16x16x32_bf16 v[108:111], v[228:231], v[140:143], v[108:111]
s_waitcnt lgkmcnt(0)
s_waitcnt vmcnt(15)
buffer_load_dwordx4 v[140:143], v10, s[20:23], s34 offen sc1
v_mfma_f32_16x16x32_bf16 v[32:35], v[192:195], v[144:147], v[32:35]
v_exp_f32 v241, v241
v_mfma_f32_16x16x32_bf16 v[36:39], v[196:199], v[144:147], v[36:39]
ds_read_b128 v[212:215], v2 offset:3072
v_exp_f32 v242, v242
v_mfma_f32_16x16x32_bf16 v[40:43], v[200:203], v[144:147], v[40:43]
s_mov_b32 s34, 1835008
v_exp_f32 v243, v243
v_mfma_f32_16x16x32_bf16 v[44:47], v[204:207], v[144:147], v[44:47]
v_exp_f32 v244, v244
v_mfma_f32_16x16x32_bf16 v[48:51], v[208:211], v[144:147], v[48:51]
s_waitcnt vmcnt(15)
buffer_load_dwordx4 v[144:147], v7, s[20:23], s34 offen sc1
v_mfma_f32_16x16x32_bf16 v[52:55], v[192:195], v[148:151], v[52:55]
ds_read_b128 v[216:219], v2 offset:16384
v_add_f32 v240, 1.0, v240
v_mfma_f32_16x16x32_bf16 v[56:59], v[196:199], v[148:151], v[56:59]
v_add_f32 v241, 1.0, v241
v_add_f32 v242, 1.0, v242
v_mfma_f32_16x16x32_bf16 v[60:63], v[200:203], v[148:151], v[60:63]
s_mov_b32 s34, 1835008
ds_read_b128 v[220:223], v2 offset:17408
v_add_f32 v243, 1.0, v243
v_mfma_f32_16x16x32_bf16 v[64:67], v[204:207], v[148:151], v[64:67]
v_add_f32 v244, 1.0, v244
v_rcp_f32 v240, v240
v_mfma_f32_16x16x32_bf16 v[68:71], v[208:211], v[148:151], v[68:71]
s_waitcnt vmcnt(15)
buffer_load_dwordx4 v[148:151], v8, s[20:23], s34 offen sc1
v_mfma_f32_16x16x32_bf16 v[72:75], v[192:195], v[152:155], v[72:75]
ds_read_b128 v[224:227], v2 offset:18432
v_rcp_f32 v241, v241
v_mfma_f32_16x16x32_bf16 v[76:79], v[196:199], v[152:155], v[76:79]
v_rcp_f32 v242, v242
v_mfma_f32_16x16x32_bf16 v[80:83], v[200:203], v[152:155], v[80:83]
s_mov_b32 s34, 1835008
v_rcp_f32 v243, v243
v_mfma_f32_16x16x32_bf16 v[84:87], v[204:207], v[152:155], v[84:87]
ds_read_b128 v[228:231], v2 offset:19456
v_rcp_f32 v244, v244
v_mfma_f32_16x16x32_bf16 v[88:91], v[208:211], v[152:155], v[88:91]
s_waitcnt vmcnt(15)
buffer_load_dwordx4 v[152:155], v9, s[20:23], s34 offen sc1
v_mfma_f32_16x16x32_bf16 v[92:95], v[192:195], v[156:159], v[92:95]
v_mul_f32 v186, v186, v240
v_mul_f32 v187, v187, v241
v_mfma_f32_16x16x32_bf16 v[96:99], v[196:199], v[156:159], v[96:99]
v_mul_f32 v188, v188, v242
v_mul_f32 v189, v189, v243
v_mfma_f32_16x16x32_bf16 v[100:103], v[200:203], v[156:159], v[100:103]
s_mov_b32 s34, 1835008
v_mul_f32 v190, v190, v244
v_mul_f32 v240, s100, v191
v_mfma_f32_16x16x32_bf16 v[104:107], v[204:207], v[156:159], v[104:107]
v_mul_f32 v241, s100, v248
v_mul_f32 v242, s100, v249
v_mfma_f32_16x16x32_bf16 v[108:111], v[208:211], v[156:159], v[108:111]
s_waitcnt lgkmcnt(0)
s_waitcnt vmcnt(14)
buffer_load_dwordx4 v[156:159], v10, s[20:23], s34 offen sc1
v_mfma_f32_16x16x32_bf16 v[32:35], v[212:215], v[160:163], v[32:35]
buffer_load_dword v238, v247, s[24:27], 0 offen sc1
v_mfma_f32_16x16x32_bf16 v[36:39], v[216:219], v[160:163], v[36:39]
v_mul_f32 v243, s100, v250
v_mul_f32 v244, s100, v251
v_mfma_f32_16x16x32_bf16 v[40:43], v[220:223], v[160:163], v[40:43]
s_mov_b32 s34, 1966080
v_exp_f32 v240, v240
v_mfma_f32_16x16x32_bf16 v[44:47], v[224:227], v[160:163], v[44:47]
v_exp_f32 v241, v241
v_mfma_f32_16x16x32_bf16 v[48:51], v[228:231], v[160:163], v[48:51]
s_waitcnt vmcnt(15)
buffer_load_dwordx4 v[160:163], v7, s[20:23], s34 offen sc1
v_mfma_f32_16x16x32_bf16 v[52:55], v[212:215], v[164:167], v[52:55]
v_exp_f32 v242, v242
v_mfma_f32_16x16x32_bf16 v[56:59], v[216:219], v[164:167], v[56:59]
v_exp_f32 v243, v243
v_mfma_f32_16x16x32_bf16 v[60:63], v[220:223], v[164:167], v[60:63]
s_mov_b32 s34, 1966080
v_exp_f32 v244, v244
v_mfma_f32_16x16x32_bf16 v[64:67], v[224:227], v[164:167], v[64:67]
v_add_f32 v240, 1.0, v240
v_add_f32 v241, 1.0, v241
v_mfma_f32_16x16x32_bf16 v[68:71], v[228:231], v[164:167], v[68:71]
s_waitcnt vmcnt(15)
buffer_load_dwordx4 v[164:167], v8, s[20:23], s34 offen sc1
v_mfma_f32_16x16x32_bf16 v[72:75], v[212:215], v[168:171], v[72:75]
v_add_f32 v242, 1.0, v242
v_add_f32 v243, 1.0, v243
v_mfma_f32_16x16x32_bf16 v[76:79], v[216:219], v[168:171], v[76:79]
v_add_f32 v244, 1.0, v244
v_rcp_f32 v240, v240
v_mfma_f32_16x16x32_bf16 v[80:83], v[220:223], v[168:171], v[80:83]
s_mov_b32 s34, 1966080
v_rcp_f32 v241, v241
v_mfma_f32_16x16x32_bf16 v[84:87], v[224:227], v[168:171], v[84:87]
v_rcp_f32 v242, v242
v_mfma_f32_16x16x32_bf16 v[88:91], v[228:231], v[168:171], v[88:91]
s_waitcnt vmcnt(15)
buffer_load_dwordx4 v[168:171], v9, s[20:23], s34 offen sc1
v_mfma_f32_16x16x32_bf16 v[92:95], v[212:215], v[172:175], v[92:95]
v_rcp_f32 v243, v243
v_mfma_f32_16x16x32_bf16 v[96:99], v[216:219], v[172:175], v[96:99]
v_rcp_f32 v244, v244
v_mfma_f32_16x16x32_bf16 v[100:103], v[220:223], v[172:175], v[100:103]
s_mov_b32 s34, 1966080
v_mul_f32 v191, v191, v240
v_mul_f32 v248, v248, v241
v_mfma_f32_16x16x32_bf16 v[104:107], v[224:227], v[172:175], v[104:107]
v_mul_f32 v249, v249, v242
v_mul_f32 v250, v250, v243
v_mfma_f32_16x16x32_bf16 v[108:111], v[228:231], v[172:175], v[108:111]
s_waitcnt vmcnt(15)
buffer_load_dwordx4 v[172:175], v10, s[20:23], s34 offen sc1
v_mfma_f32_16x16x32_bf16 v[32:35], a[16:19], v[112:115], v[32:35]
v_mul_f32 v251, v251, v244
v_cvt_pk_bf16_f32 v176, v176, v177
v_mfma_f32_16x16x32_bf16 v[36:39], a[20:23], v[112:115], v[36:39]
v_and_b32 v177, s101, v176
v_lshlrev_b32 v176, 16, v176
v_mfma_f32_16x16x32_bf16 v[40:43], a[24:27], v[112:115], v[40:43]
v_cvt_pk_bf16_f32 v178, v178, v179
v_and_b32 v179, s101, v178
v_mfma_f32_16x16x32_bf16 v[44:47], a[28:31], v[112:115], v[44:47]
v_lshlrev_b32 v178, 16, v178
v_cvt_pk_bf16_f32 v180, v180, v181
v_mfma_f32_16x16x32_bf16 v[48:51], a[32:35], v[112:115], v[48:51]
s_waitcnt vmcnt(15)
v_and_b32 v181, s101, v180
v_lshlrev_b32 v180, 16, v180
v_mfma_f32_16x16x32_bf16 v[52:55], a[16:19], v[116:119], v[52:55]
v_cvt_pk_bf16_f32 v182, v182, v183
v_and_b32 v183, s101, v182
v_mfma_f32_16x16x32_bf16 v[56:59], a[20:23], v[116:119], v[56:59]
v_lshlrev_b32 v182, 16, v182
v_cvt_pk_bf16_f32 v184, v184, v185
v_mfma_f32_16x16x32_bf16 v[60:63], a[24:27], v[116:119], v[60:63]
v_and_b32 v185, s101, v184
v_lshlrev_b32 v184, 16, v184
v_mfma_f32_16x16x32_bf16 v[64:67], a[28:31], v[116:119], v[64:67]
v_cvt_pk_bf16_f32 v186, v186, v187
v_and_b32 v187, s101, v186
v_mfma_f32_16x16x32_bf16 v[68:71], a[32:35], v[116:119], v[68:71]
s_waitcnt vmcnt(14)
v_lshlrev_b32 v186, 16, v186
v_cvt_pk_bf16_f32 v188, v188, v189
v_mfma_f32_16x16x32_bf16 v[72:75], a[16:19], v[120:123], v[72:75]
v_and_b32 v189, s101, v188
v_lshlrev_b32 v188, 16, v188
v_mfma_f32_16x16x32_bf16 v[76:79], a[20:23], v[120:123], v[76:79]
v_cvt_pk_bf16_f32 v190, v190, v191
v_and_b32 v191, s101, v190
v_mfma_f32_16x16x32_bf16 v[80:83], a[24:27], v[120:123], v[80:83]
v_lshlrev_b32 v190, 16, v190
v_cvt_pk_bf16_f32 v248, v248, v249
v_mfma_f32_16x16x32_bf16 v[84:87], a[28:31], v[120:123], v[84:87]
v_and_b32 v249, s101, v248
v_lshlrev_b32 v248, 16, v248
v_mfma_f32_16x16x32_bf16 v[88:91], a[32:35], v[120:123], v[88:91]
s_waitcnt vmcnt(13)
v_cvt_pk_bf16_f32 v250, v250, v251
v_and_b32 v251, s101, v250
v_mfma_f32_16x16x32_bf16 v[92:95], a[16:19], v[124:127], v[92:95]
v_lshlrev_b32 v250, 16, v250
s_sub_u32 s72, s28, 1
s_and_b32 s72, s72, 3
s_lshl_b32 s72, s72, 12
s_add_u32 s72, s72, 0
v_add_u32 v20, s72, v30
v_mfma_f32_16x16x32_bf16 v[96:99], a[20:23], v[124:127], v[96:99]
s_sub_u32 s72, s28, 2
s_and_b32 s72, s72, 3
s_lshl_b32 s72, s72, 12
s_add_u32 s72, s72, 0
v_add_u32 v232, s72, v30
v_mfma_f32_16x16x32_bf16 v[100:103], a[24:27], v[124:127], v[100:103]
s_sub_u32 s72, s28, 3
s_and_b32 s72, s72, 3
s_lshl_b32 s72, s72, 12
s_add_u32 s72, s72, 0
v_add_u32 v233, s72, v30
v_mfma_f32_16x16x32_bf16 v[104:107], a[28:31], v[124:127], v[104:107]
v_mfma_f32_16x16x32_bf16 v[108:111], a[32:35], v[124:127], v[108:111]
s_waitcnt vmcnt(11)
v_mfma_f32_16x16x32_bf16 v[52:55], a[36:39], v[132:135], v[52:55]
v_mfma_f32_16x16x32_bf16 v[56:59], a[40:43], v[132:135], v[56:59]
v_mfma_f32_16x16x32_bf16 v[60:63], a[44:47], v[132:135], v[60:63]
v_mfma_f32_16x16x32_bf16 v[64:67], a[48:51], v[132:135], v[64:67]
v_mfma_f32_16x16x32_bf16 v[68:71], a[52:55], v[132:135], v[68:71]
s_waitcnt vmcnt(10)
v_mfma_f32_16x16x32_bf16 v[72:75], a[36:39], v[136:139], v[72:75]
v_mfma_f32_16x16x32_bf16 v[76:79], a[40:43], v[136:139], v[76:79]
v_mfma_f32_16x16x32_bf16 v[80:83], a[44:47], v[136:139], v[80:83]
v_mfma_f32_16x16x32_bf16 v[84:87], a[48:51], v[136:139], v[84:87]
v_mfma_f32_16x16x32_bf16 v[88:91], a[52:55], v[136:139], v[88:91]
s_waitcnt vmcnt(7)
v_mfma_f32_16x16x32_bf16 v[52:55], a[56:59], v[148:151], v[52:55]
v_mfma_f32_16x16x32_bf16 v[56:59], a[60:63], v[148:151], v[56:59]
v_mfma_f32_16x16x32_bf16 v[60:63], a[64:67], v[148:151], v[60:63]
v_mfma_f32_16x16x32_bf16 v[64:67], a[68:71], v[148:151], v[64:67]
v_mfma_f32_16x16x32_bf16 v[68:71], a[72:75], v[148:151], v[68:71]
v_mfma_f32_16x16x32_bf16 v[92:95], a[36:39], v[140:143], v[92:95]
v_mfma_f32_16x16x32_bf16 v[96:99], a[40:43], v[140:143], v[96:99]
v_mfma_f32_16x16x32_bf16 v[100:103], a[44:47], v[140:143], v[100:103]
v_mfma_f32_16x16x32_bf16 v[104:107], a[48:51], v[140:143], v[104:107]
v_mfma_f32_16x16x32_bf16 v[108:111], a[52:55], v[140:143], v[108:111]
s_waitcnt vmcnt(2)
v_mfma_f32_16x16x32_bf16 v[52:55], a[76:79], v[164:167], v[52:55]
s_mov_b32 s32, 0x100000
PAIR:
v_cmp_gt_u32 vcc, 1, v238
s_sub_u32 s32, s32, 1
s_cbranch_scc1 PAIR_OK
s_cbranch_vccz PAIR_OK
s_sleep 1
buffer_load_dword v238, v247, s[24:27], 0 offen sc1
s_waitcnt vmcnt(0)
s_branch PAIR
PAIR_OK:
s_add_u32 s33, s77, 4096
v_mfma_f32_16x16x32_bf16 v[56:59], a[80:83], v[164:167], v[56:59]
v_mfma_f32_16x16x32_bf16 v[60:63], a[84:87], v[164:167], v[60:63]
buffer_load_dwordx4 v[192:195], v30, s[68:71], s77 offen offset:0 sc1
v_mfma_f32_16x16x32_bf16 v[64:67], a[88:91], v[164:167], v[64:67]
v_mfma_f32_16x16x32_bf16 v[68:71], a[92:95], v[164:167], v[68:71]
buffer_load_dwordx4 v[196:199], v30, s[68:71], s77 offen offset:1024 sc1
v_mfma_f32_16x16x32_bf16 v[72:75], a[56:59], v[152:155], v[72:75]
v_mfma_f32_16x16x32_bf16 v[76:79], a[60:63], v[152:155], v[76:79]
buffer_load_dwordx4 v[200:203], v30, s[68:71], s77 offen offset:2048 sc1
v_mfma_f32_16x16x32_bf16 v[80:83], a[64:67], v[152:155], v[80:83]
v_mfma_f32_16x16x32_bf16 v[84:87], a[68:71], v[152:155], v[84:87]
buffer_load_dwordx4 v[204:207], v30, s[68:71], s77 offen offset:3072 sc1
v_mfma_f32_16x16x32_bf16 v[88:91], a[72:75], v[152:155], v[88:91]
ds_write_b128 v12, v[52:55] offset:0
v_mfma_f32_16x16x32_bf16 v[32:35], a[36:39], v[128:131], v[32:35]
buffer_load_dwordx4 v[208:211], v30, s[68:71], s33 offen offset:0 sc1
v_mfma_f32_16x16x32_bf16 v[36:39], a[40:43], v[128:131], v[36:39]
v_mfma_f32_16x16x32_bf16 v[40:43], a[44:47], v[128:131], v[40:43]
ds_write_b128 v12, v[56:59] offset:1024
v_mfma_f32_16x16x32_bf16 v[44:47], a[48:51], v[128:131], v[44:47]
v_mfma_f32_16x16x32_bf16 v[48:51], a[52:55], v[128:131], v[48:51]
s_waitcnt vmcnt(6)
v_mfma_f32_16x16x32_bf16 v[72:75], a[76:79], v[168:171], v[72:75]
ds_write_b128 v12, v[60:63] offset:2048
v_mfma_f32_16x16x32_bf16 v[76:79], a[80:83], v[168:171], v[76:79]
v_mfma_f32_16x16x32_bf16 v[80:83], a[84:87], v[168:171], v[80:83]
v_mfma_f32_16x16x32_bf16 v[84:87], a[88:91], v[168:171], v[84:87]
ds_write_b128 v12, v[64:67] offset:3072
v_mfma_f32_16x16x32_bf16 v[88:91], a[92:95], v[168:171], v[88:91]
v_mfma_f32_16x16x32_bf16 v[92:95], a[56:59], v[156:159], v[92:95]
v_mfma_f32_16x16x32_bf16 v[96:99], a[60:63], v[156:159], v[96:99]
ds_write_b128 v12, v[68:71] offset:16384
v_mfma_f32_16x16x32_bf16 v[100:103], a[64:67], v[156:159], v[100:103]
v_mfma_f32_16x16x32_bf16 v[104:107], a[68:71], v[156:159], v[104:107]
v_mfma_f32_16x16x32_bf16 v[108:111], a[72:75], v[156:159], v[108:111]
s_waitcnt vmcnt(5)
ds_write_b128 v12, v[72:75] offset:17408
v_mfma_f32_16x16x32_bf16 v[92:95], a[76:79], v[172:175], v[92:95]
v_mfma_f32_16x16x32_bf16 v[96:99], a[80:83], v[172:175], v[96:99]
v_mfma_f32_16x16x32_bf16 v[100:103], a[84:87], v[172:175], v[100:103]
ds_write_b128 v12, v[76:79] offset:18432
v_mfma_f32_16x16x32_bf16 v[104:107], a[88:91], v[172:175], v[104:107]
v_mfma_f32_16x16x32_bf16 v[108:111], a[92:95], v[172:175], v[108:111]
v_mfma_f32_16x16x32_bf16 v[32:35], a[56:59], v[144:147], v[32:35]
ds_write_b128 v12, v[80:83] offset:19456
v_mfma_f32_16x16x32_bf16 v[36:39], a[60:63], v[144:147], v[36:39]
v_mfma_f32_16x16x32_bf16 v[40:43], a[64:67], v[144:147], v[40:43]
v_mfma_f32_16x16x32_bf16 v[44:47], a[68:71], v[144:147], v[44:47]
ds_write_b128 v12, v[84:87] offset:32768
v_mfma_f32_16x16x32_bf16 v[48:51], a[72:75], v[144:147], v[48:51]
v_mfma_f32_16x16x32_bf16 v[32:35], a[76:79], v[160:163], v[32:35]
v_mfma_f32_16x16x32_bf16 v[36:39], a[80:83], v[160:163], v[36:39]
ds_write_b128 v12, v[88:91] offset:33792
v_mfma_f32_16x16x32_bf16 v[40:43], a[84:87], v[160:163], v[40:43]
v_mfma_f32_16x16x32_bf16 v[44:47], a[88:91], v[160:163], v[44:47]
v_mfma_f32_16x16x32_bf16 v[48:51], a[92:95], v[160:163], v[48:51]
ds_write_b128 v12, v[92:95] offset:34816
ds_write_b128 v12, v[96:99] offset:35840
ds_write_b128 v12, v[100:103] offset:49152
ds_write_b128 v12, v[104:107] offset:50176
ds_write_b128 v12, v[108:111] offset:51200
v_lshlrev_b32 v112, 16, v22
v_and_b32 v113, s101, v22
v_lshlrev_b32 v114, 16, v23
v_and_b32 v115, s101, v23
v_lshlrev_b32 v116, 16, v24
v_and_b32 v117, s101, v24
v_lshlrev_b32 v118, 16, v25
v_and_b32 v119, s101, v25
v_lshlrev_b32 v120, 16, v26
v_and_b32 v121, s101, v26
v_lshlrev_b32 v122, 16, v27
v_and_b32 v123, s101, v27
v_lshlrev_b32 v124, 16, v28
v_and_b32 v125, s101, v28
v_lshlrev_b32 v126, 16, v29
v_and_b32 v127, s101, v29
v_lshlrev_b32 v128, 16, v18
v_and_b32 v129, s101, v18
v_lshlrev_b32 v130, 16, v19
v_and_b32 v131, s101, v19
s_waitcnt vmcnt(0)
v_add_f32 v32, v32, v192
v_add_f32 v33, v33, v193
v_add_f32 v34, v34, v194
v_add_f32 v35, v35, v195
v_add_f32 v36, v36, v196
v_add_f32 v37, v37, v197
v_add_f32 v38, v38, v198
v_add_f32 v39, v39, v199
v_add_f32 v40, v40, v200
v_add_f32 v41, v41, v201
v_add_f32 v42, v42, v202
v_add_f32 v43, v43, v203
v_add_f32 v44, v44, v204
v_add_f32 v45, v45, v205
v_add_f32 v46, v46, v206
v_add_f32 v47, v47, v207
v_add_f32 v48, v48, v208
v_add_f32 v49, v49, v209
v_add_f32 v50, v50, v210
v_add_f32 v51, v51, v211
s_waitcnt lgkmcnt(0)
s_barrier
ds_read_b128 v[52:55], v20 offset:0
ds_read_b128 v[72:75], v232 offset:17408
ds_read_b128 v[92:95], v233 offset:34816
ds_read_b128 v[56:59], v20 offset:1024
ds_read_b128 v[76:79], v232 offset:18432
ds_read_b128 v[96:99], v233 offset:35840
ds_read_b128 v[60:63], v20 offset:2048
ds_read_b128 v[80:83], v232 offset:19456
ds_read_b128 v[100:103], v233 offset:49152
ds_read_b128 v[64:67], v20 offset:3072
ds_read_b128 v[84:87], v232 offset:32768
ds_read_b128 v[104:107], v233 offset:50176
ds_read_b128 v[68:71], v20 offset:16384
ds_read_b128 v[88:91], v232 offset:33792
ds_read_b128 v[108:111], v233 offset:51200
s_waitcnt lgkmcnt(12)
v_add_f32 v32, v32, v52
v_add_f32 v33, v33, v53
v_add_f32 v34, v34, v54
v_add_f32 v35, v35, v55
v_add_f32 v72, v72, v92
v_add_f32 v73, v73, v93
v_add_f32 v74, v74, v94
v_add_f32 v75, v75, v95
v_add_f32 v32, v32, v72
v_add_f32 v33, v33, v73
v_add_f32 v34, v34, v74
v_add_f32 v35, v35, v75
v_fmac_f32 v112, v32, v176
v_fmac_f32 v113, v33, v177
v_fmac_f32 v114, v34, v178
v_fmac_f32 v115, v35, v179
v_cvt_pk_bf16_f32 v22, v112, v113
v_cvt_pk_bf16_f32 v23, v114, v115
s_waitcnt lgkmcnt(9)
v_add_f32 v36, v36, v56
v_add_f32 v37, v37, v57
v_add_f32 v38, v38, v58
v_add_f32 v39, v39, v59
v_add_f32 v76, v76, v96
v_add_f32 v77, v77, v97
v_add_f32 v78, v78, v98
v_add_f32 v79, v79, v99
v_add_f32 v36, v36, v76
v_add_f32 v37, v37, v77
v_add_f32 v38, v38, v78
v_add_f32 v39, v39, v79
v_fmac_f32 v116, v36, v180
v_fmac_f32 v117, v37, v181
v_fmac_f32 v118, v38, v182
v_fmac_f32 v119, v39, v183
v_cvt_pk_bf16_f32 v24, v116, v117
v_cvt_pk_bf16_f32 v25, v118, v119
buffer_store_dwordx4 v[22:25], v31, s[4:7], 0 offen offset:0
s_waitcnt lgkmcnt(6)
v_add_f32 v40, v40, v60
v_add_f32 v41, v41, v61
v_add_f32 v42, v42, v62
v_add_f32 v43, v43, v63
v_add_f32 v80, v80, v100
v_add_f32 v81, v81, v101
v_add_f32 v82, v82, v102
v_add_f32 v83, v83, v103
v_add_f32 v40, v40, v80
v_add_f32 v41, v41, v81
v_add_f32 v42, v42, v82
v_add_f32 v43, v43, v83
v_fmac_f32 v120, v40, v184
v_fmac_f32 v121, v41, v185
v_fmac_f32 v122, v42, v186
v_fmac_f32 v123, v43, v187
v_cvt_pk_bf16_f32 v26, v120, v121
v_cvt_pk_bf16_f32 v27, v122, v123
s_waitcnt lgkmcnt(3)
v_add_f32 v44, v44, v64
v_add_f32 v45, v45, v65
v_add_f32 v46, v46, v66
v_add_f32 v47, v47, v67
v_add_f32 v84, v84, v104
v_add_f32 v85, v85, v105
v_add_f32 v86, v86, v106
v_add_f32 v87, v87, v107
v_add_f32 v44, v44, v84
v_add_f32 v45, v45, v85
v_add_f32 v46, v46, v86
v_add_f32 v47, v47, v87
v_fmac_f32 v124, v44, v188
v_fmac_f32 v125, v45, v189
v_fmac_f32 v126, v46, v190
v_fmac_f32 v127, v47, v191
v_cvt_pk_bf16_f32 v28, v124, v125
v_cvt_pk_bf16_f32 v29, v126, v127
buffer_store_dwordx4 v[26:29], v31, s[4:7], 0 offen offset:64
s_waitcnt lgkmcnt(0)
v_add_f32 v48, v48, v68
v_add_f32 v49, v49, v69
v_add_f32 v50, v50, v70
v_add_f32 v51, v51, v71
v_add_f32 v88, v88, v108
v_add_f32 v89, v89, v109
v_add_f32 v90, v90, v110
v_add_f32 v91, v91, v111
v_add_f32 v48, v48, v88
v_add_f32 v49, v49, v89
v_add_f32 v50, v50, v90
v_add_f32 v51, v51, v91
v_fmac_f32 v128, v48, v248
v_fmac_f32 v129, v49, v249
v_fmac_f32 v130, v50, v250
v_fmac_f32 v131, v51, v251
v_cvt_pk_bf16_f32 v18, v128, v129
v_cvt_pk_bf16_f32 v19, v130, v131
buffer_store_dwordx2 v[18:19], v16, s[4:7], 0 offen offset:128
END:
s_endpgm
SIDE:
s_waitcnt vmcnt(16)
s_cmp_eq_u32 s62, 6
s_cbranch_scc1 JOB1
s_cmp_eq_u32 s62, 5
s_cbranch_scc1 JOB2
s_cmp_eq_u32 s62, 4
s_cbranch_scc1 JOB3
s_cmp_eq_u32 s62, 3
s_cbranch_scc1 JOB4
s_cmp_eq_u32 s62, 2
s_cbranch_scc1 JOB5
s_cmp_eq_u32 s62, 1
s_cbranch_scc1 JOB6
JOB0:
s_lshl_b32 s75, s28, 13
s_add_u32 s75, s75, 131072
v_add_u32 v240, 0, v0
v_mul_u32_u24 v241, 6554, v240
v_lshrrev_b32 v241, 16, v241
v_mul_u32_u24 v242, 10, v241
v_sub_u32 v242, v240, v242
v_lshlrev_b32 v242, 4, v242
v_mul_u32_u24 v241, 1280, v241
v_add_u32 v212, v241, v242
s_add_u32 s68, s44, 0
s_addc_u32 s69, s45, 0
s_mov_b32 s70, 5242880
s_mov_b32 s71, 0x20000
s_lshr_b32 s73, s2, 1
s_and_b32 s72, s2, 1
s_lshl_b32 s72, s72, 2
s_add_u32 s72, s72, s28
s_mul_i32 s76, s73, 40960
s_mul_i32 s77, s72, 160
s_add_u32 s76, s76, s77
s_mul_i32 s77, s72, 655360
s_mul_i32 s73, s73, 5120
s_add_u32 s77, s77, s73
s_add_u32 m0, s75, 0
s_nop 0
buffer_load_dwordx4 v212, s[68:71], s76 offen  lds
s_add_u32 m0, s75, 1024
s_add_u32 s76, s76, 7680
buffer_load_dwordx4 v212, s[68:71], s76 offen  lds
s_add_u32 m0, s75, 2048
s_add_u32 s76, s76, 7680
buffer_load_dwordx4 v212, s[68:71], s76 offen  lds
s_add_u32 m0, s75, 3072
s_add_u32 s76, s76, 7680
buffer_load_dwordx4 v212, s[68:71], s76 offen  lds
s_add_u32 m0, s75, 4096
s_add_u32 s76, s76, 7680
buffer_load_dwordx4 v212, s[68:71], s76 offen  lds
s_add_u32 m0, s75, 5120
s_add_u32 s76, s76, 7680
buffer_load_dwordx4 v212, s[68:71], s76 offen  lds
v_and_b32 v215, 1, v0
v_lshlrev_b32 v215, 7, v215
v_add_u32 v215, 40, v215
buffer_load_dword v214, v215, s[64:67], 0 offen sc1
s_branch LOOP
JOB1:
v_lshrrev_b32 v240, 2, v0
v_and_b32 v248, 3, v0
v_lshlrev_b32 v248, 3, v248
v_add_u32 v243, s75, v248
v_mul_u32_u24 v241, 43, v240
v_lshrrev_b32 v241, 8, v241
v_mul_u32_u24 v242, 160, v240
v_lshl_add_u32 v242, v241, 6, v242
v_add_u32 v244, v242, v243
v_add_u32 v246, v244, v248
v_add_u32 v240, 16, v240
v_mul_u32_u24 v241, 43, v240
v_lshrrev_b32 v241, 8, v241
v_mul_u32_u24 v242, 160, v240
v_lshl_add_u32 v242, v241, 6, v242
v_add_u32 v245, v242, v243
v_add_u32 v247, v245, v248
s_waitcnt vmcnt(32)
ds_read_b64_tr_b16 v[188:189], v246 offset:0
ds_read_b64_tr_b16 v[190:191], v247 offset:0
ds_read_b64_tr_b16 v[192:193], v246 offset:8
ds_read_b64_tr_b16 v[194:195], v247 offset:8
ds_read_b64_tr_b16 v[196:197], v246 offset:64
ds_read_b64_tr_b16 v[198:199], v247 offset:64
ds_read_b64_tr_b16 v[200:201], v246 offset:72
ds_read_b64_tr_b16 v[202:203], v247 offset:72
ds_read_b64_tr_b16 v[204:205], v244 offset:128
ds_read_b64_tr_b16 v[206:207], v245 offset:128
s_movk_i32 s72, 128
s_mov_b32 s32, 0x100000
JOB1S:
v_cmp_gt_u32 vcc, s72, v214
s_sub_u32 s32, s32, 1
s_cbranch_scc1 JOB1S_OK
s_cbranch_vccz JOB1S_OK
s_sleep 1
buffer_load_dword v214, v215, s[64:67], 0 offen sc1
s_waitcnt vmcnt(0)
s_branch JOB1S
JOB1S_OK:
v_lshrrev_b32 v215, 1, v0
v_lshlrev_b32 v215, 7, v215
v_and_b32 v240, 1, v0
v_lshl_add_u32 v215, v240, 4, v215
s_mov_b32 s72, 3145728
buffer_load_dwordx4 v[168:171], v215, s[24:27], s72 offen sc1
s_add_u32 s12, s60, 20971520
s_addc_u32 s13, s61, 0
s_mov_b32 s14, 5242880
s_mov_b32 s15, 0x20000
s_and_b32 s76, s2, 7
s_mul_i32 s76, s76, 27
s_lshr_b32 s72, s2, 3
s_min_u32 s72, s72, 26
s_add_u32 s76, s76, s72
s_mul_i32 s72, s28, 160
v_lshrrev_b32 v240, 1, v0
v_add_u32 v240, s72, v240
v_mul_u32_u24 v240, 3456, v240
s_lshl_b32 s72, s76, 4
v_add_u32 v240, s72, v240
v_and_b32 v241, 1, v0
v_cmp_eq_u32 vcc, 1, v241
v_mov_b32 v242, s50
v_mov_b32 v243, s52
v_cndmask_b32 v242, v242, v243, vcc
v_mov_b32 v241, s51
v_mov_b32 v243, s53
v_cndmask_b32 v243, v241, v243, vcc
v_add_co_u32 v212, vcc, v242, v240
s_nop 1
v_addc_co_u32 v213, vcc, 0, v243, vcc
s_waitcnt lgkmcnt(0)
buffer_store_dwordx4 v[188:191], v30, s[12:15], s77 offen offset:0 sc1
buffer_store_dwordx4 v[192:195], v30, s[12:15], s77 offen offset:1024 sc1
buffer_store_dwordx4 v[196:199], v30, s[12:15], s77 offen offset:2048 sc1
buffer_store_dwordx4 v[200:203], v30, s[12:15], s77 offen offset:3072 sc1
s_add_u32 s77, s77, 4096
buffer_store_dwordx4 v[204:207], v30, s[12:15], s77 offen offset:0 sc1
s_lshr_b32 s77, s2, 3
s_and_b32 s77, s77, 7
s_cmp_ge_u32 s77, 5
s_cselect_b32 s72, 5, 0
s_sub_u32 s77, s77, s72
s_lshl_b32 s72, s77, 10
s_add_u32 m0, s75, s72
s_mul_i32 s72, s77, 110592
s_mov_b32 s73, 0
v_lshl_add_u64 v[240:241], v[212:213], 0, s[72:73]
global_load_lds_dwordx4 v[240:241], off
s_branch LOOP
JOB2:
s_waitcnt vmcnt(32)
v_max3_u32 v168, v168, v169, v170
v_max_u32 v168, v168, v171
s_nop 1
v_max_u32_dpp v168, v168, v168 row_ror:8 row_mask:0xf bank_mask:0xf
s_nop 1
v_max_u32_dpp v168, v168, v168 row_ror:4 row_mask:0xf bank_mask:0xf
s_nop 1
v_max_u32_dpp v168, v168, v168 row_ror:2 row_mask:0xf bank_mask:0xf
s_nop 1
v_max_u32_dpp v168, v168, v168 row_ror:1 row_mask:0xf bank_mask:0xf
s_nop 0
v_readlane_b32 s68, v168, 0
v_readlane_b32 s69, v168, 16
v_readlane_b32 s70, v168, 32
v_readlane_b32 s71, v168, 48
s_max_u32 s68, s68, s69
s_max_u32 s70, s70, s71
s_max_u32 s47, s68, s70
s_and_b32 s46, s47, 2047
s_sub_u32 s46, 2047, s46
s_lshr_b32 s47, s47, 11
s_bitcmp1_b32 s47, 15
s_mov_b32 s72, 0xffff
s_cselect_b32 s72, 0x8000, s72
s_xor_b32 s47, s47, s72
s_lshl_b32 s47, s47, 16
s_mul_i32 s73, s46, 1280
s_mul_i32 s72, s28, 320
s_add_u32 s73, s73, s72
v_and_b32 v240, 48, v0
buffer_load_dwordx4 v[168:171], v240, s[24:27], s73 offen offset:0 sc1
buffer_load_dwordx4 v[172:175], v240, s[24:27], s73 offen offset:64 sc1
buffer_load_dwordx4 v[176:179], v240, s[24:27], s73 offen offset:128 sc1
buffer_load_dwordx4 v[180:183], v240, s[24:27], s73 offen offset:192 sc1
buffer_load_dwordx4 v[184:187], v240, s[24:27], s73 offen offset:256 sc1
s_cmp_lg_u32 s28, 0
s_cbranch_scc1 JOB2W
s_lshr_b32 s72, s2, 3
s_lshl_b32 s72, s72, 5
s_and_b32 s73, s2, 7
s_add_u32 s72, s72, s73
s_lshl_b32 s72, s72, 2
s_add_u32 s72, s72, 3334144
v_mov_b32 v254, 1
v_mov_b32 v255, s72
buffer_store_dword v254, v255, s[24:27], 0 offen sc1
JOB2W:
s_add_u32 s77, s77, 1
s_cmp_eq_u32 s77, 5
s_cselect_b32 s77, 0, s77
s_lshl_b32 s72, s77, 10
s_add_u32 m0, s75, s72
s_mul_i32 s72, s77, 110592
s_mov_b32 s73, 0
v_lshl_add_u64 v[240:241], v[212:213], 0, s[72:73]
global_load_lds_dwordx4 v[240:241], off
s_branch LOOP
JOB3:
s_add_u32 s68, s54, 0
s_addc_u32 s69, s55, 0
s_mov_b32 s70, 2211840
s_mov_b32 s71, 0x20000
s_mul_i32 s72, s76, 10240
s_mul_i32 s73, s28, 2560
s_add_u32 s72, s72, s73
s_add_u32 m0, s75, 5120
s_nop 0
buffer_load_dwordx4 v30, s[68:71], s72 offen offset:0  lds
s_nop 0
buffer_load_dwordx4 v30, s[68:71], s72 offen offset:1024  lds
s_mov_b64 exec, 0xffffffff
buffer_load_dwordx4 v30, s[68:71], s72 offen offset:2048  lds
s_mov_b64 exec, -1
s_and_b32 s72, s2, 7
s_lshr_b32 s73, s2, 3
s_lshr_b32 s78, s72, 1
s_lshl_b32 s78, s78, 2
s_and_b32 s79, s73, 3
s_add_u32 s78, s78, s79
s_and_b32 s72, s72, 1
s_lshl_b32 s72, s72, 2
s_bfe_u32 s79, s73, 0x20002
s_add_u32 s79, s79, s72
s_lshr_b32 s73, s2, 7
s_lshl_b32 s30, s28, 1
s_add_u32 s30, s30, s73
s_lshl_b32 s73, s73, 2
s_add_u32 s73, s73, s28
s_mul_i32 s72, s79, 655360
s_mul_i32 s73, s73, 81920
s_add_u32 s72, s72, s73
s_add_u32 s72, s72, 20971520
s_add_u32 s12, s60, s72
s_addc_u32 s13, s61, 0
s_mov_b32 s14, 81920
s_mov_b32 s15, 0x20000
s_sub_u32 s72, s72, s33
s_sub_u32 s72, s72, 487424
s_add_u32 s42, s60, s72
s_addc_u32 s43, s61, 0
s_add_u32 s36, s42, 16384
s_addc_u32 s37, s43, 0
v_and_b32 v240, 15, v0
v_lshrrev_b32 v241, 4, v0
s_lshl_b32 s73, s78, 7
s_lshl_b32 s72, s30, 4
s_add_u32 s73, s73, s72
v_add_u32 v240, s73, v240
s_mul_i32 s72, s79, 160
v_mul_u32_u24 v240, 1280, v240
v_add_u32 v240, s72, v240
v_lshl_add_u32 v31, v241, 4, v240
v_lshl_add_u32 v16, v241, 3, v240
s_add_u32 s77, s77, 1
s_cmp_eq_u32 s77, 5
s_cselect_b32 s77, 0, s77
s_lshl_b32 s72, s77, 10
s_add_u32 m0, s75, s72
s_mul_i32 s72, s77, 110592
s_mov_b32 s73, 0
v_lshl_add_u64 v[240:241], v[212:213], 0, s[72:73]
global_load_lds_dwordx4 v[240:241], off
s_branch LOOP
JOB4:
v_add_u32 v215, 3334144, v215
buffer_load_dwordx4 v[228:231], v215, s[24:27], 0 offen sc1
buffer_load_dwordx4 v[22:25], v31, s[16:19], 0 offen offset:0
s_add_u32 s77, s77, 1
s_cmp_eq_u32 s77, 5
s_cselect_b32 s77, 0, s77
s_lshl_b32 s72, s77, 10
s_add_u32 m0, s75, s72
s_mul_i32 s72, s77, 110592
s_mov_b32 s73, 0
v_lshl_add_u64 v[240:241], v[212:213], 0, s[72:73]
global_load_lds_dwordx4 v[240:241], off
s_branch LOOP
JOB5:
s_waitcnt vmcnt(32)
s_mov_b32 s32, 0x100000
JOB5S:
v_min3_u32 v228, v228, v229, v230
v_min_u32 v228, v228, v231
v_cmp_gt_u32 vcc, 1, v228
s_sub_u32 s32, s32, 1
s_cbranch_scc1 JOB5S_OK
s_cbranch_vccz JOB5S_OK
s_sleep 1
buffer_load_dwordx4 v[228:231], v215, s[24:27], 0 offen sc1
s_waitcnt vmcnt(0)
s_branch JOB5S
JOB5S_OK:
buffer_load_dwordx4 v[26:29], v31, s[16:19], 0 offen offset:64
buffer_load_dwordx2 v[18:19], v16, s[16:19], 0 offen offset:128
s_add_u32 s77, s77, 1
s_cmp_eq_u32 s77, 5
s_cselect_b32 s77, 0, s77
s_lshl_b32 s72, s77, 10
s_add_u32 m0, s75, s72
s_mul_i32 s72, s77, 110592
s_mov_b32 s73, 0
v_lshl_add_u64 v[240:241], v[212:213], 0, s[72:73]
global_load_lds_dwordx4 v[240:241], off
s_branch LOOP
JOB6:
buffer_load_dwordx4 v[232:235], v31, s[24:27], 0 offen offset:0 sc1
buffer_load_dwordx4 v[252:255], v31, s[24:27], 0 offen offset:64 sc1
buffer_load_dwordx2 v[236:237], v16, s[24:27], 0 offen offset:128 sc1
s_bfe_u32 s72, s2, 0x20003
s_add_u32 s72, s72, 120
v_lshl_add_u32 v240, v0, 2, s72
v_lshlrev_b32 v240, 7, v240
buffer_load_dword v239, v240, s[12:15], 0 offen sc1
s_branch LOOP
REDO:
s_mov_b32 s63, 1
s_mov_b32 s49, 0
s_mov_b32 s34, 0
s_mov_b64 s[4:5], s[38:39]
s_mov_b64 s[8:9], s[40:41]
s_waitcnt vmcnt(0)
v_mov_b32 v204, 0xff800000
v_mov_b32 v205, 0xff800000
v_mov_b32 v206, 0xff800000
v_mov_b32 v207, 0xff800000
MAXL:
s_barrier
s_add_u32 m0, s33, 0
s_nop 0
buffer_load_dwordx4 v1, s[4:7], s34 offen offset:0 sc1 lds
buffer_load_dwordx4 v1, s[4:7], s34 offen offset:1024 sc1 lds
buffer_load_dwordx4 v1, s[4:7], s34 offen offset:2048 sc1 lds
buffer_load_dwordx4 v1, s[4:7], s34 offen offset:3072 sc1 lds
s_add_u32 s34, s34, 16384
s_waitcnt vmcnt(0)
s_barrier
ds_read_b128 a[128:131], v4 offset:0
ds_read_b128 a[132:135], v5 offset:0
ds_read_b128 a[136:139], v6 offset:0
ds_read_b128 a[140:143], v7 offset:0
ds_read_b128 a[144:147], v4 offset:1024
ds_read_b128 a[148:151], v5 offset:1024
ds_read_b128 a[152:155], v6 offset:1024
ds_read_b128 a[156:159], v7 offset:1024
s_waitcnt lgkmcnt(0)
ds_read_b128 a[160:163], v4 offset:2048
ds_read_b128 a[164:167], v5 offset:2048
ds_read_b128 a[168:171], v6 offset:2048
ds_read_b128 a[172:175], v7 offset:2048
ds_read_b128 a[176:179], v4 offset:3072
ds_read_b128 a[180:183], v5 offset:3072
ds_read_b128 a[184:187], v6 offset:3072
ds_read_b128 a[188:191], v7 offset:3072
s_waitcnt lgkmcnt(0)
v_mfma_f32_16x16x32_bf16 v[188:191], a[128:131], v[32:35], 0
v_mfma_f32_16x16x32_bf16 v[188:191], a[132:135], v[36:39], v[188:191]
v_mfma_f32_16x16x32_bf16 v[188:191], a[136:139], v[40:43], v[188:191]
v_mfma_f32_16x16x32_bf16 v[188:191], a[140:143], v[44:47], v[188:191]
v_mfma_f32_16x16x32_bf16 v[192:195], a[144:147], v[32:35], 0
v_mfma_f32_16x16x32_bf16 v[192:195], a[148:151], v[36:39], v[192:195]
v_mfma_f32_16x16x32_bf16 v[192:195], a[152:155], v[40:43], v[192:195]
v_mfma_f32_16x16x32_bf16 v[192:195], a[156:159], v[44:47], v[192:195]
v_mfma_f32_16x16x32_bf16 v[196:199], a[160:163], v[32:35], 0
v_mfma_f32_16x16x32_bf16 v[196:199], a[164:167], v[36:39], v[196:199]
v_mfma_f32_16x16x32_bf16 v[196:199], a[168:171], v[40:43], v[196:199]
v_mfma_f32_16x16x32_bf16 v[196:199], a[172:175], v[44:47], v[196:199]
v_mfma_f32_16x16x32_bf16 v[200:203], a[176:179], v[32:35], 0
v_mfma_f32_16x16x32_bf16 v[200:203], a[180:183], v[36:39], v[200:203]
v_mfma_f32_16x16x32_bf16 v[200:203], a[184:187], v[40:43], v[200:203]
v_mfma_f32_16x16x32_bf16 v[200:203], a[188:191], v[44:47], v[200:203]
s_nop 7
v_max3_f32 v204, v204, v188, v189
v_max3_f32 v204, v204, v190, v191
v_max3_f32 v204, v204, v192, v193
v_max3_f32 v204, v204, v194, v195
v_max3_f32 v204, v204, v196, v197
v_max3_f32 v204, v204, v198, v199
v_max3_f32 v204, v204, v200, v201
v_max3_f32 v204, v204, v202, v203
v_mfma_f32_16x16x32_bf16 v[188:191], a[128:131], v[48:51], 0
v_mfma_f32_16x16x32_bf16 v[188:191], a[132:135], v[52:55], v[188:191]
v_mfma_f32_16x16x32_bf16 v[188:191], a[136:139], v[56:59], v[188:191]
v_mfma_f32_16x16x32_bf16 v[188:191], a[140:143], v[60:63], v[188:191]
v_mfma_f32_16x16x32_bf16 v[192:195], a[144:147], v[48:51], 0
v_mfma_f32_16x16x32_bf16 v[192:195], a[148:151], v[52:55], v[192:195]
v_mfma_f32_16x16x32_bf16 v[192:195], a[152:155], v[56:59], v[192:195]
v_mfma_f32_16x16x32_bf16 v[192:195], a[156:159], v[60:63], v[192:195]
v_mfma_f32_16x16x32_bf16 v[196:199], a[160:163], v[48:51], 0
v_mfma_f32_16x16x32_bf16 v[196:199], a[164:167], v[52:55], v[196:199]
v_mfma_f32_16x16x32_bf16 v[196:199], a[168:171], v[56:59], v[196:199]
v_mfma_f32_16x16x32_bf16 v[196:199], a[172:175], v[60:63], v[196:199]
v_mfma_f32_16x16x32_bf16 v[200:203], a[176:179], v[48:51], 0
v_mfma_f32_16x16x32_bf16 v[200:203], a[180:183], v[52:55], v[200:203]
v_mfma_f32_16x16x32_bf16 v[200:203], a[184:187], v[56:59], v[200:203]
v_mfma_f32_16x16x32_bf16 v[200:203], a[188:191], v[60:63], v[200:203]
s_nop 7
v_max3_f32 v205, v205, v188, v189
v_max3_f32 v205, v205, v190, v191
v_max3_f32 v205, v205, v192, v193
v_max3_f32 v205, v205, v194, v195
v_max3_f32 v205, v205, v196, v197
v_max3_f32 v205, v205, v198, v199
v_max3_f32 v205, v205, v200, v201
v_max3_f32 v205, v205, v202, v203
v_mfma_f32_16x16x32_bf16 v[188:191], a[128:131], v[64:67], 0
v_mfma_f32_16x16x32_bf16 v[188:191], a[132:135], v[68:71], v[188:191]
v_mfma_f32_16x16x32_bf16 v[188:191], a[136:139], v[72:75], v[188:191]
v_mfma_f32_16x16x32_bf16 v[188:191], a[140:143], v[76:79], v[188:191]
v_mfma_f32_16x16x32_bf16 v[192:195], a[144:147], v[64:67], 0
v_mfma_f32_16x16x32_bf16 v[192:195], a[148:151], v[68:71], v[192:195]
v_mfma_f32_16x16x32_bf16 v[192:195], a[152:155], v[72:75], v[192:195]
v_mfma_f32_16x16x32_bf16 v[192:195], a[156:159], v[76:79], v[192:195]
v_mfma_f32_16x16x32_bf16 v[196:199], a[160:163], v[64:67], 0
v_mfma_f32_16x16x32_bf16 v[196:199], a[164:167], v[68:71], v[196:199]
v_mfma_f32_16x16x32_bf16 v[196:199], a[168:171], v[72:75], v[196:199]
v_mfma_f32_16x16x32_bf16 v[196:199], a[172:175], v[76:79], v[196:199]
v_mfma_f32_16x16x32_bf16 v[200:203], a[176:179], v[64:67], 0
v_mfma_f32_16x16x32_bf16 v[200:203], a[180:183], v[68:71], v[200:203]
v_mfma_f32_16x16x32_bf16 v[200:203], a[184:187], v[72:75], v[200:203]
v_mfma_f32_16x16x32_bf16 v[200:203], a[188:191], v[76:79], v[200:203]
s_nop 7
v_max3_f32 v206, v206, v188, v189
v_max3_f32 v206, v206, v190, v191
v_max3_f32 v206, v206, v192, v193
v_max3_f32 v206, v206, v194, v195
v_max3_f32 v206, v206, v196, v197
v_max3_f32 v206, v206, v198, v199
v_max3_f32 v206, v206, v200, v201
v_max3_f32 v206, v206, v202, v203
v_mfma_f32_16x16x32_bf16 v[188:191], a[128:131], v[80:83], 0
v_mfma_f32_16x16x32_bf16 v[188:191], a[132:135], v[84:87], v[188:191]
v_mfma_f32_16x16x32_bf16 v[188:191], a[136:139], v[88:91], v[188:191]
v_mfma_f32_16x16x32_bf16 v[188:191], a[140:143], v[92:95], v[188:191]
v_mfma_f32_16x16x32_bf16 v[192:195], a[144:147], v[80:83], 0
v_mfma_f32_16x16x32_bf16 v[192:195], a[148:151], v[84:87], v[192:195]
v_mfma_f32_16x16x32_bf16 v[192:195], a[152:155], v[88:91], v[192:195]
v_mfma_f32_16x16x32_bf16 v[192:195], a[156:159], v[92:95], v[192:195]
v_mfma_f32_16x16x32_bf16 v[196:199], a[160:163], v[80:83], 0
v_mfma_f32_16x16x32_bf16 v[196:199], a[164:167], v[84:87], v[196:199]
v_mfma_f32_16x16x32_bf16 v[196:199], a[168:171], v[88:91], v[196:199]
v_mfma_f32_16x16x32_bf16 v[196:199], a[172:175], v[92:95], v[196:199]
v_mfma_f32_16x16x32_bf16 v[200:203], a[176:179], v[80:83], 0
v_mfma_f32_16x16x32_bf16 v[200:203], a[180:183], v[84:87], v[200:203]
v_mfma_f32_16x16x32_bf16 v[200:203], a[184:187], v[88:91], v[200:203]
v_mfma_f32_16x16x32_bf16 v[200:203], a[188:191], v[92:95], v[200:203]
s_nop 7
v_max3_f32 v207, v207, v188, v189
v_max3_f32 v207, v207, v190, v191
v_max3_f32 v207, v207, v192, v193
v_max3_f32 v207, v207, v194, v195
v_max3_f32 v207, v207, v196, v197
v_max3_f32 v207, v207, v198, v199
v_max3_f32 v207, v207, v200, v201
v_max3_f32 v207, v207, v202, v203
s_cmp_lt_u32 s34, 0x80000
s_cbranch_scc1 MAXL
v_mov_b32 v240, v204
v_mov_b32 v241, v205
v_mov_b32 v242, v206
v_mov_b32 v243, v207
v_permlane16_swap_b32 v204, v240
v_permlane16_swap_b32 v205, v241
v_permlane16_swap_b32 v206, v242
v_permlane16_swap_b32 v207, v243
v_max_f32 v204, v204, v240
v_max_f32 v205, v205, v241
v_max_f32 v206, v206, v242
v_max_f32 v207, v207, v243
v_mov_b32 v240, v204
v_mov_b32 v241, v205
v_mov_b32 v242, v206
v_mov_b32 v243, v207
v_permlane32_swap_b32 v204, v240
v_permlane32_swap_b32 v205, v241
v_permlane32_swap_b32 v206, v242
v_permlane32_swap_b32 v207, v243
v_max_f32 v204, v204, v240
v_max_f32 v205, v205, v241
v_max_f32 v206, v206, v242
v_max_f32 v207, v207, v243
v_sub_f32 v144, 0, v204
v_sub_f32 v145, 0, v204
v_sub_f32 v146, 0, v204
v_sub_f32 v147, 0, v204
v_sub_f32 v148, 0, v205
v_sub_f32 v149, 0, v205
v_sub_f32 v150, 0, v205
v_sub_f32 v151, 0, v205
v_sub_f32 v152, 0, v206
v_sub_f32 v153, 0, v206
v_sub_f32 v154, 0, v206
v_sub_f32 v155, 0, v206
v_sub_f32 v156, 0, v207
v_sub_f32 v157, 0, v207
v_sub_f32 v158, 0, v207
v_sub_f32 v159, 0, v207
v_accvgpr_write_b32 a0, 0
v_accvgpr_write_b32 a1, 0
v_accvgpr_write_b32 a2, 0
v_accvgpr_write_b32 a3, 0
v_accvgpr_write_b32 a4, 0
v_accvgpr_write_b32 a5, 0
v_accvgpr_write_b32 a6, 0
v_accvgpr_write_b32 a7, 0
v_accvgpr_write_b32 a8, 0
v_accvgpr_write_b32 a9, 0
v_accvgpr_write_b32 a10, 0
v_accvgpr_write_b32 a11, 0
v_accvgpr_write_b32 a12, 0
v_accvgpr_write_b32 a13, 0
v_accvgpr_write_b32 a14, 0
v_accvgpr_write_b32 a15, 0
v_accvgpr_write_b32 a16, 0
v_accvgpr_write_b32 a17, 0
v_accvgpr_write_b32 a18, 0
v_accvgpr_write_b32 a19, 0
v_accvgpr_write_b32 a20, 0
v_accvgpr_write_b32 a21, 0
v_accvgpr_write_b32 a22, 0
v_accvgpr_write_b32 a23, 0
v_accvgpr_write_b32 a24, 0
v_accvgpr_write_b32 a25, 0
v_accvgpr_write_b32 a26, 0
v_accvgpr_write_b32 a27, 0
v_accvgpr_write_b32 a28, 0
v_accvgpr_write_b32 a29, 0
v_accvgpr_write_b32 a30, 0
v_accvgpr_write_b32 a31, 0
v_accvgpr_write_b32 a32, 0
v_accvgpr_write_b32 a33, 0
v_accvgpr_write_b32 a34, 0
v_accvgpr_write_b32 a35, 0
v_accvgpr_write_b32 a36, 0
v_accvgpr_write_b32 a37, 0
v_accvgpr_write_b32 a38, 0
v_accvgpr_write_b32 a39, 0
v_accvgpr_write_b32 a40, 0
v_accvgpr_write_b32 a41, 0
v_accvgpr_write_b32 a42, 0
v_accvgpr_write_b32 a43, 0
v_accvgpr_write_b32 a44, 0
v_accvgpr_write_b32 a45, 0
v_accvgpr_write_b32 a46, 0
v_accvgpr_write_b32 a47, 0
v_accvgpr_write_b32 a48, 0
v_accvgpr_write_b32 a49, 0
v_accvgpr_write_b32 a50, 0
v_accvgpr_write_b32 a51, 0
v_accvgpr_write_b32 a52, 0
v_accvgpr_write_b32 a53, 0
v_accvgpr_write_b32 a54, 0
v_accvgpr_write_b32 a55, 0
v_accvgpr_write_b32 a56, 0
v_accvgpr_write_b32 a57, 0
v_accvgpr_write_b32 a58, 0
v_accvgpr_write_b32 a59, 0
v_accvgpr_write_b32 a60, 0
v_accvgpr_write_b32 a61, 0
v_accvgpr_write_b32 a62, 0
v_accvgpr_write_b32 a63, 0
v_accvgpr_write_b32 a64, 0
v_accvgpr_write_b32 a65, 0
v_accvgpr_write_b32 a66, 0
v_accvgpr_write_b32 a67, 0
v_accvgpr_write_b32 a68, 0
v_accvgpr_write_b32 a69, 0
v_accvgpr_write_b32 a70, 0
v_accvgpr_write_b32 a71, 0
v_accvgpr_write_b32 a72, 0
v_accvgpr_write_b32 a73, 0
v_accvgpr_write_b32 a74, 0
v_accvgpr_write_b32 a75, 0
v_accvgpr_write_b32 a76, 0
v_accvgpr_write_b32 a77, 0
v_accvgpr_write_b32 a78, 0
v_accvgpr_write_b32 a79, 0
v_accvgpr_write_b32 a80, 0
v_accvgpr_write_b32 a81, 0
v_accvgpr_write_b32 a82, 0
v_accvgpr_write_b32 a83, 0
v_accvgpr_write_b32 a84, 0
v_accvgpr_write_b32 a85, 0
v_accvgpr_write_b32 a86, 0
v_accvgpr_write_b32 a87, 0
v_accvgpr_write_b32 a88, 0
v_accvgpr_write_b32 a89, 0
v_accvgpr_write_b32 a90, 0
v_accvgpr_write_b32 a91, 0
v_accvgpr_write_b32 a92, 0
v_accvgpr_write_b32 a93, 0
v_accvgpr_write_b32 a94, 0
v_accvgpr_write_b32 a95, 0
v_accvgpr_write_b32 a96, 0
v_accvgpr_write_b32 a97, 0
v_accvgpr_write_b32 a98, 0
v_accvgpr_write_b32 a99, 0
v_accvgpr_write_b32 a100, 0
v_accvgpr_write_b32 a101, 0
v_accvgpr_write_b32 a102, 0
v_accvgpr_write_b32 a103, 0
v_accvgpr_write_b32 a104, 0
v_accvgpr_write_b32 a105, 0
v_accvgpr_write_b32 a106, 0
v_accvgpr_write_b32 a107, 0
v_accvgpr_write_b32 a108, 0
v_accvgpr_write_b32 a109, 0
v_accvgpr_write_b32 a110, 0
v_accvgpr_write_b32 a111, 0
v_accvgpr_write_b32 a112, 0
v_accvgpr_write_b32 a113, 0
v_accvgpr_write_b32 a114, 0
v_accvgpr_write_b32 a115, 0
v_accvgpr_write_b32 a116, 0
v_accvgpr_write_b32 a117, 0
v_accvgpr_write_b32 a118, 0
v_accvgpr_write_b32 a119, 0
v_accvgpr_write_b32 a120, 0
v_accvgpr_write_b32 a121, 0
v_accvgpr_write_b32 a122, 0
v_accvgpr_write_b32 a123, 0
v_accvgpr_write_b32 a124, 0
v_accvgpr_write_b32 a125, 0
v_accvgpr_write_b32 a126, 0
v_accvgpr_write_b32 a127, 0
v_mov_b32 v160, 0
v_mov_b32 v161, 0
v_mov_b32 v162, 0
v_mov_b32 v163, 0
v_mov_b32 v164, 0
v_mov_b32 v165, 0
v_mov_b32 v166, 0
v_mov_b32 v167, 0
v_mov_b32 v136, 0
v_mov_b32 v137, 0
v_mov_b32 v138, 0
v_mov_b32 v139, 0
v_mov_b32 v140, 0
v_mov_b32 v141, 0
v_mov_b32 v142, 0
v_mov_b32 v143, 0
v_mov_b32 v216, 0
v_mov_b32 v217, 0
v_mov_b32 v218, 0
v_mov_b32 v219, 0
v_mov_b32 v220, 0
v_mov_b32 v221, 0
v_mov_b32 v222, 0
v_mov_b32 v223, 0
v_mov_b32 v208, 0x3f803f80
v_mov_b32 v209, 0x3f803f80
v_mov_b32 v210, 0x3f803f80
v_mov_b32 v211, 0x3f803f80
s_mov_b32 s34, 0
s_mov_b32 s35, 0
s_barrier
s_add_u32 m0, s33, 0
s_nop 0
buffer_load_dwordx4 v1, s[4:7], s34 offen offset:0 sc1 lds
buffer_load_dwordx4 v1, s[4:7], s34 offen offset:1024 sc1 lds
buffer_load_dwordx4 v1, s[4:7], s34 offen offset:2048 sc1 lds
buffer_load_dwordx4 v1, s[4:7], s34 offen offset:3072 sc1 lds
s_add_u32 s34, s34, 16384
s_add_u32 m0, s33, 65536
s_nop 0
buffer_load_dwordx4 v2, s[8:11], s35 offen offset:0 sc1 lds
buffer_load_dwordx4 v2, s[8:11], s35 offen offset:1024 sc1 lds
buffer_load_dwordx4 v2, s[8:11], s35 offen offset:2048 sc1 lds
buffer_load_dwordx4 v2, s[8:11], s35 offen offset:3072 sc1 lds
s_add_u32 s35, s35, 16384
s_add_u32 m0, s33, 16384
s_nop 0
buffer_load_dwordx4 v1, s[4:7], s34 offen offset:0 sc1 lds
buffer_load_dwordx4 v1, s[4:7], s34 offen offset:1024 sc1 lds
buffer_load_dwordx4 v1, s[4:7], s34 offen offset:2048 sc1 lds
buffer_load_dwordx4 v1, s[4:7], s34 offen offset:3072 sc1 lds
s_add_u32 s34, s34, 16384
s_add_u32 m0, s33, 81920
s_nop 0
buffer_load_dwordx4 v2, s[8:11], s35 offen offset:0 sc1 lds
buffer_load_dwordx4 v2, s[8:11], s35 offen offset:1024 sc1 lds
buffer_load_dwordx4 v2, s[8:11], s35 offen offset:2048 sc1 lds
buffer_load_dwordx4 v2, s[8:11], s35 offen offset:3072 sc1 lds
s_add_u32 s35, s35, 16384
s_add_u32 m0, s33, 32768
s_nop 0
buffer_load_dwordx4 v1, s[4:7], s34 offen offset:0 sc1 lds
buffer_load_dwordx4 v1, s[4:7], s34 offen offset:1024 sc1 lds
buffer_load_dwordx4 v1, s[4:7], s34 offen offset:2048 sc1 lds
buffer_load_dwordx4 v1, s[4:7], s34 offen offset:3072 sc1 lds
s_add_u32 s34, s34, 16384
s_add_u32 m0, s33, 98304
s_nop 0
buffer_load_dwordx4 v2, s[8:11], s35 offen offset:0 sc1 lds
buffer_load_dwordx4 v2, s[8:11], s35 offen offset:1024 sc1 lds
buffer_load_dwordx4 v2, s[8:11], s35 offen offset:2048 sc1 lds
buffer_load_dwordx4 v2, s[8:11], s35 offen offset:3072 sc1 lds
s_add_u32 s35, s35, 16384
s_add_u32 m0, s33, 49152
s_nop 0
buffer_load_dwordx4 v1, s[4:7], s34 offen offset:0 sc1 lds
buffer_load_dwordx4 v1, s[4:7], s34 offen offset:1024 sc1 lds
buffer_load_dwordx4 v1, s[4:7], s34 offen offset:2048 sc1 lds
buffer_load_dwordx4 v1, s[4:7], s34 offen offset:3072 sc1 lds
s_add_u32 s34, s34, 16384
s_waitcnt vmcnt(24)
s_barrier
ds_read_b128 a[128:131], v4 offset:0
ds_read_b128 a[132:135], v5 offset:0
ds_read_b128 a[136:139], v6 offset:0
ds_read_b128 a[140:143], v7 offset:0
ds_read_b128 a[144:147], v4 offset:1024
ds_read_b128 a[148:151], v5 offset:1024
ds_read_b128 a[152:155], v6 offset:1024
ds_read_b128 a[156:159], v7 offset:1024
s_waitcnt lgkmcnt(0)
ds_read_b128 a[160:163], v4 offset:2048
ds_read_b128 a[164:167], v5 offset:2048
ds_read_b128 a[168:171], v6 offset:2048
ds_read_b128 a[172:175], v7 offset:2048
ds_read_b128 a[176:179], v4 offset:3072
ds_read_b128 a[180:183], v5 offset:3072
ds_read_b128 a[184:187], v6 offset:3072
ds_read_b128 a[188:191], v7 offset:3072
s_waitcnt lgkmcnt(0)
v_mfma_f32_16x16x32_bf16 v[96:99], a[128:131], v[32:35], v[144:147]
v_mfma_f32_16x16x32_bf16 v[96:99], a[132:135], v[36:39], v[96:99]
v_mfma_f32_16x16x32_bf16 v[96:99], a[136:139], v[40:43], v[96:99]
v_mfma_f32_16x16x32_bf16 v[96:99], a[140:143], v[44:47], v[96:99]
v_mfma_f32_16x16x32_bf16 v[100:103], a[156:159], v[44:47], v[144:147]
v_mfma_f32_16x16x32_bf16 v[100:103], a[152:155], v[40:43], v[100:103]
v_mfma_f32_16x16x32_bf16 v[100:103], a[148:151], v[36:39], v[100:103]
v_mfma_f32_16x16x32_bf16 v[100:103], a[144:147], v[32:35], v[100:103]
v_mfma_f32_16x16x32_bf16 v[104:107], a[160:163], v[32:35], v[144:147]
v_mfma_f32_16x16x32_bf16 v[104:107], a[164:167], v[36:39], v[104:107]
v_mfma_f32_16x16x32_bf16 v[104:107], a[168:171], v[40:43], v[104:107]
v_mfma_f32_16x16x32_bf16 v[104:107], a[172:175], v[44:47], v[104:107]
v_mfma_f32_16x16x32_bf16 v[108:111], a[188:191], v[44:47], v[144:147]
v_mfma_f32_16x16x32_bf16 v[108:111], a[184:187], v[40:43], v[108:111]
v_mfma_f32_16x16x32_bf16 v[108:111], a[180:183], v[36:39], v[108:111]
v_mfma_f32_16x16x32_bf16 v[108:111], a[176:179], v[32:35], v[108:111]
s_mov_b32 s62, 8
CODE1:
s_branch LOOPW
s_endpgm
s_endpgm
s_endpgm
s_endpgm
s_endpgm
s_endpgm
s_endpgm
s_endpgm
s_endpgm
s_endpgm
s_endpgm
s_endpgm
s_endpgm
s_endpgm
s_endpgm
s_endpgm
s_endpgm
s_endpgm
s_endpgm
s_endpgm
s_endpgm
s_endpgm
s_endpgm
s_endpgm
s_endpgm
s_endpgm
s_endpgm
s_endpgm
s_endpgm
s_endpgm
s_endpgm
s_endpgm
s_endpgm
s_endpgm
s_endpgm
s_endpgm
s_endpgm
s_endpgm
s_endpgm
s_endpgm
s_endpgm
s_endpgm
s_endpgm
s_endpgm
s_endpgm
s_endpgm
s_endpgm
s_endpgm
s_endpgm
s_endpgm
s_endpgm
s_endpgm
s_endpgm
s_endpgm
s_endpgm
s_endpgm
s_endpgm
s_endpgm
s_endpgm
s_endpgm
s_endpgm
s_endpgm
s_endpgm
s_endpgm
.section .rodata,"a"
.p2align 6
.amdhsa_kernel recurrent_scan__mha_block_cached__moe_arch_mod__prompt_kernel
  .amdhsa_next_free_vgpr 512
  .amdhsa_next_free_sgpr 102
  .amdhsa_accum_offset 256
  .amdhsa_group_segment_fixed_size 0
  .amdhsa_kernarg_size 104
  .amdhsa_user_sgpr_count 2
  .amdhsa_user_sgpr_kernarg_segment_ptr 1
  .amdhsa_system_sgpr_workgroup_id_x 1
.end_amdhsa_kernel
```
